```python
import torch

def _softmax(x, axis=-1):
    return torch.softmax(x, dim=axis)
def _gelu(x):
    return torch.nn.functional.gelu(x, approximate="tanh")
def _silu(x):
    return torch.nn.functional.silu(x)
def _sigmoid(x):
    return torch.sigmoid(x)
def _layernorm(x, axis=-1, eps=1e-5):
    m = x.mean(dim=axis, keepdim=True)
    v = x.var(dim=axis, keepdim=True, unbiased=False)
    return (x - m) / torch.sqrt(v + eps)
def _scatter_add(tgt, idx, src, axis=0):
    return tgt.clone().index_add_(axis, idx, src)
def _segment_sum(src, seg, n):
    out = torch.zeros((n,) + src.shape[1:], dtype=src.dtype)
    return out.index_add_(0, seg, src)
def _pad(x, pw):
    flat = tuple(v for pair in reversed(pw) for v in pair)
    return torch.nn.functional.pad(x, flat)

kernel_name = 'concat_heads__mha_block__ssm_conv_s5__prompt'

def setup_inputs():

    _w = (lambda a: (lambda t: t.to(torch.bfloat16) if t.is_floating_point() else t)(torch.as_tensor(a)))
    def _A_setup():
        B, S, D, H = 1, 2048, 576, 32
        return {
            "x": _w((lambda *s: torch.randn(*s, dtype=torch.bfloat16) * 0.2)(B, S, D)),
            "wqkv": _w((lambda *s: torch.randn(*s, dtype=torch.bfloat16) * 0.2)(D, 3 * D)),
            "wo": _w((lambda *s: torch.randn(*s, dtype=torch.bfloat16) * 0.05)(D, D)),
        }
    _A_in = _A_setup()

    def _B_setup():
        B, S, D = 1, 2048, 576
        P = D
        Lambda_re = -0.5 * (lambda _x: torch.exp(torch.as_tensor(_x)))((lambda *s: torch.randn(*s, dtype=torch.bfloat16) * 0.8)(P))
        Lambda_im = (lambda *s: torch.randn(*s, dtype=torch.bfloat16) * 0.8)(P) * 1.0
        B_re = (lambda *s: torch.randn(*s, dtype=torch.bfloat16) * 0.8)(P, D) * (D ** -0.5)
        B_im = (lambda *s: torch.randn(*s, dtype=torch.bfloat16) * 0.8)(P, D) * (D ** -0.5)
        C_re = (lambda *s: torch.randn(*s, dtype=torch.bfloat16) * 0.8)(D, P) * (P ** -0.5)
        C_im = (lambda *s: torch.randn(*s, dtype=torch.bfloat16) * 0.8)(D, P) * (P ** -0.5)
        log_dt = (lambda *s: torch.randn(*s, dtype=torch.bfloat16) * 0.8)(P) * 0.3 - 2.0
        Dskip = (lambda *s: torch.randn(*s, dtype=torch.bfloat16) * 0.8)(D)
        return {
            "x": _w((lambda *s: torch.randn(*s, dtype=torch.bfloat16) * 0.05)(B, S, D)),
            "Lambda_re": _w(Lambda_re),
            "Lambda_im": _w(Lambda_im),
            "B_re": _w(B_re),
            "B_im": _w(B_im),
            "C_re": _w(C_re),
            "C_im": _w(C_im),
            "log_dt": _w(log_dt),
            "Dskip": _w(Dskip),
        }
    _B_in = _B_setup()

    return {
        "A_x": _A_in["x"],
        "A_wqkv": _A_in["wqkv"],
        "A_wo": _A_in["wo"],
        "B_x": _B_in["x"],
        "B_Lambda_re": _B_in["Lambda_re"],
        "B_Lambda_im": _B_in["Lambda_im"],
        "B_B_re": _B_in["B_re"],
        "B_B_im": _B_in["B_im"],
        "B_C_re": _B_in["C_re"],
        "B_C_im": _B_in["C_im"],
        "B_log_dt": _B_in["log_dt"],
        "B_Dskip": _B_in["Dskip"],
    }

def reference(A_x, A_wqkv, A_wo, B_x, B_Lambda_re, B_Lambda_im, B_B_re, B_B_im, B_C_re, B_C_im, B_log_dt, B_Dskip):
    def _A_ref(x, wqkv, wo):
        B, S, D = x.shape
        H = 32
        Dh = D // H
        qkv = (lambda x, *d: x.permute(*d))((x @ wqkv).reshape(B, S, 3, H, Dh), 2, 0, 3, 1, 4)
        q, k, v = qkv[0], qkv[1], qkv[2]
        scores = torch.einsum("bhqd,bhkd->bhqk", q, k) * (Dh ** -0.5)
        p = _softmax(scores, axis=-1)
        o = torch.einsum("bhqk,bhkd->bhqd", p, v)
        return (lambda x, *d: x.permute(*d))(o, 0, 2, 1, 3).reshape(B, S, D) @ wo

    def _B_ref(x, Lambda_re, Lambda_im, B_re, B_im, C_re, C_im, log_dt, Dskip):
        Bsz, L, H = x.shape
        Lam = Lambda_re + 1j * Lambda_im
        Bmat = B_re + 1j * B_im
        Cmat = C_re + 1j * C_im
        dt = torch.exp(log_dt)
        Lam_bar = torch.exp(dt * Lam)
        B_bar = ((Lam_bar - 1.0) / Lam)[:, None] * Bmat
        Bu = torch.einsum("bld,pd->blp", x + 0j, B_bar)
        h = torch.zeros_like(Bu[:, 0, :])
        hs = []
        for t in range(L):
            h = Lam_bar[None, :] * h + Bu[:, t, :]
            hs.append(h)
        hseq = torch.stack(hs, 1)
        y = 2.0 * torch.einsum("blp,dp->bld", hseq, Cmat).real + x * Dskip[None, None, :]
        return y

    a = _A_ref(A_x, A_wqkv, A_wo)
    b = _B_ref(B_x, B_Lambda_re, B_Lambda_im, B_B_re, B_B_im, B_C_re, B_C_im, B_log_dt, B_Dskip)
    return torch.concatenate([a, b], axis=-1)
```

```asm
; @launch grid=(512,1,1) block=(512,1,1) lds=81920
.amdgcn_target "amdgcn-amd-amdhsa--gfx950"
.text
.globl concat_heads__mha_block__ssm_conv_s5__prompt_kernel
.p2align 8
.type concat_heads__mha_block__ssm_conv_s5__prompt_kernel,@function
concat_heads__mha_block__ssm_conv_s5__prompt_kernel:
    s_cmp_ge_u32 s2, 512
    s_cbranch_scc1 K2_done
    s_load_dwordx16 s[16:31], s[0:1], 0
    s_load_dwordx8 s[32:39], s[0:1], 64
    s_load_dwordx4 s[40:43], s[0:1], 96
    s_load_dwordx2 s[44:45], s[0:1], 112
    s_getpc_b64 s[14:15]
E_pc:
    s_bfe_u32 s13, s2, 0x60003
    s_lshl_b32 s13, s13, 10
    v_lshlrev_b32 v10, 1, v0
    v_and_b32 v10, 0x380, v10
    v_add_u32 v10, s13, v10
    v_and_b32 v11, 32, v0
    v_lshl_add_u32 v10, v11, 11, v10
    s_sub_u32 s14, s14, E_pc-concat_heads__mha_block__ssm_conv_s5__prompt_kernel
    s_subb_u32 s15, s15, 0
    v_min_u32 v10, K2_last-concat_heads__mha_block__ssm_conv_s5__prompt_kernel, v10
    v_mov_b32 v11, s15
    v_add_co_u32 v10, vcc, s14, v10
    s_nop 1
    v_addc_co_u32 v11, vcc, 0, v11, vcc
    global_load_dword v121, v[10:11], off
    v_lshrrev_b32 v1, 6, v0
    v_and_b32 v0, 63, v0
    s_and_b32 s6, s2, 7
    v_readfirstlane_b32 s5, v1
    s_bfe_u32 s47, s2, 0x50003
    s_cmp_lt_u32 s47, 20
    s_cbranch_scc1 E_np
    s_sub_u32 s12, s47, 20
    s_lshl_b32 s12, s12, 3
    s_add_u32 s12, s12, s5
    v_mul_u32_u24 v1, 1152, v0
    v_mul_u32_u24 v2, 3456, v0
    s_waitcnt lgkmcnt(0)
    s_mov_b32 s48, s16
    s_mov_b32 s49, s17
    s_mov_b32 s50, 2359296
    s_mov_b32 s51, 0x00020000
    s_mov_b32 s52, s18
    s_mov_b32 s53, s19
    s_mov_b32 s54, 1990656
    s_mov_b32 s55, 0x00020000
    s_lshr_b32 s7, s2, 8
    s_mul_i32 s7, s7, 96
    s_add_u32 s12, s12, s7
    s_add_u32 s13, s12, 0
    s_mul_i32 s14, s13, 2850
    s_lshr_b32 s14, s14, 16
    s_mul_i32 s15, s14, 23
    s_sub_u32 s15, s13, s15
    s_cmp_ge_u32 s13, 207
    s_cbranch_scc1 P_ne
    s_cmp_lt_u32 s15, 8
    s_cbranch_scc0 P_we
    s_lshr_b32 s68, s6, 1
    s_lshl_b32 s68, s68, 3
    s_add_u32 s15, s15, s68
    s_mul_i32 s15, s15, 73728
    s_lshl_b32 s14, s14, 7
    s_add_u32 s15, s15, s14
    buffer_load_dword v120, v1, s[48:51], s15 offen
    s_branch P_ne
P_we:
    s_and_b32 s69, s6, 1
    s_mul_i32 s69, s69, 15
    s_add_u32 s15, s15, s69
    s_sub_u32 s15, s15, 8
    s_mul_i32 s14, s14, 221184
    s_cmp_lt_u32 s15, 27
    s_cselect_b32 s14, s14, 2130706432
    s_lshl_b32 s15, s15, 7
    s_add_u32 s15, s15, s14
    buffer_load_dword v120, v2, s[52:55], s15 offen
P_ne:
E_np:
    s_cmp_ge_u32 s2, 256
    s_cbranch_scc1 A_go
    s_cmp_ge_u32 s47, 20
    s_cbranch_scc1 K2_ssm
    s_lshr_b32 s3, s6, 1
    s_lshl_b32 s3, s3, 2
    s_and_b32 s4, s47, 3
    s_add_u32 s3, s3, s4
    s_and_b32 s6, s6, 1
    s_mul_i32 s6, s6, 5
    s_lshr_b32 s7, s47, 2
    s_add_u32 s4, s6, s7
    s_mov_b32 s101, s4
    s_and_b32 s6, s2, 7
    s_cmp_ge_u32 s4, 9
    s_waitcnt lgkmcnt(0)
    s_cbranch_scc1 I_go
    s_mov_b32 s48, s16
    s_mov_b32 s49, s17
    s_mov_b32 s50, 2359296
    s_mov_b32 s51, 0x00020000
    s_mov_b32 s52, s18
    s_mov_b32 s53, s19
    s_mov_b32 s54, 1990656
    s_mov_b32 s55, 0x00020000
    s_setprio 2
    s_mov_b32 s6, s5
    s_and_b32 s14, s5, 3
    s_lshr_b32 s15, s5, 2
    s_xor_b32 s15, s15, 1
    v_lshrrev_b32 v3, 3, v0
    v_lshrrev_b32 v4, 4, v0
    s_and_b32 s7, s6, 1
    s_lshl_b32 s7, s7, 2
    v_add_u32 v4, s7, v4
    v_and_b32 v5, 7, v0
    v_xor_b32 v4, v4, v5
    s_lshl_b32 s7, s6, 3
    v_add_u32 v3, s7, v3
    v_mul_u32_u24 v3, 1152, v3
    v_lshl_add_u32 v10, v4, 4, v3
    s_mul_i32 s68, s3, 147456
    s_mul_i32 s69, s4, 384
    s_lshl_b32 s76, s5, 10
    s_lshl_b32 s77, s14, 10
    s_lshr_b32 s6, s47, 2
    s_and_b32 s7, s47, 3
    s_add_u32 s6, s6, s7
    s_mul_i32 s6, s6, 0
    s_mul_i32 s7, s6, 57
    s_lshr_b32 s7, s7, 9
    s_mul_i32 s7, s7, 9
    s_sub_u32 s6, s6, s7
    s_lshl_b32 s78, s6, 7
    s_mul_i32 s79, s6, 221184
    s_add_u32 m0, s76, 0
    s_add_u32 s7, s68, s78
    buffer_load_dwordx4 v10, s[48:51], s7 offen lds
    s_add_u32 m0, s76, 8192
    s_add_u32 s7, s7, 73728
    buffer_load_dwordx4 v10, s[48:51], s7 offen lds
    s_add_u32 s78, s78, 128
    s_cmp_eq_u32 s78, 1152
    s_cselect_b32 s78, 0, s78
    s_lshr_b32 s7, s76, 4
    v_add_u32 v3, s7, v0
    v_mul_u32_u24 v4, 2731, v3
    v_lshrrev_b32 v4, 16, v4
    v_mul_u32_u24 v5, 24, v4
    v_sub_u32 v5, v3, v5
    v_and_b32 v3, 2, v4
    v_lshlrev_b32 v3, 1, v3
    v_xor_b32 v5, v5, v3
    v_mul_u32_u24 v4, 3456, v4
    v_lshl_add_u32 v11, v5, 4, v4
    s_lshr_b32 s7, s77, 4
    v_add_u32 v3, s7, v0
    v_add_u32 v3, 512, v3
    v_mul_u32_u24 v4, 2731, v3
    v_lshrrev_b32 v4, 16, v4
    v_mul_u32_u24 v5, 24, v4
    v_sub_u32 v5, v3, v5
    v_and_b32 v3, 2, v4
    v_lshlrev_b32 v3, 1, v3
    v_xor_b32 v5, v5, v3
    v_mul_u32_u24 v4, 3456, v4
    v_lshl_add_u32 v12, v5, 4, v4
    s_add_u32 m0, s76, 32768
    s_add_u32 s70, s69, s79
    buffer_load_dwordx4 v11, s[52:55], s70 offen lds
    s_add_u32 s79, s79, 110592
    s_cmp_eq_u32 s79, 1990656
    s_cselect_b32 s79, 0, s79
    s_cmp_eq_u32 s15, 0
    s_cbranch_scc0 Q_sk1
    s_add_u32 m0, s77, 40960
    s_nop 0
    buffer_load_dwordx4 v12, s[52:55], s70 offen lds
Q_sk1:
    s_add_u32 m0, s76, 45056
    s_add_u32 s70, s69, s79
    buffer_load_dwordx4 v11, s[52:55], s70 offen lds
    s_add_u32 s79, s79, 110592
    s_cmp_eq_u32 s79, 1990656
    s_cselect_b32 s79, 0, s79
    s_cmp_eq_u32 s15, 1
    s_cbranch_scc0 Q_sk2
    s_add_u32 m0, s77, 53248
    s_nop 0
    buffer_load_dwordx4 v12, s[52:55], s70 offen lds
Q_sk2:
    s_mov_b32 s60, s44
    s_mov_b32 s61, s45
    s_mov_b32 s62, 18021376
    s_mov_b32 s63, 0x00020000
    v_and_b32 v1, 31, v0
    v_lshrrev_b32 v2, 5, v0
    s_mov_b32 s8, 0
    s_mov_b32 s9, -1
    s_mov_b32 s10, 0xffff0000
    s_mov_b32 s11, 0xffff0000
    s_cmp_ge_u32 s4, 6
    s_cbranch_scc1 Q_v
    s_sub_u32 s46, s4, 3
    s_cmp_lt_u32 s4, 3
    s_cselect_b32 s46, s4, s46
    s_lshl_b32 s46, s46, 1
    s_add_u32 s46, s46, s15
    s_mov_b32 s92, 168167685
    s_mov_b32 s93, 201853703
    s_mov_b32 s94, 319754766
    s_mov_b32 s95, 353440784
    s_mov_b32 s96, 704719104
    s_mov_b32 s97, 738405122
    s_cmp_eq_u32 s46, 1
    s_cselect_b32 s92, 471341847, s92
    s_cselect_b32 s93, 505027865, s93
    s_cselect_b32 s94, 622928928, s94
    s_cselect_b32 s95, 656614946, s95
    s_cselect_b32 s96, 70200877, s96
    s_cselect_b32 s97, 673125901, s97
    s_cmp_eq_u32 s46, 2
    s_cselect_b32 s92, 117638658, s92
    s_cselect_b32 s93, 151324676, s93
    s_cselect_b32 s94, 269225739, s94
    s_cselect_b32 s95, 302911757, s95
    s_cselect_b32 s96, 420812820, s96
    s_cselect_b32 s97, 454498838, s97
    s_cmp_eq_u32 s46, 3
    s_cselect_b32 s92, 572399901, s92
    s_cselect_b32 s93, 606085919, s93
    s_cselect_b32 s94, 723986982, s94
    s_cselect_b32 s95, 757673000, s95
    s_cselect_b32 s96, 167849728, s96
    s_cselect_b32 s97, 774183955, s97
    s_cmp_eq_u32 s46, 4
    s_cselect_b32 s92, 218696712, s92
    s_cselect_b32 s93, 252382730, s93
    s_cselect_b32 s94, 370283793, s94
    s_cselect_b32 s95, 403969811, s95
    s_cselect_b32 s96, 755248131, s96
    s_cselect_b32 s97, 788934149, s97
    s_cmp_eq_u32 s46, 5
    s_cselect_b32 s92, 521870874, s92
    s_cselect_b32 s93, 555556892, s93
    s_cselect_b32 s94, 673457955, s94
    s_cselect_b32 s95, 707143973, s95
    s_cselect_b32 s96, 117441025, s96
    s_cselect_b32 s97, 723654928, s97
    v_bfe_u32 v3, v0, 2, 2
    v_lshl_add_u32 v3, v2, 3, v3
    v_mul_u32_u24 v3, 384, v3
    v_add_u32 v3, 32768, v3
    v_and_b32 v4, 8, v0
    v_lshlrev_b32 v4, 3, v4
    v_and_b32 v5, 3, v0
    v_lshlrev_b32 v5, 3, v5
    v_mov_b32 v6, s92
    v_mov_b32 v7, s93
    v_cndmask_b32 v6, v6, v7, s[10:11]
    v_bfe_u32 v6, v6, v5, 8
    v_lshlrev_b32 v6, 3, v6
    v_xor_b32 v6, v6, v4
    v_add_u32 v88, v3, v6
    v_mov_b32 v6, s94
    v_mov_b32 v7, s95
    v_cndmask_b32 v6, v6, v7, s[10:11]
    v_bfe_u32 v6, v6, v5, 8
    v_lshlrev_b32 v6, 3, v6
    v_xor_b32 v6, v6, v4
    v_add_u32 v89, v3, v6
    v_mov_b32 v6, s96
    v_mov_b32 v7, s97
    v_cndmask_b32 v6, v6, v7, s[10:11]
    v_bfe_u32 v6, v6, v5, 8
    v_lshlrev_b32 v6, 3, v6
    v_xor_b32 v6, v6, v4
    v_add_u32 v90, v3, v6
    s_lshl_b32 s7, s14, 12
    v_bfe_u32 v8, v1, 1, 3
    v_xor_b32 v8, v8, v2
    v_lshlrev_b32 v8, 4, v8
    v_lshl_add_u32 v8, v1, 7, v8
    v_add_u32 v84, s7, v8
    v_xor_b32 v85, 32, v84
    v_xor_b32 v86, 64, v84
    v_xor_b32 v87, 96, v84
    s_lshr_b32 s6, s3, 1
    s_mul_i32 s6, s6, 19456
    s_cmp_lt_u32 s4, 3
    s_cselect_b32 s7, 4980736, 0
    s_add_u32 s6, s6, s7
    s_and_b32 s7, s3, 1
    s_lshl_b32 s13, s7, 9
    s_lshl_b32 s7, s7, 2
    s_add_u32 s7, s7, s14
    s_lshl_b32 s12, s7, 9
    s_add_u32 s12, s12, s6
    s_add_u32 s75, s13, s6
    s_add_u32 s75, s75, 8192
    s_lshl_b32 s13, s14, 2
    s_add_u32 s13, s13, 16384
    v_lshl_add_u32 v3, v1, 4, s12
    v_lshl_add_u32 v4, v1, 4, s13
    s_mov_b32 s7, 155648
    v_mad_u32_u24 v5, v2, s7, v3
    v_xor_b32 v13, 1, v2
    v_lshlrev_b32 v17, 4, v1
    v_mad_u32_u24 v17, v2, s7, v17
    s_lshr_b32 s6, s46, 1
    s_mul_i32 s7, s6, 11
    s_lshr_b32 s7, s7, 1
    s_add_u32 s7, s7, s5
    s_mul_i32 s7, s7, 311296
    s_add_u32 s75, s75, s7
    s_lshl_b32 s7, s5, 10
    s_add_u32 s7, s7, 16384
    v_lshl_add_u32 v16, v0, 4, s7
    s_waitcnt vmcnt(1)
    s_barrier
    s_add_u32 m0, s76, 16384
    s_add_u32 s7, s68, s78
    buffer_load_dwordx4 v10, s[48:51], s7 offen lds
    s_add_u32 m0, s76, 24576
    s_add_u32 s7, s7, 73728
    buffer_load_dwordx4 v10, s[48:51], s7 offen lds
    s_add_u32 s78, s78, 128
    s_cmp_eq_u32 s78, 1152
    s_cselect_b32 s78, 0, s78
    s_add_u32 m0, s76, 57344
    s_add_u32 s70, s69, s79
    buffer_load_dwordx4 v11, s[52:55], s70 offen lds
    s_add_u32 s79, s79, 110592
    s_cmp_eq_u32 s79, 1990656
    s_cselect_b32 s79, 0, s79
    s_cmp_eq_u32 s15, 0
    s_cbranch_scc0 Q_sk3
    s_add_u32 m0, s77, 65536
    s_nop 0
    buffer_load_dwordx4 v12, s[52:55], s70 offen lds
Q_sk3:
    ds_read_b128 v[96:99], v84
    ds_read_b64_tr_b16 v[100:101], v88 offset:0
    ds_read_b64_tr_b16 v[102:103], v88 offset:1536
    ds_read_b64_tr_b16 v[104:105], v89 offset:0
    ds_read_b64_tr_b16 v[106:107], v89 offset:1536
    ds_read_b64_tr_b16 v[108:109], v90 offset:0
    ds_read_b64_tr_b16 v[110:111], v90 offset:1536
    v_add_u32 v84, 16384, v84
    s_waitcnt lgkmcnt(4)
    v_mfma_f32_32x32x16_bf16 v[32:47], v[100:103], v[96:99], 0
    ds_read_b128 v[112:115], v85
    ds_read_b64_tr_b16 v[116:117], v88 offset:6144
    ds_read_b64_tr_b16 v[118:119], v88 offset:7680
    s_waitcnt lgkmcnt(5)
    v_mfma_f32_32x32x16_bf16 v[48:63], v[104:107], v[96:99], 0
    ds_read_b64_tr_b16 v[120:121], v89 offset:6144
    ds_read_b64_tr_b16 v[122:123], v89 offset:7680
    ds_read_b64_tr_b16 v[124:125], v90 offset:6144
    s_waitcnt lgkmcnt(6)
    v_mfma_f32_32x32x16_bf16 v[64:79], v[108:111], v[96:99], 0
    ds_read_b64_tr_b16 v[126:127], v90 offset:7680
    v_add_u32 v85, 16384, v85
    v_add_u32 v88, 12288, v88
    v_add_u32 v89, 12288, v89
    v_add_u32 v90, 12288, v90
    s_waitcnt lgkmcnt(4)
    v_mfma_f32_32x32x16_bf16 v[32:47], v[116:119], v[112:115], v[32:47]
    s_waitcnt vmcnt(3)
    s_barrier
    ds_read_b128 v[96:99], v86
    ds_read_b64_tr_b16 v[100:101], v88 offset:0
    ds_read_b64_tr_b16 v[102:103], v88 offset:1536
    s_add_u32 m0, s76, 69632
    s_add_u32 s70, s69, s79
    buffer_load_dwordx4 v11, s[52:55], s70 offen lds
    s_add_u32 s79, s79, 110592
    s_cmp_eq_u32 s79, 1990656
    s_cselect_b32 s79, 0, s79
    s_waitcnt lgkmcnt(5)
    v_mfma_f32_32x32x16_bf16 v[48:63], v[120:123], v[112:115], v[48:63]
    ds_read_b64_tr_b16 v[104:105], v89 offset:0
    ds_read_b64_tr_b16 v[106:107], v89 offset:1536
    ds_read_b64_tr_b16 v[108:109], v90 offset:0
    s_cmp_eq_u32 s15, 1
    s_cbranch_scc0 Q_sk4
    s_add_u32 m0, s77, 77824
    s_nop 0
    buffer_load_dwordx4 v12, s[52:55], s70 offen lds
Q_sk4:
    s_waitcnt lgkmcnt(6)
    v_mfma_f32_32x32x16_bf16 v[64:79], v[124:127], v[112:115], v[64:79]
    ds_read_b64_tr_b16 v[110:111], v90 offset:1536
    v_add_u32 v86, 16384, v86
    s_waitcnt lgkmcnt(4)
    v_mfma_f32_32x32x16_bf16 v[32:47], v[100:103], v[96:99], v[32:47]
    ds_read_b128 v[112:115], v87
    ds_read_b64_tr_b16 v[116:117], v88 offset:6144
    ds_read_b64_tr_b16 v[118:119], v88 offset:7680
    s_waitcnt lgkmcnt(5)
    v_mfma_f32_32x32x16_bf16 v[48:63], v[104:107], v[96:99], v[48:63]
    ds_read_b64_tr_b16 v[120:121], v89 offset:6144
    ds_read_b64_tr_b16 v[122:123], v89 offset:7680
    ds_read_b64_tr_b16 v[124:125], v90 offset:6144
    s_waitcnt lgkmcnt(6)
    v_mfma_f32_32x32x16_bf16 v[64:79], v[108:111], v[96:99], v[64:79]
    ds_read_b64_tr_b16 v[126:127], v90 offset:7680
    v_add_u32 v87, 16384, v87
    v_add_u32 v88, 12288, v88
    v_add_u32 v89, 12288, v89
    v_add_u32 v90, 12288, v90
    s_waitcnt lgkmcnt(4)
    v_mfma_f32_32x32x16_bf16 v[32:47], v[116:119], v[112:115], v[32:47]
    s_waitcnt vmcnt(1)
    s_barrier
    ds_read_b128 v[96:99], v84
    ds_read_b64_tr_b16 v[100:101], v88 offset:0
    ds_read_b64_tr_b16 v[102:103], v88 offset:1536
    s_add_u32 m0, s76, 0
    s_add_u32 s7, s68, s78
    buffer_load_dwordx4 v10, s[48:51], s7 offen lds
    s_waitcnt lgkmcnt(5)
    v_mfma_f32_32x32x16_bf16 v[48:63], v[120:123], v[112:115], v[48:63]
    ds_read_b64_tr_b16 v[104:105], v89 offset:0
    ds_read_b64_tr_b16 v[106:107], v89 offset:1536
    ds_read_b64_tr_b16 v[108:109], v90 offset:0
    s_add_u32 m0, s76, 8192
    s_add_u32 s7, s7, 73728
    buffer_load_dwordx4 v10, s[48:51], s7 offen lds
    s_add_u32 s78, s78, 128
    s_cmp_eq_u32 s78, 1152
    s_cselect_b32 s78, 0, s78
    s_waitcnt lgkmcnt(6)
    v_mfma_f32_32x32x16_bf16 v[64:79], v[124:127], v[112:115], v[64:79]
    ds_read_b64_tr_b16 v[110:111], v90 offset:1536
    v_add_u32 v84, 4294950912, v84
    s_add_u32 m0, s76, 32768
    s_add_u32 s70, s69, s79
    buffer_load_dwordx4 v11, s[52:55], s70 offen lds
    s_add_u32 s79, s79, 110592
    s_cmp_eq_u32 s79, 1990656
    s_cselect_b32 s79, 0, s79
    s_waitcnt lgkmcnt(4)
    v_mfma_f32_32x32x16_bf16 v[32:47], v[100:103], v[96:99], v[32:47]
    ds_read_b128 v[112:115], v85
    ds_read_b64_tr_b16 v[116:117], v88 offset:6144
    ds_read_b64_tr_b16 v[118:119], v88 offset:7680
    s_cmp_eq_u32 s15, 0
    s_cbranch_scc0 Q_sk5
    s_add_u32 m0, s77, 40960
    s_nop 0
    buffer_load_dwordx4 v12, s[52:55], s70 offen lds
Q_sk5:
    s_waitcnt lgkmcnt(5)
    v_mfma_f32_32x32x16_bf16 v[48:63], v[104:107], v[96:99], v[48:63]
    ds_read_b64_tr_b16 v[120:121], v89 offset:6144
    ds_read_b64_tr_b16 v[122:123], v89 offset:7680
    ds_read_b64_tr_b16 v[124:125], v90 offset:6144
    s_waitcnt lgkmcnt(6)
    v_mfma_f32_32x32x16_bf16 v[64:79], v[108:111], v[96:99], v[64:79]
    ds_read_b64_tr_b16 v[126:127], v90 offset:7680
    v_add_u32 v85, 4294950912, v85
    v_add_u32 v88, 12288, v88
    v_add_u32 v89, 12288, v89
    v_add_u32 v90, 12288, v90
    s_waitcnt lgkmcnt(4)
    v_mfma_f32_32x32x16_bf16 v[32:47], v[116:119], v[112:115], v[32:47]
    s_waitcnt vmcnt(3)
    s_barrier
    ds_read_b128 v[96:99], v86
    ds_read_b64_tr_b16 v[100:101], v88 offset:0
    ds_read_b64_tr_b16 v[102:103], v88 offset:1536
    s_add_u32 m0, s76, 45056
    s_add_u32 s70, s69, s79
    buffer_load_dwordx4 v11, s[52:55], s70 offen lds
    s_add_u32 s79, s79, 110592
    s_cmp_eq_u32 s79, 1990656
    s_cselect_b32 s79, 0, s79
    s_waitcnt lgkmcnt(5)
    v_mfma_f32_32x32x16_bf16 v[48:63], v[120:123], v[112:115], v[48:63]
    ds_read_b64_tr_b16 v[104:105], v89 offset:0
    ds_read_b64_tr_b16 v[106:107], v89 offset:1536
    ds_read_b64_tr_b16 v[108:109], v90 offset:0
    s_cmp_eq_u32 s15, 1
    s_cbranch_scc0 Q_sk6
    s_add_u32 m0, s77, 53248
    s_nop 0
    buffer_load_dwordx4 v12, s[52:55], s70 offen lds
Q_sk6:
    s_waitcnt lgkmcnt(6)
    v_mfma_f32_32x32x16_bf16 v[64:79], v[124:127], v[112:115], v[64:79]
    ds_read_b64_tr_b16 v[110:111], v90 offset:1536
    v_add_u32 v86, 4294950912, v86
    s_waitcnt lgkmcnt(4)
    v_mfma_f32_32x32x16_bf16 v[32:47], v[100:103], v[96:99], v[32:47]
    ds_read_b128 v[112:115], v87
    ds_read_b64_tr_b16 v[116:117], v88 offset:6144
    ds_read_b64_tr_b16 v[118:119], v88 offset:7680
    s_waitcnt lgkmcnt(5)
    v_mfma_f32_32x32x16_bf16 v[48:63], v[104:107], v[96:99], v[48:63]
    ds_read_b64_tr_b16 v[120:121], v89 offset:6144
    ds_read_b64_tr_b16 v[122:123], v89 offset:7680
    ds_read_b64_tr_b16 v[124:125], v90 offset:6144
    s_waitcnt lgkmcnt(6)
    v_mfma_f32_32x32x16_bf16 v[64:79], v[108:111], v[96:99], v[64:79]
    ds_read_b64_tr_b16 v[126:127], v90 offset:7680
    v_add_u32 v87, 4294950912, v87
    v_add_u32 v88, 4294930432, v88
    v_add_u32 v89, 4294930432, v89
    v_add_u32 v90, 4294930432, v90
    s_waitcnt lgkmcnt(4)
    v_mfma_f32_32x32x16_bf16 v[32:47], v[116:119], v[112:115], v[32:47]
    s_waitcnt vmcnt(1)
    s_barrier
    ds_read_b128 v[96:99], v84
    ds_read_b64_tr_b16 v[100:101], v88 offset:0
    ds_read_b64_tr_b16 v[102:103], v88 offset:1536
    s_add_u32 m0, s76, 16384
    s_add_u32 s7, s68, s78
    buffer_load_dwordx4 v10, s[48:51], s7 offen lds
    s_waitcnt lgkmcnt(5)
    v_mfma_f32_32x32x16_bf16 v[48:63], v[120:123], v[112:115], v[48:63]
    ds_read_b64_tr_b16 v[104:105], v89 offset:0
    ds_read_b64_tr_b16 v[106:107], v89 offset:1536
    ds_read_b64_tr_b16 v[108:109], v90 offset:0
    s_add_u32 m0, s76, 24576
    s_add_u32 s7, s7, 73728
    buffer_load_dwordx4 v10, s[48:51], s7 offen lds
    s_add_u32 s78, s78, 128
    s_cmp_eq_u32 s78, 1152
    s_cselect_b32 s78, 0, s78
    s_waitcnt lgkmcnt(6)
    v_mfma_f32_32x32x16_bf16 v[64:79], v[124:127], v[112:115], v[64:79]
    ds_read_b64_tr_b16 v[110:111], v90 offset:1536
    v_add_u32 v84, 16384, v84
    s_add_u32 m0, s76, 57344
    s_add_u32 s70, s69, s79
    buffer_load_dwordx4 v11, s[52:55], s70 offen lds
    s_add_u32 s79, s79, 110592
    s_cmp_eq_u32 s79, 1990656
    s_cselect_b32 s79, 0, s79
    s_waitcnt lgkmcnt(4)
    v_mfma_f32_32x32x16_bf16 v[32:47], v[100:103], v[96:99], v[32:47]
    ds_read_b128 v[112:115], v85
    ds_read_b64_tr_b16 v[116:117], v88 offset:6144
    ds_read_b64_tr_b16 v[118:119], v88 offset:7680
    s_cmp_eq_u32 s15, 0
    s_cbranch_scc0 Q_sk7
    s_add_u32 m0, s77, 65536
    s_nop 0
    buffer_load_dwordx4 v12, s[52:55], s70 offen lds
Q_sk7:
    s_waitcnt lgkmcnt(5)
    v_mfma_f32_32x32x16_bf16 v[48:63], v[104:107], v[96:99], v[48:63]
    ds_read_b64_tr_b16 v[120:121], v89 offset:6144
    ds_read_b64_tr_b16 v[122:123], v89 offset:7680
    ds_read_b64_tr_b16 v[124:125], v90 offset:6144
    s_waitcnt lgkmcnt(6)
    v_mfma_f32_32x32x16_bf16 v[64:79], v[108:111], v[96:99], v[64:79]
    ds_read_b64_tr_b16 v[126:127], v90 offset:7680
    v_add_u32 v85, 16384, v85
    v_add_u32 v88, 12288, v88
    v_add_u32 v89, 12288, v89
    v_add_u32 v90, 12288, v90
    s_waitcnt lgkmcnt(4)
    v_mfma_f32_32x32x16_bf16 v[32:47], v[116:119], v[112:115], v[32:47]
    s_waitcnt vmcnt(3)
    s_barrier
    ds_read_b128 v[96:99], v86
    ds_read_b64_tr_b16 v[100:101], v88 offset:0
    ds_read_b64_tr_b16 v[102:103], v88 offset:1536
    s_add_u32 m0, s76, 69632
    s_add_u32 s70, s69, s79
    buffer_load_dwordx4 v11, s[52:55], s70 offen lds
    s_add_u32 s79, s79, 110592
    s_cmp_eq_u32 s79, 1990656
    s_cselect_b32 s79, 0, s79
    s_waitcnt lgkmcnt(5)
    v_mfma_f32_32x32x16_bf16 v[48:63], v[120:123], v[112:115], v[48:63]
    ds_read_b64_tr_b16 v[104:105], v89 offset:0
    ds_read_b64_tr_b16 v[106:107], v89 offset:1536
    ds_read_b64_tr_b16 v[108:109], v90 offset:0
    s_cmp_eq_u32 s15, 1
    s_cbranch_scc0 Q_sk8
    s_add_u32 m0, s77, 77824
    s_nop 0
    buffer_load_dwordx4 v12, s[52:55], s70 offen lds
Q_sk8:
    s_waitcnt lgkmcnt(6)
    v_mfma_f32_32x32x16_bf16 v[64:79], v[124:127], v[112:115], v[64:79]
    ds_read_b64_tr_b16 v[110:111], v90 offset:1536
    v_add_u32 v86, 16384, v86
    s_waitcnt lgkmcnt(4)
    v_mfma_f32_32x32x16_bf16 v[32:47], v[100:103], v[96:99], v[32:47]
    ds_read_b128 v[112:115], v87
    ds_read_b64_tr_b16 v[116:117], v88 offset:6144
    ds_read_b64_tr_b16 v[118:119], v88 offset:7680
    s_waitcnt lgkmcnt(5)
    v_mfma_f32_32x32x16_bf16 v[48:63], v[104:107], v[96:99], v[48:63]
    ds_read_b64_tr_b16 v[120:121], v89 offset:6144
    ds_read_b64_tr_b16 v[122:123], v89 offset:7680
    ds_read_b64_tr_b16 v[124:125], v90 offset:6144
    s_waitcnt lgkmcnt(6)
    v_mfma_f32_32x32x16_bf16 v[64:79], v[108:111], v[96:99], v[64:79]
    ds_read_b64_tr_b16 v[126:127], v90 offset:7680
    v_add_u32 v87, 16384, v87
    v_add_u32 v88, 12288, v88
    v_add_u32 v89, 12288, v89
    v_add_u32 v90, 12288, v90
    s_waitcnt lgkmcnt(4)
    v_mfma_f32_32x32x16_bf16 v[32:47], v[116:119], v[112:115], v[32:47]
    s_waitcnt vmcnt(1)
    s_barrier
    ds_read_b128 v[96:99], v84
    ds_read_b64_tr_b16 v[100:101], v88 offset:0
    ds_read_b64_tr_b16 v[102:103], v88 offset:1536
    s_add_u32 m0, s76, 0
    s_add_u32 s7, s68, s78
    buffer_load_dwordx4 v10, s[48:51], s7 offen lds
    s_waitcnt lgkmcnt(5)
    v_mfma_f32_32x32x16_bf16 v[48:63], v[120:123], v[112:115], v[48:63]
    ds_read_b64_tr_b16 v[104:105], v89 offset:0
    ds_read_b64_tr_b16 v[106:107], v89 offset:1536
    ds_read_b64_tr_b16 v[108:109], v90 offset:0
    s_add_u32 m0, s76, 8192
    s_add_u32 s7, s7, 73728
    buffer_load_dwordx4 v10, s[48:51], s7 offen lds
    s_add_u32 s78, s78, 128
    s_cmp_eq_u32 s78, 1152
    s_cselect_b32 s78, 0, s78
    s_waitcnt lgkmcnt(6)
    v_mfma_f32_32x32x16_bf16 v[64:79], v[124:127], v[112:115], v[64:79]
    ds_read_b64_tr_b16 v[110:111], v90 offset:1536
    v_add_u32 v84, 4294950912, v84
    s_add_u32 m0, s76, 32768
    s_add_u32 s70, s69, s79
    buffer_load_dwordx4 v11, s[52:55], s70 offen lds
    s_add_u32 s79, s79, 110592
    s_cmp_eq_u32 s79, 1990656
    s_cselect_b32 s79, 0, s79
    s_waitcnt lgkmcnt(4)
    v_mfma_f32_32x32x16_bf16 v[32:47], v[100:103], v[96:99], v[32:47]
    ds_read_b128 v[112:115], v85
    ds_read_b64_tr_b16 v[116:117], v88 offset:6144
    ds_read_b64_tr_b16 v[118:119], v88 offset:7680
    s_cmp_eq_u32 s15, 0
    s_cbranch_scc0 Q_sk9
    s_add_u32 m0, s77, 40960
    s_nop 0
    buffer_load_dwordx4 v12, s[52:55], s70 offen lds
Q_sk9:
    s_waitcnt lgkmcnt(5)
    v_mfma_f32_32x32x16_bf16 v[48:63], v[104:107], v[96:99], v[48:63]
    ds_read_b64_tr_b16 v[120:121], v89 offset:6144
    ds_read_b64_tr_b16 v[122:123], v89 offset:7680
    ds_read_b64_tr_b16 v[124:125], v90 offset:6144
    s_waitcnt lgkmcnt(6)
    v_mfma_f32_32x32x16_bf16 v[64:79], v[108:111], v[96:99], v[64:79]
    ds_read_b64_tr_b16 v[126:127], v90 offset:7680
    v_add_u32 v85, 4294950912, v85
    v_add_u32 v88, 12288, v88
    v_add_u32 v89, 12288, v89
    v_add_u32 v90, 12288, v90
    s_waitcnt lgkmcnt(4)
    v_mfma_f32_32x32x16_bf16 v[32:47], v[116:119], v[112:115], v[32:47]
    s_waitcnt vmcnt(3)
    s_barrier
    ds_read_b128 v[96:99], v86
    ds_read_b64_tr_b16 v[100:101], v88 offset:0
    ds_read_b64_tr_b16 v[102:103], v88 offset:1536
    s_add_u32 m0, s76, 45056
    s_add_u32 s70, s69, s79
    buffer_load_dwordx4 v11, s[52:55], s70 offen lds
    s_add_u32 s79, s79, 110592
    s_cmp_eq_u32 s79, 1990656
    s_cselect_b32 s79, 0, s79
    s_waitcnt lgkmcnt(5)
    v_mfma_f32_32x32x16_bf16 v[48:63], v[120:123], v[112:115], v[48:63]
    ds_read_b64_tr_b16 v[104:105], v89 offset:0
    ds_read_b64_tr_b16 v[106:107], v89 offset:1536
    ds_read_b64_tr_b16 v[108:109], v90 offset:0
    s_cmp_eq_u32 s15, 1
    s_cbranch_scc0 Q_sk10
    s_add_u32 m0, s77, 53248
    s_nop 0
    buffer_load_dwordx4 v12, s[52:55], s70 offen lds
Q_sk10:
    s_waitcnt lgkmcnt(6)
    v_mfma_f32_32x32x16_bf16 v[64:79], v[124:127], v[112:115], v[64:79]
    ds_read_b64_tr_b16 v[110:111], v90 offset:1536
    v_add_u32 v86, 4294950912, v86
    s_waitcnt lgkmcnt(4)
    v_mfma_f32_32x32x16_bf16 v[32:47], v[100:103], v[96:99], v[32:47]
    ds_read_b128 v[112:115], v87
    ds_read_b64_tr_b16 v[116:117], v88 offset:6144
    ds_read_b64_tr_b16 v[118:119], v88 offset:7680
    s_waitcnt lgkmcnt(5)
    v_mfma_f32_32x32x16_bf16 v[48:63], v[104:107], v[96:99], v[48:63]
    ds_read_b64_tr_b16 v[120:121], v89 offset:6144
    ds_read_b64_tr_b16 v[122:123], v89 offset:7680
    ds_read_b64_tr_b16 v[124:125], v90 offset:6144
    s_waitcnt lgkmcnt(6)
    v_mfma_f32_32x32x16_bf16 v[64:79], v[108:111], v[96:99], v[64:79]
    ds_read_b64_tr_b16 v[126:127], v90 offset:7680
    v_add_u32 v87, 4294950912, v87
    v_add_u32 v88, 4294930432, v88
    v_add_u32 v89, 4294930432, v89
    v_add_u32 v90, 4294930432, v90
    s_waitcnt lgkmcnt(4)
    v_mfma_f32_32x32x16_bf16 v[32:47], v[116:119], v[112:115], v[32:47]
    s_waitcnt vmcnt(1)
    s_barrier
    ds_read_b128 v[96:99], v84
    ds_read_b64_tr_b16 v[100:101], v88 offset:0
    ds_read_b64_tr_b16 v[102:103], v88 offset:1536
    s_add_u32 m0, s76, 16384
    s_add_u32 s7, s68, s78
    buffer_load_dwordx4 v10, s[48:51], s7 offen lds
    s_waitcnt lgkmcnt(5)
    v_mfma_f32_32x32x16_bf16 v[48:63], v[120:123], v[112:115], v[48:63]
    ds_read_b64_tr_b16 v[104:105], v89 offset:0
    ds_read_b64_tr_b16 v[106:107], v89 offset:1536
    ds_read_b64_tr_b16 v[108:109], v90 offset:0
    s_add_u32 m0, s76, 24576
    s_add_u32 s7, s7, 73728
    buffer_load_dwordx4 v10, s[48:51], s7 offen lds
    s_add_u32 s78, s78, 128
    s_cmp_eq_u32 s78, 1152
    s_cselect_b32 s78, 0, s78
    s_waitcnt lgkmcnt(6)
    v_mfma_f32_32x32x16_bf16 v[64:79], v[124:127], v[112:115], v[64:79]
    ds_read_b64_tr_b16 v[110:111], v90 offset:1536
    v_add_u32 v84, 16384, v84
    s_add_u32 m0, s76, 57344
    s_add_u32 s70, s69, s79
    buffer_load_dwordx4 v11, s[52:55], s70 offen lds
    s_add_u32 s79, s79, 110592
    s_cmp_eq_u32 s79, 1990656
    s_cselect_b32 s79, 0, s79
    s_waitcnt lgkmcnt(4)
    v_mfma_f32_32x32x16_bf16 v[32:47], v[100:103], v[96:99], v[32:47]
    ds_read_b128 v[112:115], v85
    ds_read_b64_tr_b16 v[116:117], v88 offset:6144
    ds_read_b64_tr_b16 v[118:119], v88 offset:7680
    s_cmp_eq_u32 s15, 0
    s_cbranch_scc0 Q_sk11
    s_add_u32 m0, s77, 65536
    s_nop 0
    buffer_load_dwordx4 v12, s[52:55], s70 offen lds
Q_sk11:
    s_waitcnt lgkmcnt(5)
    v_mfma_f32_32x32x16_bf16 v[48:63], v[104:107], v[96:99], v[48:63]
    ds_read_b64_tr_b16 v[120:121], v89 offset:6144
    ds_read_b64_tr_b16 v[122:123], v89 offset:7680
    ds_read_b64_tr_b16 v[124:125], v90 offset:6144
    s_waitcnt lgkmcnt(6)
    v_mfma_f32_32x32x16_bf16 v[64:79], v[108:111], v[96:99], v[64:79]
    ds_read_b64_tr_b16 v[126:127], v90 offset:7680
    v_add_u32 v85, 16384, v85
    v_add_u32 v88, 12288, v88
    v_add_u32 v89, 12288, v89
    v_add_u32 v90, 12288, v90
    s_waitcnt lgkmcnt(4)
    v_mfma_f32_32x32x16_bf16 v[32:47], v[116:119], v[112:115], v[32:47]
    s_waitcnt vmcnt(3)
    s_barrier
    ds_read_b128 v[96:99], v86
    ds_read_b64_tr_b16 v[100:101], v88 offset:0
    ds_read_b64_tr_b16 v[102:103], v88 offset:1536
    s_add_u32 m0, s76, 69632
    s_add_u32 s70, s69, s79
    buffer_load_dwordx4 v11, s[52:55], s70 offen lds
    s_add_u32 s79, s79, 110592
    s_cmp_eq_u32 s79, 1990656
    s_cselect_b32 s79, 0, s79
    s_waitcnt lgkmcnt(5)
    v_mfma_f32_32x32x16_bf16 v[48:63], v[120:123], v[112:115], v[48:63]
    ds_read_b64_tr_b16 v[104:105], v89 offset:0
    ds_read_b64_tr_b16 v[106:107], v89 offset:1536
    ds_read_b64_tr_b16 v[108:109], v90 offset:0
    s_cmp_eq_u32 s15, 1
    s_cbranch_scc0 Q_sk12
    s_add_u32 m0, s77, 77824
    s_nop 0
    buffer_load_dwordx4 v12, s[52:55], s70 offen lds
Q_sk12:
    s_waitcnt lgkmcnt(6)
    v_mfma_f32_32x32x16_bf16 v[64:79], v[124:127], v[112:115], v[64:79]
    ds_read_b64_tr_b16 v[110:111], v90 offset:1536
    v_add_u32 v86, 16384, v86
    s_waitcnt lgkmcnt(4)
    v_mfma_f32_32x32x16_bf16 v[32:47], v[100:103], v[96:99], v[32:47]
    ds_read_b128 v[112:115], v87
    ds_read_b64_tr_b16 v[116:117], v88 offset:6144
    ds_read_b64_tr_b16 v[118:119], v88 offset:7680
    s_waitcnt lgkmcnt(5)
    v_mfma_f32_32x32x16_bf16 v[48:63], v[104:107], v[96:99], v[48:63]
    ds_read_b64_tr_b16 v[120:121], v89 offset:6144
    ds_read_b64_tr_b16 v[122:123], v89 offset:7680
    ds_read_b64_tr_b16 v[124:125], v90 offset:6144
    s_waitcnt lgkmcnt(6)
    v_mfma_f32_32x32x16_bf16 v[64:79], v[108:111], v[96:99], v[64:79]
    ds_read_b64_tr_b16 v[126:127], v90 offset:7680
    v_add_u32 v87, 16384, v87
    v_add_u32 v88, 12288, v88
    v_add_u32 v89, 12288, v89
    v_add_u32 v90, 12288, v90
    s_waitcnt lgkmcnt(4)
    v_mfma_f32_32x32x16_bf16 v[32:47], v[116:119], v[112:115], v[32:47]
    s_waitcnt vmcnt(1)
    s_barrier
    ds_read_b128 v[96:99], v84
    ds_read_b64_tr_b16 v[100:101], v88 offset:0
    ds_read_b64_tr_b16 v[102:103], v88 offset:1536
    s_add_u32 m0, s76, 0
    s_add_u32 s7, s68, s78
    buffer_load_dwordx4 v10, s[48:51], s7 offen lds
    s_waitcnt lgkmcnt(5)
    v_mfma_f32_32x32x16_bf16 v[48:63], v[120:123], v[112:115], v[48:63]
    ds_read_b64_tr_b16 v[104:105], v89 offset:0
    ds_read_b64_tr_b16 v[106:107], v89 offset:1536
    ds_read_b64_tr_b16 v[108:109], v90 offset:0
    s_add_u32 m0, s76, 8192
    s_add_u32 s7, s7, 73728
    buffer_load_dwordx4 v10, s[48:51], s7 offen lds
    s_add_u32 s78, s78, 128
    s_cmp_eq_u32 s78, 1152
    s_cselect_b32 s78, 0, s78
    s_waitcnt lgkmcnt(6)
    v_mfma_f32_32x32x16_bf16 v[64:79], v[124:127], v[112:115], v[64:79]
    ds_read_b64_tr_b16 v[110:111], v90 offset:1536
    v_add_u32 v84, 4294950912, v84
    s_add_u32 m0, s76, 32768
    s_add_u32 s70, s69, s79
    buffer_load_dwordx4 v11, s[52:55], s70 offen lds
    s_add_u32 s79, s79, 110592
    s_cmp_eq_u32 s79, 1990656
    s_cselect_b32 s79, 0, s79
    s_waitcnt lgkmcnt(4)
    v_mfma_f32_32x32x16_bf16 v[32:47], v[100:103], v[96:99], v[32:47]
    ds_read_b128 v[112:115], v85
    ds_read_b64_tr_b16 v[116:117], v88 offset:6144
    ds_read_b64_tr_b16 v[118:119], v88 offset:7680
    s_cmp_eq_u32 s15, 0
    s_cbranch_scc0 Q_sk13
    s_add_u32 m0, s77, 40960
    s_nop 0
    buffer_load_dwordx4 v12, s[52:55], s70 offen lds
Q_sk13:
    s_waitcnt lgkmcnt(5)
    v_mfma_f32_32x32x16_bf16 v[48:63], v[104:107], v[96:99], v[48:63]
    ds_read_b64_tr_b16 v[120:121], v89 offset:6144
    ds_read_b64_tr_b16 v[122:123], v89 offset:7680
    ds_read_b64_tr_b16 v[124:125], v90 offset:6144
    s_waitcnt lgkmcnt(6)
    v_mfma_f32_32x32x16_bf16 v[64:79], v[108:111], v[96:99], v[64:79]
    ds_read_b64_tr_b16 v[126:127], v90 offset:7680
    v_add_u32 v85, 4294950912, v85
    v_add_u32 v88, 12288, v88
    v_add_u32 v89, 12288, v89
    v_add_u32 v90, 12288, v90
    s_waitcnt lgkmcnt(4)
    v_mfma_f32_32x32x16_bf16 v[32:47], v[116:119], v[112:115], v[32:47]
    s_waitcnt vmcnt(3)
    s_barrier
    ds_read_b128 v[96:99], v86
    ds_read_b64_tr_b16 v[100:101], v88 offset:0
    ds_read_b64_tr_b16 v[102:103], v88 offset:1536
    s_add_u32 m0, s76, 45056
    s_add_u32 s70, s69, s79
    buffer_load_dwordx4 v11, s[52:55], s70 offen lds
    s_add_u32 s79, s79, 110592
    s_cmp_eq_u32 s79, 1990656
    s_cselect_b32 s79, 0, s79
    s_waitcnt lgkmcnt(5)
    v_mfma_f32_32x32x16_bf16 v[48:63], v[120:123], v[112:115], v[48:63]
    ds_read_b64_tr_b16 v[104:105], v89 offset:0
    ds_read_b64_tr_b16 v[106:107], v89 offset:1536
    ds_read_b64_tr_b16 v[108:109], v90 offset:0
    s_cmp_eq_u32 s15, 1
    s_cbranch_scc0 Q_sk14
    s_add_u32 m0, s77, 53248
    s_nop 0
    buffer_load_dwordx4 v12, s[52:55], s70 offen lds
Q_sk14:
    s_waitcnt lgkmcnt(6)
    v_mfma_f32_32x32x16_bf16 v[64:79], v[124:127], v[112:115], v[64:79]
    ds_read_b64_tr_b16 v[110:111], v90 offset:1536
    v_add_u32 v86, 4294950912, v86
    s_waitcnt lgkmcnt(4)
    v_mfma_f32_32x32x16_bf16 v[32:47], v[100:103], v[96:99], v[32:47]
    ds_read_b128 v[112:115], v87
    ds_read_b64_tr_b16 v[116:117], v88 offset:6144
    ds_read_b64_tr_b16 v[118:119], v88 offset:7680
    s_waitcnt lgkmcnt(5)
    v_mfma_f32_32x32x16_bf16 v[48:63], v[104:107], v[96:99], v[48:63]
    ds_read_b64_tr_b16 v[120:121], v89 offset:6144
    ds_read_b64_tr_b16 v[122:123], v89 offset:7680
    ds_read_b64_tr_b16 v[124:125], v90 offset:6144
    s_waitcnt lgkmcnt(6)
    v_mfma_f32_32x32x16_bf16 v[64:79], v[108:111], v[96:99], v[64:79]
    ds_read_b64_tr_b16 v[126:127], v90 offset:7680
    v_add_u32 v87, 4294950912, v87
    v_add_u32 v88, 4294930432, v88
    v_add_u32 v89, 4294930432, v89
    v_add_u32 v90, 4294930432, v90
    s_waitcnt lgkmcnt(4)
    v_mfma_f32_32x32x16_bf16 v[32:47], v[116:119], v[112:115], v[32:47]
    s_waitcnt vmcnt(1)
    s_barrier
    ds_read_b128 v[96:99], v84
    ds_read_b64_tr_b16 v[100:101], v88 offset:0
    ds_read_b64_tr_b16 v[102:103], v88 offset:1536
    s_add_u32 m0, s76, 16384
    s_add_u32 s7, s68, s78
    buffer_load_dwordx4 v10, s[48:51], s7 offen lds
    s_waitcnt lgkmcnt(5)
    v_mfma_f32_32x32x16_bf16 v[48:63], v[120:123], v[112:115], v[48:63]
    ds_read_b64_tr_b16 v[104:105], v89 offset:0
    ds_read_b64_tr_b16 v[106:107], v89 offset:1536
    ds_read_b64_tr_b16 v[108:109], v90 offset:0
    s_add_u32 m0, s76, 24576
    s_add_u32 s7, s7, 73728
    buffer_load_dwordx4 v10, s[48:51], s7 offen lds
    s_add_u32 s78, s78, 128
    s_cmp_eq_u32 s78, 1152
    s_cselect_b32 s78, 0, s78
    s_waitcnt lgkmcnt(6)
    v_mfma_f32_32x32x16_bf16 v[64:79], v[124:127], v[112:115], v[64:79]
    ds_read_b64_tr_b16 v[110:111], v90 offset:1536
    v_add_u32 v84, 16384, v84
    s_add_u32 m0, s76, 57344
    s_add_u32 s70, s69, s79
    buffer_load_dwordx4 v11, s[52:55], s70 offen lds
    s_add_u32 s79, s79, 110592
    s_cmp_eq_u32 s79, 1990656
    s_cselect_b32 s79, 0, s79
    s_waitcnt lgkmcnt(4)
    v_mfma_f32_32x32x16_bf16 v[32:47], v[100:103], v[96:99], v[32:47]
    ds_read_b128 v[112:115], v85
    ds_read_b64_tr_b16 v[116:117], v88 offset:6144
    ds_read_b64_tr_b16 v[118:119], v88 offset:7680
    s_cmp_eq_u32 s15, 0
    s_cbranch_scc0 Q_sk15
    s_add_u32 m0, s77, 65536
    s_nop 0
    buffer_load_dwordx4 v12, s[52:55], s70 offen lds
Q_sk15:
    s_waitcnt lgkmcnt(5)
    v_mfma_f32_32x32x16_bf16 v[48:63], v[104:107], v[96:99], v[48:63]
    ds_read_b64_tr_b16 v[120:121], v89 offset:6144
    ds_read_b64_tr_b16 v[122:123], v89 offset:7680
    ds_read_b64_tr_b16 v[124:125], v90 offset:6144
    s_waitcnt lgkmcnt(6)
    v_mfma_f32_32x32x16_bf16 v[64:79], v[108:111], v[96:99], v[64:79]
    ds_read_b64_tr_b16 v[126:127], v90 offset:7680
    v_add_u32 v85, 16384, v85
    v_add_u32 v88, 12288, v88
    v_add_u32 v89, 12288, v89
    v_add_u32 v90, 12288, v90
    s_waitcnt lgkmcnt(4)
    v_mfma_f32_32x32x16_bf16 v[32:47], v[116:119], v[112:115], v[32:47]
    s_waitcnt vmcnt(3)
    s_barrier
    ds_read_b128 v[96:99], v86
    ds_read_b64_tr_b16 v[100:101], v88 offset:0
    ds_read_b64_tr_b16 v[102:103], v88 offset:1536
    s_add_u32 m0, s76, 69632
    s_add_u32 s70, s69, s79
    buffer_load_dwordx4 v11, s[52:55], s70 offen lds
    s_add_u32 s79, s79, 110592
    s_cmp_eq_u32 s79, 1990656
    s_cselect_b32 s79, 0, s79
    s_waitcnt lgkmcnt(5)
    v_mfma_f32_32x32x16_bf16 v[48:63], v[120:123], v[112:115], v[48:63]
    ds_read_b64_tr_b16 v[104:105], v89 offset:0
    ds_read_b64_tr_b16 v[106:107], v89 offset:1536
    ds_read_b64_tr_b16 v[108:109], v90 offset:0
    s_cmp_eq_u32 s15, 1
    s_cbranch_scc0 Q_sk16
    s_add_u32 m0, s77, 77824
    s_nop 0
    buffer_load_dwordx4 v12, s[52:55], s70 offen lds
Q_sk16:
    s_waitcnt lgkmcnt(6)
    v_mfma_f32_32x32x16_bf16 v[64:79], v[124:127], v[112:115], v[64:79]
    ds_read_b64_tr_b16 v[110:111], v90 offset:1536
    v_add_u32 v86, 16384, v86
    s_waitcnt lgkmcnt(4)
    v_mfma_f32_32x32x16_bf16 v[32:47], v[100:103], v[96:99], v[32:47]
    ds_read_b128 v[112:115], v87
    ds_read_b64_tr_b16 v[116:117], v88 offset:6144
    ds_read_b64_tr_b16 v[118:119], v88 offset:7680
    s_waitcnt lgkmcnt(5)
    v_mfma_f32_32x32x16_bf16 v[48:63], v[104:107], v[96:99], v[48:63]
    ds_read_b64_tr_b16 v[120:121], v89 offset:6144
    ds_read_b64_tr_b16 v[122:123], v89 offset:7680
    ds_read_b64_tr_b16 v[124:125], v90 offset:6144
    s_waitcnt lgkmcnt(6)
    v_mfma_f32_32x32x16_bf16 v[64:79], v[108:111], v[96:99], v[64:79]
    ds_read_b64_tr_b16 v[126:127], v90 offset:7680
    v_add_u32 v87, 16384, v87
    v_add_u32 v88, 12288, v88
    v_add_u32 v89, 12288, v89
    v_add_u32 v90, 12288, v90
    s_waitcnt lgkmcnt(4)
    v_mfma_f32_32x32x16_bf16 v[32:47], v[116:119], v[112:115], v[32:47]
    s_waitcnt vmcnt(1)
    s_barrier
    ds_read_b128 v[96:99], v84
    ds_read_b64_tr_b16 v[100:101], v88 offset:0
    ds_read_b64_tr_b16 v[102:103], v88 offset:1536
    s_add_u32 m0, s76, 0
    s_add_u32 s7, s68, s78
    buffer_load_dwordx4 v10, s[48:51], s7 offen lds
    s_waitcnt lgkmcnt(5)
    v_mfma_f32_32x32x16_bf16 v[48:63], v[120:123], v[112:115], v[48:63]
    ds_read_b64_tr_b16 v[104:105], v89 offset:0
    ds_read_b64_tr_b16 v[106:107], v89 offset:1536
    ds_read_b64_tr_b16 v[108:109], v90 offset:0
    s_add_u32 m0, s76, 8192
    s_add_u32 s7, s7, 73728
    buffer_load_dwordx4 v10, s[48:51], s7 offen lds
    s_add_u32 s78, s78, 128
    s_cmp_eq_u32 s78, 1152
    s_cselect_b32 s78, 0, s78
    s_waitcnt lgkmcnt(6)
    v_mfma_f32_32x32x16_bf16 v[64:79], v[124:127], v[112:115], v[64:79]
    ds_read_b64_tr_b16 v[110:111], v90 offset:1536
    v_add_u32 v84, 4294950912, v84
    s_add_u32 m0, s76, 32768
    s_add_u32 s70, s69, s79
    buffer_load_dwordx4 v11, s[52:55], s70 offen lds
    s_add_u32 s79, s79, 110592
    s_cmp_eq_u32 s79, 1990656
    s_cselect_b32 s79, 0, s79
    s_waitcnt lgkmcnt(4)
    v_mfma_f32_32x32x16_bf16 v[32:47], v[100:103], v[96:99], v[32:47]
    ds_read_b128 v[112:115], v85
    ds_read_b64_tr_b16 v[116:117], v88 offset:6144
    ds_read_b64_tr_b16 v[118:119], v88 offset:7680
    s_cmp_eq_u32 s15, 0
    s_cbranch_scc0 Q_sk17
    s_add_u32 m0, s77, 40960
    s_nop 0
    buffer_load_dwordx4 v12, s[52:55], s70 offen lds
Q_sk17:
    s_waitcnt lgkmcnt(5)
    v_mfma_f32_32x32x16_bf16 v[48:63], v[104:107], v[96:99], v[48:63]
    ds_read_b64_tr_b16 v[120:121], v89 offset:6144
    ds_read_b64_tr_b16 v[122:123], v89 offset:7680
    ds_read_b64_tr_b16 v[124:125], v90 offset:6144
    s_waitcnt lgkmcnt(6)
    v_mfma_f32_32x32x16_bf16 v[64:79], v[108:111], v[96:99], v[64:79]
    ds_read_b64_tr_b16 v[126:127], v90 offset:7680
    v_add_u32 v85, 4294950912, v85
    v_add_u32 v88, 12288, v88
    v_add_u32 v89, 12288, v89
    v_add_u32 v90, 12288, v90
    s_waitcnt lgkmcnt(4)
    v_mfma_f32_32x32x16_bf16 v[32:47], v[116:119], v[112:115], v[32:47]
    s_waitcnt vmcnt(3)
    s_barrier
    ds_read_b128 v[96:99], v86
    ds_read_b64_tr_b16 v[100:101], v88 offset:0
    ds_read_b64_tr_b16 v[102:103], v88 offset:1536
    s_add_u32 m0, s76, 45056
    s_add_u32 s70, s69, s79
    buffer_load_dwordx4 v11, s[52:55], s70 offen lds
    s_add_u32 s79, s79, 110592
    s_cmp_eq_u32 s79, 1990656
    s_cselect_b32 s79, 0, s79
    s_waitcnt lgkmcnt(5)
    v_mfma_f32_32x32x16_bf16 v[48:63], v[120:123], v[112:115], v[48:63]
    ds_read_b64_tr_b16 v[104:105], v89 offset:0
    ds_read_b64_tr_b16 v[106:107], v89 offset:1536
    ds_read_b64_tr_b16 v[108:109], v90 offset:0
    s_cmp_eq_u32 s15, 1
    s_cbranch_scc0 Q_sk18
    s_add_u32 m0, s77, 53248
    s_nop 0
    buffer_load_dwordx4 v12, s[52:55], s70 offen lds
Q_sk18:
    s_waitcnt lgkmcnt(6)
    v_mfma_f32_32x32x16_bf16 v[64:79], v[124:127], v[112:115], v[64:79]
    ds_read_b64_tr_b16 v[110:111], v90 offset:1536
    v_add_u32 v86, 4294950912, v86
    s_waitcnt lgkmcnt(4)
    v_mfma_f32_32x32x16_bf16 v[32:47], v[100:103], v[96:99], v[32:47]
    ds_read_b128 v[112:115], v87
    ds_read_b64_tr_b16 v[116:117], v88 offset:6144
    ds_read_b64_tr_b16 v[118:119], v88 offset:7680
    s_waitcnt lgkmcnt(5)
    v_mfma_f32_32x32x16_bf16 v[48:63], v[104:107], v[96:99], v[48:63]
    ds_read_b64_tr_b16 v[120:121], v89 offset:6144
    ds_read_b64_tr_b16 v[122:123], v89 offset:7680
    ds_read_b64_tr_b16 v[124:125], v90 offset:6144
    s_waitcnt lgkmcnt(6)
    v_mfma_f32_32x32x16_bf16 v[64:79], v[108:111], v[96:99], v[64:79]
    ds_read_b64_tr_b16 v[126:127], v90 offset:7680
    v_add_u32 v87, 4294950912, v87
    v_add_u32 v88, 4294930432, v88
    v_add_u32 v89, 4294930432, v89
    v_add_u32 v90, 4294930432, v90
    s_waitcnt lgkmcnt(4)
    v_mfma_f32_32x32x16_bf16 v[32:47], v[116:119], v[112:115], v[32:47]
    s_waitcnt vmcnt(1)
    s_barrier
    ds_read_b128 v[96:99], v84
    ds_read_b64_tr_b16 v[100:101], v88 offset:0
    ds_read_b64_tr_b16 v[102:103], v88 offset:1536
    s_waitcnt lgkmcnt(5)
    v_mfma_f32_32x32x16_bf16 v[48:63], v[120:123], v[112:115], v[48:63]
    ds_read_b64_tr_b16 v[104:105], v89 offset:0
    ds_read_b64_tr_b16 v[106:107], v89 offset:1536
    ds_read_b64_tr_b16 v[108:109], v90 offset:0
    s_waitcnt lgkmcnt(6)
    v_mfma_f32_32x32x16_bf16 v[64:79], v[124:127], v[112:115], v[64:79]
    ds_read_b64_tr_b16 v[110:111], v90 offset:1536
    s_waitcnt lgkmcnt(4)
    v_mfma_f32_32x32x16_bf16 v[32:47], v[100:103], v[96:99], v[32:47]
    ds_read_b128 v[112:115], v85
    ds_read_b64_tr_b16 v[116:117], v88 offset:6144
    ds_read_b64_tr_b16 v[118:119], v88 offset:7680
    s_waitcnt lgkmcnt(5)
    v_mfma_f32_32x32x16_bf16 v[48:63], v[104:107], v[96:99], v[48:63]
    ds_read_b64_tr_b16 v[120:121], v89 offset:6144
    ds_read_b64_tr_b16 v[122:123], v89 offset:7680
    ds_read_b64_tr_b16 v[124:125], v90 offset:6144
    s_waitcnt lgkmcnt(6)
    v_mfma_f32_32x32x16_bf16 v[64:79], v[108:111], v[96:99], v[64:79]
    ds_read_b64_tr_b16 v[126:127], v90 offset:7680
    v_add_u32 v88, 12288, v88
    v_add_u32 v89, 12288, v89
    v_add_u32 v90, 12288, v90
    s_waitcnt lgkmcnt(4)
    v_mfma_f32_32x32x16_bf16 v[32:47], v[116:119], v[112:115], v[32:47]
    s_waitcnt vmcnt(0)
    s_barrier
    ds_read_b128 v[96:99], v86
    ds_read_b64_tr_b16 v[100:101], v88 offset:0
    ds_read_b64_tr_b16 v[102:103], v88 offset:1536
    s_waitcnt lgkmcnt(5)
    v_mfma_f32_32x32x16_bf16 v[48:63], v[120:123], v[112:115], v[48:63]
    ds_read_b64_tr_b16 v[104:105], v89 offset:0
    ds_read_b64_tr_b16 v[106:107], v89 offset:1536
    ds_read_b64_tr_b16 v[108:109], v90 offset:0
    s_waitcnt lgkmcnt(6)
    v_mfma_f32_32x32x16_bf16 v[64:79], v[124:127], v[112:115], v[64:79]
    ds_read_b64_tr_b16 v[110:111], v90 offset:1536
    s_waitcnt lgkmcnt(4)
    v_mfma_f32_32x32x16_bf16 v[32:47], v[100:103], v[96:99], v[32:47]
    ds_read_b128 v[112:115], v87
    ds_read_b64_tr_b16 v[116:117], v88 offset:6144
    ds_read_b64_tr_b16 v[118:119], v88 offset:7680
    s_waitcnt lgkmcnt(5)
    v_mfma_f32_32x32x16_bf16 v[48:63], v[104:107], v[96:99], v[48:63]
    ds_read_b64_tr_b16 v[120:121], v89 offset:6144
    ds_read_b64_tr_b16 v[122:123], v89 offset:7680
    ds_read_b64_tr_b16 v[124:125], v90 offset:6144
    s_waitcnt lgkmcnt(6)
    v_mfma_f32_32x32x16_bf16 v[64:79], v[108:111], v[96:99], v[64:79]
    ds_read_b64_tr_b16 v[126:127], v90 offset:7680
    s_waitcnt lgkmcnt(4)
    v_mfma_f32_32x32x16_bf16 v[32:47], v[116:119], v[112:115], v[32:47]
    s_waitcnt lgkmcnt(2)
    v_mfma_f32_32x32x16_bf16 v[48:63], v[120:123], v[112:115], v[48:63]
    s_waitcnt lgkmcnt(0)
    v_mfma_f32_32x32x16_bf16 v[64:79], v[124:127], v[112:115], v[64:79]
    s_nop 7
    s_cmp_eq_u32 s46, 1
    s_cbranch_scc1 Q_e1
    s_cmp_eq_u32 s46, 2
    s_cbranch_scc1 Q_e2
    s_cmp_eq_u32 s46, 3
    s_cbranch_scc1 Q_e3
    s_cmp_eq_u32 s46, 4
    s_cbranch_scc1 Q_e4
    s_cmp_eq_u32 s46, 5
    s_cbranch_scc1 Q_e5
    s_mov_b32 s7, 1400832
    v_mad_u32_u24 v6, v2, s7, v3
    s_mov_b32 s12, 0
    s_mov_b32 s13, 4096
    v_cvt_pk_bf16_f32 v64, v64, v65
    v_cvt_pk_bf16_f32 v65, v66, v67
    v_cvt_pk_bf16_f32 v66, v68, v69
    v_cvt_pk_bf16_f32 v67, v70, v71
    buffer_store_dwordx4 v[64:67], v6, s[60:63], s12 offen sc1
    v_cvt_pk_bf16_f32 v68, v72, v73
    v_cvt_pk_bf16_f32 v69, v74, v75
    v_cvt_pk_bf16_f32 v70, v76, v77
    v_cvt_pk_bf16_f32 v71, v78, v79
    buffer_store_dwordx4 v[68:71], v6, s[60:63], s13 offen sc1
    s_cmp_lt_u32 s5, 5
    s_waitcnt lgkmcnt(0)
    s_barrier
    s_cbranch_scc0 Q_x00
    ds_read_b128 v[104:107], v16
    s_waitcnt lgkmcnt(0)
    buffer_store_dwordx4 v[104:107], v17, s[60:63], s75 offen sc1
Q_x00:
    s_mov_b32 s12, 155648
    s_mov_b32 s13, 159744
    v_cvt_pk_bf16_f32 v32, v32, v33
    v_cvt_pk_bf16_f32 v33, v34, v35
    v_cvt_pk_bf16_f32 v34, v36, v37
    v_cvt_pk_bf16_f32 v35, v38, v39
    buffer_store_dwordx4 v[32:35], v5, s[60:63], s12 offen sc1
    v_cvt_pk_bf16_f32 v36, v40, v41
    v_cvt_pk_bf16_f32 v37, v42, v43
    v_cvt_pk_bf16_f32 v38, v44, v45
    v_cvt_pk_bf16_f32 v39, v46, v47
    buffer_store_dwordx4 v[36:39], v5, s[60:63], s13 offen sc1
    s_mov_b32 s12, 466944
    s_mov_b32 s13, 471040
    v_cvt_pk_bf16_f32 v48, v48, v49
    v_cvt_pk_bf16_f32 v49, v50, v51
    v_cvt_pk_bf16_f32 v50, v52, v53
    v_cvt_pk_bf16_f32 v51, v54, v55
    buffer_store_dwordx4 v[48:51], v5, s[60:63], s12 offen sc1
    v_cvt_pk_bf16_f32 v52, v56, v57
    v_cvt_pk_bf16_f32 v53, v58, v59
    v_cvt_pk_bf16_f32 v54, v60, v61
    v_cvt_pk_bf16_f32 v55, v62, v63
    buffer_store_dwordx4 v[52:55], v5, s[60:63], s13 offen sc1
    s_branch Q_fin
Q_e1:
    v_cvt_pk_bf16_f32 v96, v64, v65
    v_cvt_pk_bf16_f32 v97, v66, v67
    s_mov_b32 s7, 8
    v_mad_u32_u24 v8, v2, s7, v3
    s_mov_b32 s12, 1556480
    buffer_store_dwordx2 v[96:97], v8, s[60:63], s12 offen sc1
    v_cvt_pk_bf16_f32 v98, v68, v69
    v_cvt_pk_bf16_f32 v99, v70, v71
    s_mov_b64 exec, 0xffffffff
    s_mov_b32 s12, 1560576
    buffer_store_dwordx2 v[98:99], v3, s[60:63], s12 offen sc1
    s_mov_b64 exec, -1
    s_mov_b64 exec, s[8:9]
    ds_write_b32 v4, v98 offset:0
    ds_write_b32 v4, v99 offset:512
    s_mov_b64 exec, -1
    v_cvt_pk_bf16_f32 v100, v72, v73
    v_cvt_pk_bf16_f32 v101, v74, v75
    s_mov_b32 s7, 1024
    v_mad_u32_u24 v8, v2, s7, v4
    ds_write_b32 v8, v100 offset:1024
    ds_write_b32 v8, v101 offset:1536
    v_cvt_pk_bf16_f32 v102, v76, v77
    v_cvt_pk_bf16_f32 v103, v78, v79
    s_mov_b32 s7, 1024
    v_mad_u32_u24 v8, v2, s7, v4
    ds_write_b32 v8, v102 offset:3072
    ds_write_b32 v8, v103 offset:3584
    s_cmp_lt_u32 s5, 5
    s_waitcnt lgkmcnt(0)
    s_barrier
    s_cbranch_scc0 Q_x01
    ds_read_b128 v[104:107], v16
    s_waitcnt lgkmcnt(0)
    buffer_store_dwordx4 v[104:107], v17, s[60:63], s75 offen sc1
Q_x01:
    s_mov_b32 s12, 778240
    s_mov_b32 s13, 782336
    v_cvt_pk_bf16_f32 v32, v32, v33
    v_cvt_pk_bf16_f32 v33, v34, v35
    v_cvt_pk_bf16_f32 v34, v36, v37
    v_cvt_pk_bf16_f32 v35, v38, v39
    buffer_store_dwordx4 v[32:35], v5, s[60:63], s12 offen sc1
    v_cvt_pk_bf16_f32 v36, v40, v41
    v_cvt_pk_bf16_f32 v37, v42, v43
    v_cvt_pk_bf16_f32 v38, v44, v45
    v_cvt_pk_bf16_f32 v39, v46, v47
    buffer_store_dwordx4 v[36:39], v5, s[60:63], s13 offen sc1
    s_mov_b32 s12, 1089536
    s_mov_b32 s13, 1093632
    v_cvt_pk_bf16_f32 v48, v48, v49
    v_cvt_pk_bf16_f32 v49, v50, v51
    v_cvt_pk_bf16_f32 v50, v52, v53
    v_cvt_pk_bf16_f32 v51, v54, v55
    buffer_store_dwordx4 v[48:51], v5, s[60:63], s12 offen sc1
    v_cvt_pk_bf16_f32 v52, v56, v57
    v_cvt_pk_bf16_f32 v53, v58, v59
    v_cvt_pk_bf16_f32 v54, v60, v61
    v_cvt_pk_bf16_f32 v55, v62, v63
    buffer_store_dwordx4 v[52:55], v5, s[60:63], s13 offen sc1
    s_branch Q_fin
Q_e2:
    s_mov_b32 s12, 2334720
    s_mov_b32 s13, 2338816
    v_cvt_pk_bf16_f32 v64, v64, v65
    v_cvt_pk_bf16_f32 v65, v66, v67
    v_cvt_pk_bf16_f32 v66, v68, v69
    v_cvt_pk_bf16_f32 v67, v70, v71
    buffer_store_dwordx4 v[64:67], v5, s[60:63], s12 offen sc1
    v_cvt_pk_bf16_f32 v68, v72, v73
    v_cvt_pk_bf16_f32 v69, v74, v75
    v_cvt_pk_bf16_f32 v70, v76, v77
    v_cvt_pk_bf16_f32 v71, v78, v79
    buffer_store_dwordx4 v[68:71], v5, s[60:63], s13 offen sc1
    s_cmp_lt_u32 s5, 6
    s_waitcnt lgkmcnt(0)
    s_barrier
    s_cbranch_scc0 Q_x10
    ds_read_b128 v[104:107], v16
    s_waitcnt lgkmcnt(0)
    buffer_store_dwordx4 v[104:107], v17, s[60:63], s75 offen sc1
Q_x10:
    s_mov_b32 s12, 1712128
    s_mov_b32 s13, 1716224
    v_cvt_pk_bf16_f32 v32, v32, v33
    v_cvt_pk_bf16_f32 v33, v34, v35
    v_cvt_pk_bf16_f32 v34, v36, v37
    v_cvt_pk_bf16_f32 v35, v38, v39
    buffer_store_dwordx4 v[32:35], v5, s[60:63], s12 offen sc1
    v_cvt_pk_bf16_f32 v36, v40, v41
    v_cvt_pk_bf16_f32 v37, v42, v43
    v_cvt_pk_bf16_f32 v38, v44, v45
    v_cvt_pk_bf16_f32 v39, v46, v47
    buffer_store_dwordx4 v[36:39], v5, s[60:63], s13 offen sc1
    s_mov_b32 s12, 2023424
    s_mov_b32 s13, 2027520
    v_cvt_pk_bf16_f32 v48, v48, v49
    v_cvt_pk_bf16_f32 v49, v50, v51
    v_cvt_pk_bf16_f32 v50, v52, v53
    v_cvt_pk_bf16_f32 v51, v54, v55
    buffer_store_dwordx4 v[48:51], v5, s[60:63], s12 offen sc1
    v_cvt_pk_bf16_f32 v52, v56, v57
    v_cvt_pk_bf16_f32 v53, v58, v59
    v_cvt_pk_bf16_f32 v54, v60, v61
    v_cvt_pk_bf16_f32 v55, v62, v63
    buffer_store_dwordx4 v[52:55], v5, s[60:63], s13 offen sc1
    s_branch Q_fin
Q_e3:
    v_cvt_pk_bf16_f32 v96, v64, v65
    v_cvt_pk_bf16_f32 v97, v66, v67
    s_mov_b32 s7, 1708024
    v_mad_u32_u24 v8, v2, s7, v3
    s_mov_b32 s12, 1560584
    buffer_store_dwordx2 v[96:97], v8, s[60:63], s12 offen sc1
    v_cvt_pk_bf16_f32 v98, v68, v69
    v_cvt_pk_bf16_f32 v99, v70, v71
    s_mov_b32 s7, 1024
    v_mad_u32_u24 v8, v2, s7, v4
    ds_write_b32 v8, v98 offset:0
    ds_write_b32 v8, v99 offset:512
    v_cvt_pk_bf16_f32 v100, v72, v73
    v_cvt_pk_bf16_f32 v101, v74, v75
    s_mov_b32 s7, 1024
    v_mad_u32_u24 v8, v2, s7, v4
    ds_write_b32 v8, v100 offset:2048
    ds_write_b32 v8, v101 offset:2560
    v_cvt_pk_bf16_f32 v102, v76, v77
    v_cvt_pk_bf16_f32 v103, v78, v79
    s_mov_b32 s7, 1024
    v_mad_u32_u24 v8, v2, s7, v4
    ds_write_b32 v8, v102 offset:4096
    ds_write_b32 v8, v103 offset:4608
    s_cmp_lt_u32 s5, 6
    s_waitcnt lgkmcnt(0)
    s_barrier
    s_cbranch_scc0 Q_x11
    ds_read_b128 v[104:107], v16
    s_waitcnt lgkmcnt(0)
    buffer_store_dwordx4 v[104:107], v17, s[60:63], s75 offen sc1
Q_x11:
    s_mov_b32 s12, 2646016
    s_mov_b32 s13, 2650112
    v_cvt_pk_bf16_f32 v32, v32, v33
    v_cvt_pk_bf16_f32 v33, v34, v35
    v_cvt_pk_bf16_f32 v34, v36, v37
    v_cvt_pk_bf16_f32 v35, v38, v39
    buffer_store_dwordx4 v[32:35], v5, s[60:63], s12 offen sc1
    v_cvt_pk_bf16_f32 v36, v40, v41
    v_cvt_pk_bf16_f32 v37, v42, v43
    v_cvt_pk_bf16_f32 v38, v44, v45
    v_cvt_pk_bf16_f32 v39, v46, v47
    buffer_store_dwordx4 v[36:39], v5, s[60:63], s13 offen sc1
    s_mov_b32 s12, 2957312
    s_mov_b32 s13, 2961408
    v_cvt_pk_bf16_f32 v48, v48, v49
    v_cvt_pk_bf16_f32 v49, v50, v51
    v_cvt_pk_bf16_f32 v50, v52, v53
    v_cvt_pk_bf16_f32 v51, v54, v55
    buffer_store_dwordx4 v[48:51], v5, s[60:63], s12 offen sc1
    v_cvt_pk_bf16_f32 v52, v56, v57
    v_cvt_pk_bf16_f32 v53, v58, v59
    v_cvt_pk_bf16_f32 v54, v60, v61
    v_cvt_pk_bf16_f32 v55, v62, v63
    buffer_store_dwordx4 v[52:55], v5, s[60:63], s13 offen sc1
    s_branch Q_fin
Q_e4:
    s_mov_b32 s7, 1400832
    v_mad_u32_u24 v6, v2, s7, v3
    s_mov_b32 s12, 3424256
    s_mov_b32 s13, 3428352
    v_cvt_pk_bf16_f32 v64, v64, v65
    v_cvt_pk_bf16_f32 v65, v66, v67
    v_cvt_pk_bf16_f32 v66, v68, v69
    v_cvt_pk_bf16_f32 v67, v70, v71
    buffer_store_dwordx4 v[64:67], v6, s[60:63], s12 offen sc1
    v_cvt_pk_bf16_f32 v68, v72, v73
    v_cvt_pk_bf16_f32 v69, v74, v75
    v_cvt_pk_bf16_f32 v70, v76, v77
    v_cvt_pk_bf16_f32 v71, v78, v79
    buffer_store_dwordx4 v[68:71], v6, s[60:63], s13 offen sc1
    s_cmp_lt_u32 s5, 5
    s_waitcnt lgkmcnt(0)
    s_barrier
    s_cbranch_scc0 Q_x20
    ds_read_b128 v[104:107], v16
    s_waitcnt lgkmcnt(0)
    buffer_store_dwordx4 v[104:107], v17, s[60:63], s75 offen sc1
Q_x20:
    s_mov_b32 s12, 3579904
    s_mov_b32 s13, 3584000
    v_cvt_pk_bf16_f32 v32, v32, v33
    v_cvt_pk_bf16_f32 v33, v34, v35
    v_cvt_pk_bf16_f32 v34, v36, v37
    v_cvt_pk_bf16_f32 v35, v38, v39
    buffer_store_dwordx4 v[32:35], v5, s[60:63], s12 offen sc1
    v_cvt_pk_bf16_f32 v36, v40, v41
    v_cvt_pk_bf16_f32 v37, v42, v43
    v_cvt_pk_bf16_f32 v38, v44, v45
    v_cvt_pk_bf16_f32 v39, v46, v47
    buffer_store_dwordx4 v[36:39], v5, s[60:63], s13 offen sc1
    s_mov_b32 s12, 3891200
    s_mov_b32 s13, 3895296
    v_cvt_pk_bf16_f32 v48, v48, v49
    v_cvt_pk_bf16_f32 v49, v50, v51
    v_cvt_pk_bf16_f32 v50, v52, v53
    v_cvt_pk_bf16_f32 v51, v54, v55
    buffer_store_dwordx4 v[48:51], v5, s[60:63], s12 offen sc1
    v_cvt_pk_bf16_f32 v52, v56, v57
    v_cvt_pk_bf16_f32 v53, v58, v59
    v_cvt_pk_bf16_f32 v54, v60, v61
    v_cvt_pk_bf16_f32 v55, v62, v63
    buffer_store_dwordx4 v[52:55], v5, s[60:63], s13 offen sc1
    s_branch Q_fin
Q_e5:
    v_cvt_pk_bf16_f32 v96, v64, v65
    v_cvt_pk_bf16_f32 v97, v66, v67
    s_mov_b32 s7, 8
    v_mad_u32_u24 v8, v2, s7, v3
    s_mov_b32 s12, 3272704
    buffer_store_dwordx2 v[96:97], v8, s[60:63], s12 offen sc1
    v_cvt_pk_bf16_f32 v98, v68, v69
    v_cvt_pk_bf16_f32 v99, v70, v71
    s_mov_b64 exec, 0xffffffff
    s_mov_b32 s12, 3268616
    buffer_store_dwordx2 v[98:99], v3, s[60:63], s12 offen sc1
    s_mov_b64 exec, -1
    s_mov_b64 exec, s[8:9]
    ds_write_b32 v4, v98 offset:0
    ds_write_b32 v4, v99 offset:512
    s_mov_b64 exec, -1
    v_cvt_pk_bf16_f32 v100, v72, v73
    v_cvt_pk_bf16_f32 v101, v74, v75
    s_mov_b32 s7, 1024
    v_mad_u32_u24 v8, v2, s7, v4
    ds_write_b32 v8, v100 offset:1024
    ds_write_b32 v8, v101 offset:1536
    v_cvt_pk_bf16_f32 v102, v76, v77
    v_cvt_pk_bf16_f32 v103, v78, v79
    s_mov_b32 s7, 1024
    v_mad_u32_u24 v8, v2, s7, v4
    ds_write_b32 v8, v102 offset:3072
    ds_write_b32 v8, v103 offset:3584
    s_cmp_lt_u32 s5, 5
    s_waitcnt lgkmcnt(0)
    s_barrier
    s_cbranch_scc0 Q_x21
    ds_read_b128 v[104:107], v16
    s_waitcnt lgkmcnt(0)
    buffer_store_dwordx4 v[104:107], v17, s[60:63], s75 offen sc1
Q_x21:
    s_mov_b32 s12, 4202496
    s_mov_b32 s13, 4206592
    v_cvt_pk_bf16_f32 v32, v32, v33
    v_cvt_pk_bf16_f32 v33, v34, v35
    v_cvt_pk_bf16_f32 v34, v36, v37
    v_cvt_pk_bf16_f32 v35, v38, v39
    buffer_store_dwordx4 v[32:35], v5, s[60:63], s12 offen sc1
    v_cvt_pk_bf16_f32 v36, v40, v41
    v_cvt_pk_bf16_f32 v37, v42, v43
    v_cvt_pk_bf16_f32 v38, v44, v45
    v_cvt_pk_bf16_f32 v39, v46, v47
    buffer_store_dwordx4 v[36:39], v5, s[60:63], s13 offen sc1
    s_mov_b32 s12, 4513792
    s_mov_b32 s13, 4517888
    v_cvt_pk_bf16_f32 v48, v48, v49
    v_cvt_pk_bf16_f32 v49, v50, v51
    v_cvt_pk_bf16_f32 v50, v52, v53
    v_cvt_pk_bf16_f32 v51, v54, v55
    buffer_store_dwordx4 v[48:51], v5, s[60:63], s12 offen sc1
    v_cvt_pk_bf16_f32 v52, v56, v57
    v_cvt_pk_bf16_f32 v53, v58, v59
    v_cvt_pk_bf16_f32 v54, v60, v61
    v_cvt_pk_bf16_f32 v55, v62, v63
    buffer_store_dwordx4 v[52:55], v5, s[60:63], s13 offen sc1
    s_branch Q_fin
Q_v:
    s_mul_i32 s46, s15, 3
    s_add_u32 s7, s46, 0
    s_mul_i32 s7, s7, 0x08080808
    s_add_u32 s92, s7, 0x03020100
    s_add_u32 s93, s7, 0x07060504
    s_add_u32 s7, s46, 1
    s_mul_i32 s7, s7, 0x08080808
    s_add_u32 s94, s7, 0x03020100
    s_add_u32 s95, s7, 0x07060504
    s_add_u32 s7, s46, 2
    s_mul_i32 s7, s7, 0x08080808
    s_add_u32 s96, s7, 0x03020100
    s_add_u32 s97, s7, 0x07060504
    v_bfe_u32 v3, v0, 2, 2
    v_lshl_add_u32 v3, v2, 3, v3
    v_mul_u32_u24 v3, 384, v3
    v_add_u32 v3, 32768, v3
    v_and_b32 v4, 8, v0
    v_lshlrev_b32 v4, 3, v4
    v_and_b32 v5, 3, v0
    v_lshlrev_b32 v5, 3, v5
    v_mov_b32 v6, s92
    v_mov_b32 v7, s93
    v_cndmask_b32 v6, v6, v7, s[10:11]
    v_bfe_u32 v6, v6, v5, 8
    v_lshlrev_b32 v6, 3, v6
    v_xor_b32 v6, v6, v4
    v_add_u32 v88, v3, v6
    v_mov_b32 v6, s94
    v_mov_b32 v7, s95
    v_cndmask_b32 v6, v6, v7, s[10:11]
    v_bfe_u32 v6, v6, v5, 8
    v_lshlrev_b32 v6, 3, v6
    v_xor_b32 v6, v6, v4
    v_add_u32 v89, v3, v6
    v_mov_b32 v6, s96
    v_mov_b32 v7, s97
    v_cndmask_b32 v6, v6, v7, s[10:11]
    v_bfe_u32 v6, v6, v5, 8
    v_lshlrev_b32 v6, 3, v6
    v_xor_b32 v6, v6, v4
    v_add_u32 v90, v3, v6
    v_and_b32 v9, 3, v1
    v_lshrrev_b32 v8, 3, v1
    v_lshl_add_u32 v9, v8, 2, v9
    v_and_b32 v8, 4, v1
    v_lshl_add_u32 v9, v8, 2, v9
    s_lshl_b32 s7, s14, 12
    v_bfe_u32 v8, v9, 1, 3
    v_xor_b32 v8, v8, v2
    v_lshlrev_b32 v8, 4, v8
    v_lshl_add_u32 v8, v9, 7, v8
    v_add_u32 v84, s7, v8
    v_xor_b32 v85, 32, v84
    v_xor_b32 v86, 64, v84
    v_xor_b32 v87, 96, v84
    s_sub_u32 s6, s4, 6
    s_mul_i32 s6, s6, 192
    s_lshl_b32 s7, s46, 5
    s_add_u32 s6, s6, s7
    v_add_u32 v3, s6, v1
    v_lshrrev_b32 v7, 2, v0
    v_add_u32 v7, s6, v7
    s_lshl_b32 s6, s5, 11
    s_add_u32 s6, s6, 16384
    v_lshl_add_u32 v8, v1, 6, s6
    v_lshl_add_u32 v22, v0, 4, s6
    v_and_b32 v9, 3, v0
    v_lshlrev_b32 v9, 4, v9
    v_lshlrev_b32 v13, 1, v2
    s_mov_b32 s7, 155648
    v_add_u32 v4, 0, v3
    v_mul_u32_u24 v5, 3641, v4
    v_lshrrev_b32 v5, 16, v5
    v_mul_u32_u24 v6, 18, v5
    v_sub_u32 v6, v4, v6
    v_bfe_u32 v6, v6, 2, 2
    v_xor_b32 v6, v6, v13
    v_lshl_add_u32 v80, v6, 4, v8
    v_add_u32 v4, 0, v7
    v_mul_u32_u24 v5, 3641, v4
    v_lshrrev_b32 v5, 16, v5
    v_mul_u32_u24 v6, 18, v5
    v_sub_u32 v6, v4, v6
    v_mad_u32_u24 v5, v5, s7, v9
    v_lshl_add_u32 v16, v6, 6, v5
    v_add_u32 v4, 16, v7
    v_mul_u32_u24 v5, 3641, v4
    v_lshrrev_b32 v5, 16, v5
    v_mul_u32_u24 v6, 18, v5
    v_sub_u32 v6, v4, v6
    v_mad_u32_u24 v5, v5, s7, v9
    v_lshl_add_u32 v17, v6, 6, v5
    v_add_u32 v4, 32, v3
    v_mul_u32_u24 v5, 3641, v4
    v_lshrrev_b32 v5, 16, v5
    v_mul_u32_u24 v6, 18, v5
    v_sub_u32 v6, v4, v6
    v_bfe_u32 v6, v6, 2, 2
    v_xor_b32 v6, v6, v13
    v_lshl_add_u32 v81, v6, 4, v8
    v_add_u32 v4, 32, v7
    v_mul_u32_u24 v5, 3641, v4
    v_lshrrev_b32 v5, 16, v5
    v_mul_u32_u24 v6, 18, v5
    v_sub_u32 v6, v4, v6
    v_mad_u32_u24 v5, v5, s7, v9
    v_lshl_add_u32 v18, v6, 6, v5
    v_add_u32 v4, 48, v7
    v_mul_u32_u24 v5, 3641, v4
    v_lshrrev_b32 v5, 16, v5
    v_mul_u32_u24 v6, 18, v5
    v_sub_u32 v6, v4, v6
    v_mad_u32_u24 v5, v5, s7, v9
    v_lshl_add_u32 v19, v6, 6, v5
    v_add_u32 v4, 64, v3
    v_mul_u32_u24 v5, 3641, v4
    v_lshrrev_b32 v5, 16, v5
    v_mul_u32_u24 v6, 18, v5
    v_sub_u32 v6, v4, v6
    v_bfe_u32 v6, v6, 2, 2
    v_xor_b32 v6, v6, v13
    v_lshl_add_u32 v82, v6, 4, v8
    v_add_u32 v4, 64, v7
    v_mul_u32_u24 v5, 3641, v4
    v_lshrrev_b32 v5, 16, v5
    v_mul_u32_u24 v6, 18, v5
    v_sub_u32 v6, v4, v6
    v_mad_u32_u24 v5, v5, s7, v9
    v_lshl_add_u32 v20, v6, 6, v5
    v_add_u32 v4, 80, v7
    v_mul_u32_u24 v5, 3641, v4
    v_lshrrev_b32 v5, 16, v5
    v_mul_u32_u24 v6, 18, v5
    v_sub_u32 v6, v4, v6
    v_mad_u32_u24 v5, v5, s7, v9
    v_lshl_add_u32 v21, v6, 6, v5
    s_waitcnt vmcnt(1)
    s_barrier
    s_add_u32 m0, s76, 16384
    s_add_u32 s7, s68, s78
    buffer_load_dwordx4 v10, s[48:51], s7 offen lds
    s_add_u32 m0, s76, 24576
    s_add_u32 s7, s7, 73728
    buffer_load_dwordx4 v10, s[48:51], s7 offen lds
    s_add_u32 s78, s78, 128
    s_cmp_eq_u32 s78, 1152
    s_cselect_b32 s78, 0, s78
    s_add_u32 m0, s76, 57344
    s_add_u32 s70, s69, s79
    buffer_load_dwordx4 v11, s[52:55], s70 offen lds
    s_add_u32 s79, s79, 110592
    s_cmp_eq_u32 s79, 1990656
    s_cselect_b32 s79, 0, s79
    s_cmp_eq_u32 s15, 0
    s_cbranch_scc0 Q_sk19
    s_add_u32 m0, s77, 65536
    s_nop 0
    buffer_load_dwordx4 v12, s[52:55], s70 offen lds
Q_sk19:
    ds_read_b128 v[96:99], v84
    ds_read_b64_tr_b16 v[100:101], v88 offset:0
    ds_read_b64_tr_b16 v[102:103], v88 offset:1536
    ds_read_b64_tr_b16 v[104:105], v89 offset:0
    ds_read_b64_tr_b16 v[106:107], v89 offset:1536
    ds_read_b64_tr_b16 v[108:109], v90 offset:0
    ds_read_b64_tr_b16 v[110:111], v90 offset:1536
    v_add_u32 v84, 16384, v84
    s_waitcnt lgkmcnt(4)
    v_mfma_f32_32x32x16_bf16 v[32:47], v[96:99], v[100:103], 0
    ds_read_b128 v[112:115], v85
    ds_read_b64_tr_b16 v[116:117], v88 offset:6144
    ds_read_b64_tr_b16 v[118:119], v88 offset:7680
    s_waitcnt lgkmcnt(5)
    v_mfma_f32_32x32x16_bf16 v[48:63], v[96:99], v[104:107], 0
    ds_read_b64_tr_b16 v[120:121], v89 offset:6144
    ds_read_b64_tr_b16 v[122:123], v89 offset:7680
    ds_read_b64_tr_b16 v[124:125], v90 offset:6144
    s_waitcnt lgkmcnt(6)
    v_mfma_f32_32x32x16_bf16 v[64:79], v[96:99], v[108:111], 0
    ds_read_b64_tr_b16 v[126:127], v90 offset:7680
    v_add_u32 v85, 16384, v85
    v_add_u32 v88, 12288, v88
    v_add_u32 v89, 12288, v89
    v_add_u32 v90, 12288, v90
    s_waitcnt lgkmcnt(4)
    v_mfma_f32_32x32x16_bf16 v[32:47], v[112:115], v[116:119], v[32:47]
    s_waitcnt vmcnt(3)
    s_barrier
    ds_read_b128 v[96:99], v86
    ds_read_b64_tr_b16 v[100:101], v88 offset:0
    ds_read_b64_tr_b16 v[102:103], v88 offset:1536
    s_add_u32 m0, s76, 69632
    s_add_u32 s70, s69, s79
    buffer_load_dwordx4 v11, s[52:55], s70 offen lds
    s_add_u32 s79, s79, 110592
    s_cmp_eq_u32 s79, 1990656
    s_cselect_b32 s79, 0, s79
    s_waitcnt lgkmcnt(5)
    v_mfma_f32_32x32x16_bf16 v[48:63], v[112:115], v[120:123], v[48:63]
    ds_read_b64_tr_b16 v[104:105], v89 offset:0
    ds_read_b64_tr_b16 v[106:107], v89 offset:1536
    ds_read_b64_tr_b16 v[108:109], v90 offset:0
    s_cmp_eq_u32 s15, 1
    s_cbranch_scc0 Q_sk20
    s_add_u32 m0, s77, 77824
    s_nop 0
    buffer_load_dwordx4 v12, s[52:55], s70 offen lds
Q_sk20:
    s_waitcnt lgkmcnt(6)
    v_mfma_f32_32x32x16_bf16 v[64:79], v[112:115], v[124:127], v[64:79]
    ds_read_b64_tr_b16 v[110:111], v90 offset:1536
    v_add_u32 v86, 16384, v86
    s_waitcnt lgkmcnt(4)
    v_mfma_f32_32x32x16_bf16 v[32:47], v[96:99], v[100:103], v[32:47]
    ds_read_b128 v[112:115], v87
    ds_read_b64_tr_b16 v[116:117], v88 offset:6144
    ds_read_b64_tr_b16 v[118:119], v88 offset:7680
    s_waitcnt lgkmcnt(5)
    v_mfma_f32_32x32x16_bf16 v[48:63], v[96:99], v[104:107], v[48:63]
    ds_read_b64_tr_b16 v[120:121], v89 offset:6144
    ds_read_b64_tr_b16 v[122:123], v89 offset:7680
    ds_read_b64_tr_b16 v[124:125], v90 offset:6144
    s_waitcnt lgkmcnt(6)
    v_mfma_f32_32x32x16_bf16 v[64:79], v[96:99], v[108:111], v[64:79]
    ds_read_b64_tr_b16 v[126:127], v90 offset:7680
    v_add_u32 v87, 16384, v87
    v_add_u32 v88, 12288, v88
    v_add_u32 v89, 12288, v89
    v_add_u32 v90, 12288, v90
    s_waitcnt lgkmcnt(4)
    v_mfma_f32_32x32x16_bf16 v[32:47], v[112:115], v[116:119], v[32:47]
    s_waitcnt vmcnt(1)
    s_barrier
    ds_read_b128 v[96:99], v84
    ds_read_b64_tr_b16 v[100:101], v88 offset:0
    ds_read_b64_tr_b16 v[102:103], v88 offset:1536
    s_add_u32 m0, s76, 0
    s_add_u32 s7, s68, s78
    buffer_load_dwordx4 v10, s[48:51], s7 offen lds
    s_waitcnt lgkmcnt(5)
    v_mfma_f32_32x32x16_bf16 v[48:63], v[112:115], v[120:123], v[48:63]
    ds_read_b64_tr_b16 v[104:105], v89 offset:0
    ds_read_b64_tr_b16 v[106:107], v89 offset:1536
    ds_read_b64_tr_b16 v[108:109], v90 offset:0
    s_add_u32 m0, s76, 8192
    s_add_u32 s7, s7, 73728
    buffer_load_dwordx4 v10, s[48:51], s7 offen lds
    s_add_u32 s78, s78, 128
    s_cmp_eq_u32 s78, 1152
    s_cselect_b32 s78, 0, s78
    s_waitcnt lgkmcnt(6)
    v_mfma_f32_32x32x16_bf16 v[64:79], v[112:115], v[124:127], v[64:79]
    ds_read_b64_tr_b16 v[110:111], v90 offset:1536
    v_add_u32 v84, 4294950912, v84
    s_add_u32 m0, s76, 32768
    s_add_u32 s70, s69, s79
    buffer_load_dwordx4 v11, s[52:55], s70 offen lds
    s_add_u32 s79, s79, 110592
    s_cmp_eq_u32 s79, 1990656
    s_cselect_b32 s79, 0, s79
    s_waitcnt lgkmcnt(4)
    v_mfma_f32_32x32x16_bf16 v[32:47], v[96:99], v[100:103], v[32:47]
    ds_read_b128 v[112:115], v85
    ds_read_b64_tr_b16 v[116:117], v88 offset:6144
    ds_read_b64_tr_b16 v[118:119], v88 offset:7680
    s_cmp_eq_u32 s15, 0
    s_cbranch_scc0 Q_sk21
    s_add_u32 m0, s77, 40960
    s_nop 0
    buffer_load_dwordx4 v12, s[52:55], s70 offen lds
Q_sk21:
    s_waitcnt lgkmcnt(5)
    v_mfma_f32_32x32x16_bf16 v[48:63], v[96:99], v[104:107], v[48:63]
    ds_read_b64_tr_b16 v[120:121], v89 offset:6144
    ds_read_b64_tr_b16 v[122:123], v89 offset:7680
    ds_read_b64_tr_b16 v[124:125], v90 offset:6144
    s_waitcnt lgkmcnt(6)
    v_mfma_f32_32x32x16_bf16 v[64:79], v[96:99], v[108:111], v[64:79]
    ds_read_b64_tr_b16 v[126:127], v90 offset:7680
    v_add_u32 v85, 4294950912, v85
    v_add_u32 v88, 12288, v88
    v_add_u32 v89, 12288, v89
    v_add_u32 v90, 12288, v90
    s_waitcnt lgkmcnt(4)
    v_mfma_f32_32x32x16_bf16 v[32:47], v[112:115], v[116:119], v[32:47]
    s_waitcnt vmcnt(3)
    s_barrier
    ds_read_b128 v[96:99], v86
    ds_read_b64_tr_b16 v[100:101], v88 offset:0
    ds_read_b64_tr_b16 v[102:103], v88 offset:1536
    s_add_u32 m0, s76, 45056
    s_add_u32 s70, s69, s79
    buffer_load_dwordx4 v11, s[52:55], s70 offen lds
    s_add_u32 s79, s79, 110592
    s_cmp_eq_u32 s79, 1990656
    s_cselect_b32 s79, 0, s79
    s_waitcnt lgkmcnt(5)
    v_mfma_f32_32x32x16_bf16 v[48:63], v[112:115], v[120:123], v[48:63]
    ds_read_b64_tr_b16 v[104:105], v89 offset:0
    ds_read_b64_tr_b16 v[106:107], v89 offset:1536
    ds_read_b64_tr_b16 v[108:109], v90 offset:0
    s_cmp_eq_u32 s15, 1
    s_cbranch_scc0 Q_sk22
    s_add_u32 m0, s77, 53248
    s_nop 0
    buffer_load_dwordx4 v12, s[52:55], s70 offen lds
Q_sk22:
    s_waitcnt lgkmcnt(6)
    v_mfma_f32_32x32x16_bf16 v[64:79], v[112:115], v[124:127], v[64:79]
    ds_read_b64_tr_b16 v[110:111], v90 offset:1536
    v_add_u32 v86, 4294950912, v86
    s_waitcnt lgkmcnt(4)
    v_mfma_f32_32x32x16_bf16 v[32:47], v[96:99], v[100:103], v[32:47]
    ds_read_b128 v[112:115], v87
    ds_read_b64_tr_b16 v[116:117], v88 offset:6144
    ds_read_b64_tr_b16 v[118:119], v88 offset:7680
    s_waitcnt lgkmcnt(5)
    v_mfma_f32_32x32x16_bf16 v[48:63], v[96:99], v[104:107], v[48:63]
    ds_read_b64_tr_b16 v[120:121], v89 offset:6144
    ds_read_b64_tr_b16 v[122:123], v89 offset:7680
    ds_read_b64_tr_b16 v[124:125], v90 offset:6144
    s_waitcnt lgkmcnt(6)
    v_mfma_f32_32x32x16_bf16 v[64:79], v[96:99], v[108:111], v[64:79]
    ds_read_b64_tr_b16 v[126:127], v90 offset:7680
    v_add_u32 v87, 4294950912, v87
    v_add_u32 v88, 4294930432, v88
    v_add_u32 v89, 4294930432, v89
    v_add_u32 v90, 4294930432, v90
    s_waitcnt lgkmcnt(4)
    v_mfma_f32_32x32x16_bf16 v[32:47], v[112:115], v[116:119], v[32:47]
    s_waitcnt vmcnt(1)
    s_barrier
    ds_read_b128 v[96:99], v84
    ds_read_b64_tr_b16 v[100:101], v88 offset:0
    ds_read_b64_tr_b16 v[102:103], v88 offset:1536
    s_add_u32 m0, s76, 16384
    s_add_u32 s7, s68, s78
    buffer_load_dwordx4 v10, s[48:51], s7 offen lds
    s_waitcnt lgkmcnt(5)
    v_mfma_f32_32x32x16_bf16 v[48:63], v[112:115], v[120:123], v[48:63]
    ds_read_b64_tr_b16 v[104:105], v89 offset:0
    ds_read_b64_tr_b16 v[106:107], v89 offset:1536
    ds_read_b64_tr_b16 v[108:109], v90 offset:0
    s_add_u32 m0, s76, 24576
    s_add_u32 s7, s7, 73728
    buffer_load_dwordx4 v10, s[48:51], s7 offen lds
    s_add_u32 s78, s78, 128
    s_cmp_eq_u32 s78, 1152
    s_cselect_b32 s78, 0, s78
    s_waitcnt lgkmcnt(6)
    v_mfma_f32_32x32x16_bf16 v[64:79], v[112:115], v[124:127], v[64:79]
    ds_read_b64_tr_b16 v[110:111], v90 offset:1536
    v_add_u32 v84, 16384, v84
    s_add_u32 m0, s76, 57344
    s_add_u32 s70, s69, s79
    buffer_load_dwordx4 v11, s[52:55], s70 offen lds
    s_add_u32 s79, s79, 110592
    s_cmp_eq_u32 s79, 1990656
    s_cselect_b32 s79, 0, s79
    s_waitcnt lgkmcnt(4)
    v_mfma_f32_32x32x16_bf16 v[32:47], v[96:99], v[100:103], v[32:47]
    ds_read_b128 v[112:115], v85
    ds_read_b64_tr_b16 v[116:117], v88 offset:6144
    ds_read_b64_tr_b16 v[118:119], v88 offset:7680
    s_cmp_eq_u32 s15, 0
    s_cbranch_scc0 Q_sk23
    s_add_u32 m0, s77, 65536
    s_nop 0
    buffer_load_dwordx4 v12, s[52:55], s70 offen lds
Q_sk23:
    s_waitcnt lgkmcnt(5)
    v_mfma_f32_32x32x16_bf16 v[48:63], v[96:99], v[104:107], v[48:63]
    ds_read_b64_tr_b16 v[120:121], v89 offset:6144
    ds_read_b64_tr_b16 v[122:123], v89 offset:7680
    ds_read_b64_tr_b16 v[124:125], v90 offset:6144
    s_waitcnt lgkmcnt(6)
    v_mfma_f32_32x32x16_bf16 v[64:79], v[96:99], v[108:111], v[64:79]
    ds_read_b64_tr_b16 v[126:127], v90 offset:7680
    v_add_u32 v85, 16384, v85
    v_add_u32 v88, 12288, v88
    v_add_u32 v89, 12288, v89
    v_add_u32 v90, 12288, v90
    s_waitcnt lgkmcnt(4)
    v_mfma_f32_32x32x16_bf16 v[32:47], v[112:115], v[116:119], v[32:47]
    s_waitcnt vmcnt(3)
    s_barrier
    ds_read_b128 v[96:99], v86
    ds_read_b64_tr_b16 v[100:101], v88 offset:0
    ds_read_b64_tr_b16 v[102:103], v88 offset:1536
    s_add_u32 m0, s76, 69632
    s_add_u32 s70, s69, s79
    buffer_load_dwordx4 v11, s[52:55], s70 offen lds
    s_add_u32 s79, s79, 110592
    s_cmp_eq_u32 s79, 1990656
    s_cselect_b32 s79, 0, s79
    s_waitcnt lgkmcnt(5)
    v_mfma_f32_32x32x16_bf16 v[48:63], v[112:115], v[120:123], v[48:63]
    ds_read_b64_tr_b16 v[104:105], v89 offset:0
    ds_read_b64_tr_b16 v[106:107], v89 offset:1536
    ds_read_b64_tr_b16 v[108:109], v90 offset:0
    s_cmp_eq_u32 s15, 1
    s_cbranch_scc0 Q_sk24
    s_add_u32 m0, s77, 77824
    s_nop 0
    buffer_load_dwordx4 v12, s[52:55], s70 offen lds
Q_sk24:
    s_waitcnt lgkmcnt(6)
    v_mfma_f32_32x32x16_bf16 v[64:79], v[112:115], v[124:127], v[64:79]
    ds_read_b64_tr_b16 v[110:111], v90 offset:1536
    v_add_u32 v86, 16384, v86
    s_waitcnt lgkmcnt(4)
    v_mfma_f32_32x32x16_bf16 v[32:47], v[96:99], v[100:103], v[32:47]
    ds_read_b128 v[112:115], v87
    ds_read_b64_tr_b16 v[116:117], v88 offset:6144
    ds_read_b64_tr_b16 v[118:119], v88 offset:7680
    s_waitcnt lgkmcnt(5)
    v_mfma_f32_32x32x16_bf16 v[48:63], v[96:99], v[104:107], v[48:63]
    ds_read_b64_tr_b16 v[120:121], v89 offset:6144
    ds_read_b64_tr_b16 v[122:123], v89 offset:7680
    ds_read_b64_tr_b16 v[124:125], v90 offset:6144
    s_waitcnt lgkmcnt(6)
    v_mfma_f32_32x32x16_bf16 v[64:79], v[96:99], v[108:111], v[64:79]
    ds_read_b64_tr_b16 v[126:127], v90 offset:7680
    v_add_u32 v87, 16384, v87
    v_add_u32 v88, 12288, v88
    v_add_u32 v89, 12288, v89
    v_add_u32 v90, 12288, v90
    s_waitcnt lgkmcnt(4)
    v_mfma_f32_32x32x16_bf16 v[32:47], v[112:115], v[116:119], v[32:47]
    s_waitcnt vmcnt(1)
    s_barrier
    ds_read_b128 v[96:99], v84
    ds_read_b64_tr_b16 v[100:101], v88 offset:0
    ds_read_b64_tr_b16 v[102:103], v88 offset:1536
    s_add_u32 m0, s76, 0
    s_add_u32 s7, s68, s78
    buffer_load_dwordx4 v10, s[48:51], s7 offen lds
    s_waitcnt lgkmcnt(5)
    v_mfma_f32_32x32x16_bf16 v[48:63], v[112:115], v[120:123], v[48:63]
    ds_read_b64_tr_b16 v[104:105], v89 offset:0
    ds_read_b64_tr_b16 v[106:107], v89 offset:1536
    ds_read_b64_tr_b16 v[108:109], v90 offset:0
    s_add_u32 m0, s76, 8192
    s_add_u32 s7, s7, 73728
    buffer_load_dwordx4 v10, s[48:51], s7 offen lds
    s_add_u32 s78, s78, 128
    s_cmp_eq_u32 s78, 1152
    s_cselect_b32 s78, 0, s78
    s_waitcnt lgkmcnt(6)
    v_mfma_f32_32x32x16_bf16 v[64:79], v[112:115], v[124:127], v[64:79]
    ds_read_b64_tr_b16 v[110:111], v90 offset:1536
    v_add_u32 v84, 4294950912, v84
    s_add_u32 m0, s76, 32768
    s_add_u32 s70, s69, s79
    buffer_load_dwordx4 v11, s[52:55], s70 offen lds
    s_add_u32 s79, s79, 110592
    s_cmp_eq_u32 s79, 1990656
    s_cselect_b32 s79, 0, s79
    s_waitcnt lgkmcnt(4)
    v_mfma_f32_32x32x16_bf16 v[32:47], v[96:99], v[100:103], v[32:47]
    ds_read_b128 v[112:115], v85
    ds_read_b64_tr_b16 v[116:117], v88 offset:6144
    ds_read_b64_tr_b16 v[118:119], v88 offset:7680
    s_cmp_eq_u32 s15, 0
    s_cbranch_scc0 Q_sk25
    s_add_u32 m0, s77, 40960
    s_nop 0
    buffer_load_dwordx4 v12, s[52:55], s70 offen lds
Q_sk25:
    s_waitcnt lgkmcnt(5)
    v_mfma_f32_32x32x16_bf16 v[48:63], v[96:99], v[104:107], v[48:63]
    ds_read_b64_tr_b16 v[120:121], v89 offset:6144
    ds_read_b64_tr_b16 v[122:123], v89 offset:7680
    ds_read_b64_tr_b16 v[124:125], v90 offset:6144
    s_waitcnt lgkmcnt(6)
    v_mfma_f32_32x32x16_bf16 v[64:79], v[96:99], v[108:111], v[64:79]
    ds_read_b64_tr_b16 v[126:127], v90 offset:7680
    v_add_u32 v85, 4294950912, v85
    v_add_u32 v88, 12288, v88
    v_add_u32 v89, 12288, v89
    v_add_u32 v90, 12288, v90
    s_waitcnt lgkmcnt(4)
    v_mfma_f32_32x32x16_bf16 v[32:47], v[112:115], v[116:119], v[32:47]
    s_waitcnt vmcnt(3)
    s_barrier
    ds_read_b128 v[96:99], v86
    ds_read_b64_tr_b16 v[100:101], v88 offset:0
    ds_read_b64_tr_b16 v[102:103], v88 offset:1536
    s_add_u32 m0, s76, 45056
    s_add_u32 s70, s69, s79
    buffer_load_dwordx4 v11, s[52:55], s70 offen lds
    s_add_u32 s79, s79, 110592
    s_cmp_eq_u32 s79, 1990656
    s_cselect_b32 s79, 0, s79
    s_waitcnt lgkmcnt(5)
    v_mfma_f32_32x32x16_bf16 v[48:63], v[112:115], v[120:123], v[48:63]
    ds_read_b64_tr_b16 v[104:105], v89 offset:0
    ds_read_b64_tr_b16 v[106:107], v89 offset:1536
    ds_read_b64_tr_b16 v[108:109], v90 offset:0
    s_cmp_eq_u32 s15, 1
    s_cbranch_scc0 Q_sk26
    s_add_u32 m0, s77, 53248
    s_nop 0
    buffer_load_dwordx4 v12, s[52:55], s70 offen lds
Q_sk26:
    s_waitcnt lgkmcnt(6)
    v_mfma_f32_32x32x16_bf16 v[64:79], v[112:115], v[124:127], v[64:79]
    ds_read_b64_tr_b16 v[110:111], v90 offset:1536
    v_add_u32 v86, 4294950912, v86
    s_waitcnt lgkmcnt(4)
    v_mfma_f32_32x32x16_bf16 v[32:47], v[96:99], v[100:103], v[32:47]
    ds_read_b128 v[112:115], v87
    ds_read_b64_tr_b16 v[116:117], v88 offset:6144
    ds_read_b64_tr_b16 v[118:119], v88 offset:7680
    s_waitcnt lgkmcnt(5)
    v_mfma_f32_32x32x16_bf16 v[48:63], v[96:99], v[104:107], v[48:63]
    ds_read_b64_tr_b16 v[120:121], v89 offset:6144
    ds_read_b64_tr_b16 v[122:123], v89 offset:7680
    ds_read_b64_tr_b16 v[124:125], v90 offset:6144
    s_waitcnt lgkmcnt(6)
    v_mfma_f32_32x32x16_bf16 v[64:79], v[96:99], v[108:111], v[64:79]
    ds_read_b64_tr_b16 v[126:127], v90 offset:7680
    v_add_u32 v87, 4294950912, v87
    v_add_u32 v88, 4294930432, v88
    v_add_u32 v89, 4294930432, v89
    v_add_u32 v90, 4294930432, v90
    s_waitcnt lgkmcnt(4)
    v_mfma_f32_32x32x16_bf16 v[32:47], v[112:115], v[116:119], v[32:47]
    s_waitcnt vmcnt(1)
    s_barrier
    ds_read_b128 v[96:99], v84
    ds_read_b64_tr_b16 v[100:101], v88 offset:0
    ds_read_b64_tr_b16 v[102:103], v88 offset:1536
    s_add_u32 m0, s76, 16384
    s_add_u32 s7, s68, s78
    buffer_load_dwordx4 v10, s[48:51], s7 offen lds
    s_waitcnt lgkmcnt(5)
    v_mfma_f32_32x32x16_bf16 v[48:63], v[112:115], v[120:123], v[48:63]
    ds_read_b64_tr_b16 v[104:105], v89 offset:0
    ds_read_b64_tr_b16 v[106:107], v89 offset:1536
    ds_read_b64_tr_b16 v[108:109], v90 offset:0
    s_add_u32 m0, s76, 24576
    s_add_u32 s7, s7, 73728
    buffer_load_dwordx4 v10, s[48:51], s7 offen lds
    s_add_u32 s78, s78, 128
    s_cmp_eq_u32 s78, 1152
    s_cselect_b32 s78, 0, s78
    s_waitcnt lgkmcnt(6)
    v_mfma_f32_32x32x16_bf16 v[64:79], v[112:115], v[124:127], v[64:79]
    ds_read_b64_tr_b16 v[110:111], v90 offset:1536
    v_add_u32 v84, 16384, v84
    s_add_u32 m0, s76, 57344
    s_add_u32 s70, s69, s79
    buffer_load_dwordx4 v11, s[52:55], s70 offen lds
    s_add_u32 s79, s79, 110592
    s_cmp_eq_u32 s79, 1990656
    s_cselect_b32 s79, 0, s79
    s_waitcnt lgkmcnt(4)
    v_mfma_f32_32x32x16_bf16 v[32:47], v[96:99], v[100:103], v[32:47]
    ds_read_b128 v[112:115], v85
    ds_read_b64_tr_b16 v[116:117], v88 offset:6144
    ds_read_b64_tr_b16 v[118:119], v88 offset:7680
    s_cmp_eq_u32 s15, 0
    s_cbranch_scc0 Q_sk27
    s_add_u32 m0, s77, 65536
    s_nop 0
    buffer_load_dwordx4 v12, s[52:55], s70 offen lds
Q_sk27:
    s_waitcnt lgkmcnt(5)
    v_mfma_f32_32x32x16_bf16 v[48:63], v[96:99], v[104:107], v[48:63]
    ds_read_b64_tr_b16 v[120:121], v89 offset:6144
    ds_read_b64_tr_b16 v[122:123], v89 offset:7680
    ds_read_b64_tr_b16 v[124:125], v90 offset:6144
    s_waitcnt lgkmcnt(6)
    v_mfma_f32_32x32x16_bf16 v[64:79], v[96:99], v[108:111], v[64:79]
    ds_read_b64_tr_b16 v[126:127], v90 offset:7680
    v_add_u32 v85, 16384, v85
    v_add_u32 v88, 12288, v88
    v_add_u32 v89, 12288, v89
    v_add_u32 v90, 12288, v90
    s_waitcnt lgkmcnt(4)
    v_mfma_f32_32x32x16_bf16 v[32:47], v[112:115], v[116:119], v[32:47]
    s_waitcnt vmcnt(3)
    s_barrier
    ds_read_b128 v[96:99], v86
    ds_read_b64_tr_b16 v[100:101], v88 offset:0
    ds_read_b64_tr_b16 v[102:103], v88 offset:1536
    s_add_u32 m0, s76, 69632
    s_add_u32 s70, s69, s79
    buffer_load_dwordx4 v11, s[52:55], s70 offen lds
    s_add_u32 s79, s79, 110592
    s_cmp_eq_u32 s79, 1990656
    s_cselect_b32 s79, 0, s79
    s_waitcnt lgkmcnt(5)
    v_mfma_f32_32x32x16_bf16 v[48:63], v[112:115], v[120:123], v[48:63]
    ds_read_b64_tr_b16 v[104:105], v89 offset:0
    ds_read_b64_tr_b16 v[106:107], v89 offset:1536
    ds_read_b64_tr_b16 v[108:109], v90 offset:0
    s_cmp_eq_u32 s15, 1
    s_cbranch_scc0 Q_sk28
    s_add_u32 m0, s77, 77824
    s_nop 0
    buffer_load_dwordx4 v12, s[52:55], s70 offen lds
Q_sk28:
    s_waitcnt lgkmcnt(6)
    v_mfma_f32_32x32x16_bf16 v[64:79], v[112:115], v[124:127], v[64:79]
    ds_read_b64_tr_b16 v[110:111], v90 offset:1536
    v_add_u32 v86, 16384, v86
    s_waitcnt lgkmcnt(4)
    v_mfma_f32_32x32x16_bf16 v[32:47], v[96:99], v[100:103], v[32:47]
    ds_read_b128 v[112:115], v87
    ds_read_b64_tr_b16 v[116:117], v88 offset:6144
    ds_read_b64_tr_b16 v[118:119], v88 offset:7680
    s_waitcnt lgkmcnt(5)
    v_mfma_f32_32x32x16_bf16 v[48:63], v[96:99], v[104:107], v[48:63]
    ds_read_b64_tr_b16 v[120:121], v89 offset:6144
    ds_read_b64_tr_b16 v[122:123], v89 offset:7680
    ds_read_b64_tr_b16 v[124:125], v90 offset:6144
    s_waitcnt lgkmcnt(6)
    v_mfma_f32_32x32x16_bf16 v[64:79], v[96:99], v[108:111], v[64:79]
    ds_read_b64_tr_b16 v[126:127], v90 offset:7680
    v_add_u32 v87, 16384, v87
    v_add_u32 v88, 12288, v88
    v_add_u32 v89, 12288, v89
    v_add_u32 v90, 12288, v90
    s_waitcnt lgkmcnt(4)
    v_mfma_f32_32x32x16_bf16 v[32:47], v[112:115], v[116:119], v[32:47]
    s_waitcnt vmcnt(1)
    s_barrier
    ds_read_b128 v[96:99], v84
    ds_read_b64_tr_b16 v[100:101], v88 offset:0
    ds_read_b64_tr_b16 v[102:103], v88 offset:1536
    s_add_u32 m0, s76, 0
    s_add_u32 s7, s68, s78
    buffer_load_dwordx4 v10, s[48:51], s7 offen lds
    s_waitcnt lgkmcnt(5)
    v_mfma_f32_32x32x16_bf16 v[48:63], v[112:115], v[120:123], v[48:63]
    ds_read_b64_tr_b16 v[104:105], v89 offset:0
    ds_read_b64_tr_b16 v[106:107], v89 offset:1536
    ds_read_b64_tr_b16 v[108:109], v90 offset:0
    s_add_u32 m0, s76, 8192
    s_add_u32 s7, s7, 73728
    buffer_load_dwordx4 v10, s[48:51], s7 offen lds
    s_add_u32 s78, s78, 128
    s_cmp_eq_u32 s78, 1152
    s_cselect_b32 s78, 0, s78
    s_waitcnt lgkmcnt(6)
    v_mfma_f32_32x32x16_bf16 v[64:79], v[112:115], v[124:127], v[64:79]
    ds_read_b64_tr_b16 v[110:111], v90 offset:1536
    v_add_u32 v84, 4294950912, v84
    s_add_u32 m0, s76, 32768
    s_add_u32 s70, s69, s79
    buffer_load_dwordx4 v11, s[52:55], s70 offen lds
    s_add_u32 s79, s79, 110592
    s_cmp_eq_u32 s79, 1990656
    s_cselect_b32 s79, 0, s79
    s_waitcnt lgkmcnt(4)
    v_mfma_f32_32x32x16_bf16 v[32:47], v[96:99], v[100:103], v[32:47]
    ds_read_b128 v[112:115], v85
    ds_read_b64_tr_b16 v[116:117], v88 offset:6144
    ds_read_b64_tr_b16 v[118:119], v88 offset:7680
    s_cmp_eq_u32 s15, 0
    s_cbranch_scc0 Q_sk29
    s_add_u32 m0, s77, 40960
    s_nop 0
    buffer_load_dwordx4 v12, s[52:55], s70 offen lds
Q_sk29:
    s_waitcnt lgkmcnt(5)
    v_mfma_f32_32x32x16_bf16 v[48:63], v[96:99], v[104:107], v[48:63]
    ds_read_b64_tr_b16 v[120:121], v89 offset:6144
    ds_read_b64_tr_b16 v[122:123], v89 offset:7680
    ds_read_b64_tr_b16 v[124:125], v90 offset:6144
    s_waitcnt lgkmcnt(6)
    v_mfma_f32_32x32x16_bf16 v[64:79], v[96:99], v[108:111], v[64:79]
    ds_read_b64_tr_b16 v[126:127], v90 offset:7680
    v_add_u32 v85, 4294950912, v85
    v_add_u32 v88, 12288, v88
    v_add_u32 v89, 12288, v89
    v_add_u32 v90, 12288, v90
    s_waitcnt lgkmcnt(4)
    v_mfma_f32_32x32x16_bf16 v[32:47], v[112:115], v[116:119], v[32:47]
    s_waitcnt vmcnt(3)
    s_barrier
    ds_read_b128 v[96:99], v86
    ds_read_b64_tr_b16 v[100:101], v88 offset:0
    ds_read_b64_tr_b16 v[102:103], v88 offset:1536
    s_add_u32 m0, s76, 45056
    s_add_u32 s70, s69, s79
    buffer_load_dwordx4 v11, s[52:55], s70 offen lds
    s_add_u32 s79, s79, 110592
    s_cmp_eq_u32 s79, 1990656
    s_cselect_b32 s79, 0, s79
    s_waitcnt lgkmcnt(5)
    v_mfma_f32_32x32x16_bf16 v[48:63], v[112:115], v[120:123], v[48:63]
    ds_read_b64_tr_b16 v[104:105], v89 offset:0
    ds_read_b64_tr_b16 v[106:107], v89 offset:1536
    ds_read_b64_tr_b16 v[108:109], v90 offset:0
    s_cmp_eq_u32 s15, 1
    s_cbranch_scc0 Q_sk30
    s_add_u32 m0, s77, 53248
    s_nop 0
    buffer_load_dwordx4 v12, s[52:55], s70 offen lds
Q_sk30:
    s_waitcnt lgkmcnt(6)
    v_mfma_f32_32x32x16_bf16 v[64:79], v[112:115], v[124:127], v[64:79]
    ds_read_b64_tr_b16 v[110:111], v90 offset:1536
    v_add_u32 v86, 4294950912, v86
    s_waitcnt lgkmcnt(4)
    v_mfma_f32_32x32x16_bf16 v[32:47], v[96:99], v[100:103], v[32:47]
    ds_read_b128 v[112:115], v87
    ds_read_b64_tr_b16 v[116:117], v88 offset:6144
    ds_read_b64_tr_b16 v[118:119], v88 offset:7680
    s_waitcnt lgkmcnt(5)
    v_mfma_f32_32x32x16_bf16 v[48:63], v[96:99], v[104:107], v[48:63]
    ds_read_b64_tr_b16 v[120:121], v89 offset:6144
    ds_read_b64_tr_b16 v[122:123], v89 offset:7680
    ds_read_b64_tr_b16 v[124:125], v90 offset:6144
    s_waitcnt lgkmcnt(6)
    v_mfma_f32_32x32x16_bf16 v[64:79], v[96:99], v[108:111], v[64:79]
    ds_read_b64_tr_b16 v[126:127], v90 offset:7680
    v_add_u32 v87, 4294950912, v87
    v_add_u32 v88, 4294930432, v88
    v_add_u32 v89, 4294930432, v89
    v_add_u32 v90, 4294930432, v90
    s_waitcnt lgkmcnt(4)
    v_mfma_f32_32x32x16_bf16 v[32:47], v[112:115], v[116:119], v[32:47]
    s_waitcnt vmcnt(1)
    s_barrier
    ds_read_b128 v[96:99], v84
    ds_read_b64_tr_b16 v[100:101], v88 offset:0
    ds_read_b64_tr_b16 v[102:103], v88 offset:1536
    s_add_u32 m0, s76, 16384
    s_add_u32 s7, s68, s78
    buffer_load_dwordx4 v10, s[48:51], s7 offen lds
    s_waitcnt lgkmcnt(5)
    v_mfma_f32_32x32x16_bf16 v[48:63], v[112:115], v[120:123], v[48:63]
    ds_read_b64_tr_b16 v[104:105], v89 offset:0
    ds_read_b64_tr_b16 v[106:107], v89 offset:1536
    ds_read_b64_tr_b16 v[108:109], v90 offset:0
    s_add_u32 m0, s76, 24576
    s_add_u32 s7, s7, 73728
    buffer_load_dwordx4 v10, s[48:51], s7 offen lds
    s_add_u32 s78, s78, 128
    s_cmp_eq_u32 s78, 1152
    s_cselect_b32 s78, 0, s78
    s_waitcnt lgkmcnt(6)
    v_mfma_f32_32x32x16_bf16 v[64:79], v[112:115], v[124:127], v[64:79]
    ds_read_b64_tr_b16 v[110:111], v90 offset:1536
    v_add_u32 v84, 16384, v84
    s_add_u32 m0, s76, 57344
    s_add_u32 s70, s69, s79
    buffer_load_dwordx4 v11, s[52:55], s70 offen lds
    s_add_u32 s79, s79, 110592
    s_cmp_eq_u32 s79, 1990656
    s_cselect_b32 s79, 0, s79
    s_waitcnt lgkmcnt(4)
    v_mfma_f32_32x32x16_bf16 v[32:47], v[96:99], v[100:103], v[32:47]
    ds_read_b128 v[112:115], v85
    ds_read_b64_tr_b16 v[116:117], v88 offset:6144
    ds_read_b64_tr_b16 v[118:119], v88 offset:7680
    s_cmp_eq_u32 s15, 0
    s_cbranch_scc0 Q_sk31
    s_add_u32 m0, s77, 65536
    s_nop 0
    buffer_load_dwordx4 v12, s[52:55], s70 offen lds
Q_sk31:
    s_waitcnt lgkmcnt(5)
    v_mfma_f32_32x32x16_bf16 v[48:63], v[96:99], v[104:107], v[48:63]
    ds_read_b64_tr_b16 v[120:121], v89 offset:6144
    ds_read_b64_tr_b16 v[122:123], v89 offset:7680
    ds_read_b64_tr_b16 v[124:125], v90 offset:6144
    s_waitcnt lgkmcnt(6)
    v_mfma_f32_32x32x16_bf16 v[64:79], v[96:99], v[108:111], v[64:79]
    ds_read_b64_tr_b16 v[126:127], v90 offset:7680
    v_add_u32 v85, 16384, v85
    v_add_u32 v88, 12288, v88
    v_add_u32 v89, 12288, v89
    v_add_u32 v90, 12288, v90
    s_waitcnt lgkmcnt(4)
    v_mfma_f32_32x32x16_bf16 v[32:47], v[112:115], v[116:119], v[32:47]
    s_waitcnt vmcnt(3)
    s_barrier
    ds_read_b128 v[96:99], v86
    ds_read_b64_tr_b16 v[100:101], v88 offset:0
    ds_read_b64_tr_b16 v[102:103], v88 offset:1536
    s_add_u32 m0, s76, 69632
    s_add_u32 s70, s69, s79
    buffer_load_dwordx4 v11, s[52:55], s70 offen lds
    s_add_u32 s79, s79, 110592
    s_cmp_eq_u32 s79, 1990656
    s_cselect_b32 s79, 0, s79
    s_waitcnt lgkmcnt(5)
    v_mfma_f32_32x32x16_bf16 v[48:63], v[112:115], v[120:123], v[48:63]
    ds_read_b64_tr_b16 v[104:105], v89 offset:0
    ds_read_b64_tr_b16 v[106:107], v89 offset:1536
    ds_read_b64_tr_b16 v[108:109], v90 offset:0
    s_cmp_eq_u32 s15, 1
    s_cbranch_scc0 Q_sk32
    s_add_u32 m0, s77, 77824
    s_nop 0
    buffer_load_dwordx4 v12, s[52:55], s70 offen lds
Q_sk32:
    s_waitcnt lgkmcnt(6)
    v_mfma_f32_32x32x16_bf16 v[64:79], v[112:115], v[124:127], v[64:79]
    ds_read_b64_tr_b16 v[110:111], v90 offset:1536
    v_add_u32 v86, 16384, v86
    s_waitcnt lgkmcnt(4)
    v_mfma_f32_32x32x16_bf16 v[32:47], v[96:99], v[100:103], v[32:47]
    ds_read_b128 v[112:115], v87
    ds_read_b64_tr_b16 v[116:117], v88 offset:6144
    ds_read_b64_tr_b16 v[118:119], v88 offset:7680
    s_waitcnt lgkmcnt(5)
    v_mfma_f32_32x32x16_bf16 v[48:63], v[96:99], v[104:107], v[48:63]
    ds_read_b64_tr_b16 v[120:121], v89 offset:6144
    ds_read_b64_tr_b16 v[122:123], v89 offset:7680
    ds_read_b64_tr_b16 v[124:125], v90 offset:6144
    s_waitcnt lgkmcnt(6)
    v_mfma_f32_32x32x16_bf16 v[64:79], v[96:99], v[108:111], v[64:79]
    ds_read_b64_tr_b16 v[126:127], v90 offset:7680
    v_add_u32 v87, 16384, v87
    v_add_u32 v88, 12288, v88
    v_add_u32 v89, 12288, v89
    v_add_u32 v90, 12288, v90
    s_waitcnt lgkmcnt(4)
    v_mfma_f32_32x32x16_bf16 v[32:47], v[112:115], v[116:119], v[32:47]
    s_waitcnt vmcnt(1)
    s_barrier
    ds_read_b128 v[96:99], v84
    ds_read_b64_tr_b16 v[100:101], v88 offset:0
    ds_read_b64_tr_b16 v[102:103], v88 offset:1536
    s_add_u32 m0, s76, 0
    s_add_u32 s7, s68, s78
    buffer_load_dwordx4 v10, s[48:51], s7 offen lds
    s_waitcnt lgkmcnt(5)
    v_mfma_f32_32x32x16_bf16 v[48:63], v[112:115], v[120:123], v[48:63]
    ds_read_b64_tr_b16 v[104:105], v89 offset:0
    ds_read_b64_tr_b16 v[106:107], v89 offset:1536
    ds_read_b64_tr_b16 v[108:109], v90 offset:0
    s_add_u32 m0, s76, 8192
    s_add_u32 s7, s7, 73728
    buffer_load_dwordx4 v10, s[48:51], s7 offen lds
    s_add_u32 s78, s78, 128
    s_cmp_eq_u32 s78, 1152
    s_cselect_b32 s78, 0, s78
    s_waitcnt lgkmcnt(6)
    v_mfma_f32_32x32x16_bf16 v[64:79], v[112:115], v[124:127], v[64:79]
    ds_read_b64_tr_b16 v[110:111], v90 offset:1536
    v_add_u32 v84, 4294950912, v84
    s_add_u32 m0, s76, 32768
    s_add_u32 s70, s69, s79
    buffer_load_dwordx4 v11, s[52:55], s70 offen lds
    s_add_u32 s79, s79, 110592
    s_cmp_eq_u32 s79, 1990656
    s_cselect_b32 s79, 0, s79
    s_waitcnt lgkmcnt(4)
    v_mfma_f32_32x32x16_bf16 v[32:47], v[96:99], v[100:103], v[32:47]
    ds_read_b128 v[112:115], v85
    ds_read_b64_tr_b16 v[116:117], v88 offset:6144
    ds_read_b64_tr_b16 v[118:119], v88 offset:7680
    s_cmp_eq_u32 s15, 0
    s_cbranch_scc0 Q_sk33
    s_add_u32 m0, s77, 40960
    s_nop 0
    buffer_load_dwordx4 v12, s[52:55], s70 offen lds
Q_sk33:
    s_waitcnt lgkmcnt(5)
    v_mfma_f32_32x32x16_bf16 v[48:63], v[96:99], v[104:107], v[48:63]
    ds_read_b64_tr_b16 v[120:121], v89 offset:6144
    ds_read_b64_tr_b16 v[122:123], v89 offset:7680
    ds_read_b64_tr_b16 v[124:125], v90 offset:6144
    s_waitcnt lgkmcnt(6)
    v_mfma_f32_32x32x16_bf16 v[64:79], v[96:99], v[108:111], v[64:79]
    ds_read_b64_tr_b16 v[126:127], v90 offset:7680
    v_add_u32 v85, 4294950912, v85
    v_add_u32 v88, 12288, v88
    v_add_u32 v89, 12288, v89
    v_add_u32 v90, 12288, v90
    s_waitcnt lgkmcnt(4)
    v_mfma_f32_32x32x16_bf16 v[32:47], v[112:115], v[116:119], v[32:47]
    s_waitcnt vmcnt(3)
    s_barrier
    ds_read_b128 v[96:99], v86
    ds_read_b64_tr_b16 v[100:101], v88 offset:0
    ds_read_b64_tr_b16 v[102:103], v88 offset:1536
    s_add_u32 m0, s76, 45056
    s_add_u32 s70, s69, s79
    buffer_load_dwordx4 v11, s[52:55], s70 offen lds
    s_add_u32 s79, s79, 110592
    s_cmp_eq_u32 s79, 1990656
    s_cselect_b32 s79, 0, s79
    s_waitcnt lgkmcnt(5)
    v_mfma_f32_32x32x16_bf16 v[48:63], v[112:115], v[120:123], v[48:63]
    ds_read_b64_tr_b16 v[104:105], v89 offset:0
    ds_read_b64_tr_b16 v[106:107], v89 offset:1536
    ds_read_b64_tr_b16 v[108:109], v90 offset:0
    s_cmp_eq_u32 s15, 1
    s_cbranch_scc0 Q_sk34
    s_add_u32 m0, s77, 53248
    s_nop 0
    buffer_load_dwordx4 v12, s[52:55], s70 offen lds
Q_sk34:
    s_waitcnt lgkmcnt(6)
    v_mfma_f32_32x32x16_bf16 v[64:79], v[112:115], v[124:127], v[64:79]
    ds_read_b64_tr_b16 v[110:111], v90 offset:1536
    v_add_u32 v86, 4294950912, v86
    s_waitcnt lgkmcnt(4)
    v_mfma_f32_32x32x16_bf16 v[32:47], v[96:99], v[100:103], v[32:47]
    ds_read_b128 v[112:115], v87
    ds_read_b64_tr_b16 v[116:117], v88 offset:6144
    ds_read_b64_tr_b16 v[118:119], v88 offset:7680
    s_waitcnt lgkmcnt(5)
    v_mfma_f32_32x32x16_bf16 v[48:63], v[96:99], v[104:107], v[48:63]
    ds_read_b64_tr_b16 v[120:121], v89 offset:6144
    ds_read_b64_tr_b16 v[122:123], v89 offset:7680
    ds_read_b64_tr_b16 v[124:125], v90 offset:6144
    s_waitcnt lgkmcnt(6)
    v_mfma_f32_32x32x16_bf16 v[64:79], v[96:99], v[108:111], v[64:79]
    ds_read_b64_tr_b16 v[126:127], v90 offset:7680
    v_add_u32 v87, 4294950912, v87
    v_add_u32 v88, 4294930432, v88
    v_add_u32 v89, 4294930432, v89
    v_add_u32 v90, 4294930432, v90
    s_waitcnt lgkmcnt(4)
    v_mfma_f32_32x32x16_bf16 v[32:47], v[112:115], v[116:119], v[32:47]
    s_waitcnt vmcnt(1)
    s_barrier
    ds_read_b128 v[96:99], v84
    ds_read_b64_tr_b16 v[100:101], v88 offset:0
    ds_read_b64_tr_b16 v[102:103], v88 offset:1536
    s_waitcnt lgkmcnt(5)
    v_mfma_f32_32x32x16_bf16 v[48:63], v[112:115], v[120:123], v[48:63]
    ds_read_b64_tr_b16 v[104:105], v89 offset:0
    ds_read_b64_tr_b16 v[106:107], v89 offset:1536
    ds_read_b64_tr_b16 v[108:109], v90 offset:0
    s_waitcnt lgkmcnt(6)
    v_mfma_f32_32x32x16_bf16 v[64:79], v[112:115], v[124:127], v[64:79]
    ds_read_b64_tr_b16 v[110:111], v90 offset:1536
    s_waitcnt lgkmcnt(4)
    v_mfma_f32_32x32x16_bf16 v[32:47], v[96:99], v[100:103], v[32:47]
    ds_read_b128 v[112:115], v85
    ds_read_b64_tr_b16 v[116:117], v88 offset:6144
    ds_read_b64_tr_b16 v[118:119], v88 offset:7680
    s_waitcnt lgkmcnt(5)
    v_mfma_f32_32x32x16_bf16 v[48:63], v[96:99], v[104:107], v[48:63]
    ds_read_b64_tr_b16 v[120:121], v89 offset:6144
    ds_read_b64_tr_b16 v[122:123], v89 offset:7680
    ds_read_b64_tr_b16 v[124:125], v90 offset:6144
    s_waitcnt lgkmcnt(6)
    v_mfma_f32_32x32x16_bf16 v[64:79], v[96:99], v[108:111], v[64:79]
    ds_read_b64_tr_b16 v[126:127], v90 offset:7680
    v_add_u32 v88, 12288, v88
    v_add_u32 v89, 12288, v89
    v_add_u32 v90, 12288, v90
    s_waitcnt lgkmcnt(4)
    v_mfma_f32_32x32x16_bf16 v[32:47], v[112:115], v[116:119], v[32:47]
    s_waitcnt vmcnt(0)
    s_barrier
    ds_read_b128 v[96:99], v86
    ds_read_b64_tr_b16 v[100:101], v88 offset:0
    ds_read_b64_tr_b16 v[102:103], v88 offset:1536
    s_waitcnt lgkmcnt(5)
    v_mfma_f32_32x32x16_bf16 v[48:63], v[112:115], v[120:123], v[48:63]
    ds_read_b64_tr_b16 v[104:105], v89 offset:0
    ds_read_b64_tr_b16 v[106:107], v89 offset:1536
    ds_read_b64_tr_b16 v[108:109], v90 offset:0
    s_waitcnt lgkmcnt(6)
    v_mfma_f32_32x32x16_bf16 v[64:79], v[112:115], v[124:127], v[64:79]
    ds_read_b64_tr_b16 v[110:111], v90 offset:1536
    s_waitcnt lgkmcnt(4)
    v_mfma_f32_32x32x16_bf16 v[32:47], v[96:99], v[100:103], v[32:47]
    ds_read_b128 v[112:115], v87
    ds_read_b64_tr_b16 v[116:117], v88 offset:6144
    ds_read_b64_tr_b16 v[118:119], v88 offset:7680
    s_waitcnt lgkmcnt(5)
    v_mfma_f32_32x32x16_bf16 v[48:63], v[96:99], v[104:107], v[48:63]
    ds_read_b64_tr_b16 v[120:121], v89 offset:6144
    ds_read_b64_tr_b16 v[122:123], v89 offset:7680
    ds_read_b64_tr_b16 v[124:125], v90 offset:6144
    s_waitcnt lgkmcnt(6)
    v_mfma_f32_32x32x16_bf16 v[64:79], v[96:99], v[108:111], v[64:79]
    ds_read_b64_tr_b16 v[126:127], v90 offset:7680
    s_waitcnt lgkmcnt(4)
    v_mfma_f32_32x32x16_bf16 v[32:47], v[112:115], v[116:119], v[32:47]
    s_waitcnt lgkmcnt(2)
    v_mfma_f32_32x32x16_bf16 v[48:63], v[112:115], v[120:123], v[48:63]
    s_waitcnt lgkmcnt(0)
    v_mfma_f32_32x32x16_bf16 v[64:79], v[112:115], v[124:127], v[64:79]
    s_lshr_b32 s6, s3, 1
    s_mul_i32 s6, s6, 19456
    s_and_b32 s7, s3, 1
    s_lshl_b32 s7, s7, 2
    s_add_u32 s7, s7, s14
    s_mul_i32 s7, s7, 1280
    s_add_u32 s12, s6, s7
    s_add_u32 s12, s12, 9216
    s_nop 3
    v_cvt_pk_bf16_f32 v32, v32, v33
    v_cvt_pk_bf16_f32 v33, v34, v35
    v_cvt_pk_bf16_f32 v34, v36, v37
    v_cvt_pk_bf16_f32 v35, v38, v39
    v_cvt_pk_bf16_f32 v36, v40, v41
    v_cvt_pk_bf16_f32 v37, v42, v43
    v_cvt_pk_bf16_f32 v38, v44, v45
    v_cvt_pk_bf16_f32 v39, v46, v47
    v_xor_b32 v23, 16, v80
    ds_write_b128 v80, v[32:35]
    ds_write_b128 v23, v[36:39]
    ds_read_b128 v[40:43], v22
    ds_read_b128 v[44:47], v22 offset:1024
    v_cvt_pk_bf16_f32 v48, v48, v49
    v_cvt_pk_bf16_f32 v49, v50, v51
    v_cvt_pk_bf16_f32 v50, v52, v53
    v_cvt_pk_bf16_f32 v51, v54, v55
    v_cvt_pk_bf16_f32 v52, v56, v57
    v_cvt_pk_bf16_f32 v53, v58, v59
    v_cvt_pk_bf16_f32 v54, v60, v61
    v_cvt_pk_bf16_f32 v55, v62, v63
    v_xor_b32 v23, 16, v81
    ds_write_b128 v81, v[48:51]
    ds_write_b128 v23, v[52:55]
    ds_read_b128 v[56:59], v22
    ds_read_b128 v[60:63], v22 offset:1024
    s_waitcnt lgkmcnt(4)
    buffer_store_dwordx4 v[40:43], v16, s[60:63], s12 offen sc1
    buffer_store_dwordx4 v[44:47], v17, s[60:63], s12 offen sc1
    v_cvt_pk_bf16_f32 v64, v64, v65
    v_cvt_pk_bf16_f32 v65, v66, v67
    v_cvt_pk_bf16_f32 v66, v68, v69
    v_cvt_pk_bf16_f32 v67, v70, v71
    v_cvt_pk_bf16_f32 v68, v72, v73
    v_cvt_pk_bf16_f32 v69, v74, v75
    v_cvt_pk_bf16_f32 v70, v76, v77
    v_cvt_pk_bf16_f32 v71, v78, v79
    v_xor_b32 v23, 16, v82
    ds_write_b128 v82, v[64:67]
    ds_write_b128 v23, v[68:71]
    ds_read_b128 v[72:75], v22
    ds_read_b128 v[76:79], v22 offset:1024
    s_waitcnt lgkmcnt(4)
    buffer_store_dwordx4 v[56:59], v18, s[60:63], s12 offen sc1
    buffer_store_dwordx4 v[60:63], v19, s[60:63], s12 offen sc1
    s_waitcnt lgkmcnt(0)
    buffer_store_dwordx4 v[72:75], v20, s[60:63], s12 offen sc1
    buffer_store_dwordx4 v[76:79], v21, s[60:63], s12 offen sc1
Q_fin:
    s_cmp_lg_u32 s5, 3
    s_cbranch_scc1 Q_w
    s_load_dword s73, s[42:43], 132
    s_waitcnt lgkmcnt(0)
    s_cmp_ge_u32 s73, 16
    s_cbranch_scc1 Q_wi_c
    s_mov_b32 s80, s42
    s_mov_b32 s81, s43
    s_mov_b32 s82, 256
    s_mov_b32 s83, 0x00020000
    v_mov_b32 v14, 0
    s_mov_b32 exec_lo, 1
    s_mov_b32 exec_hi, 0
    s_mov_b32 s72, 0
Q_wi:
    buffer_load_dword v15, v14, s[80:83], 0 offen offset:132 sc1
    s_waitcnt vmcnt(0)
    v_cmp_gt_u32 vcc, 16, v15
    s_add_u32 s72, s72, 1
    s_cbranch_vccz Q_wi_ok
    s_sleep 8
    s_cmp_lt_u32 s72, 0x100000
    s_cbranch_scc1 Q_wi
Q_wi_ok:
    s_mov_b64 exec, -1
Q_wi_c:
    s_mul_i32 s6, s4, 43
    s_lshr_b32 s6, s6, 7
    s_mul_i32 s6, s6, 3
    s_sub_u32 s6, s4, s6
    s_lshl_b32 s74, s6, 8
    s_sub_u32 s6, s4, s6
    s_mul_i32 s6, s6, 43
    s_lshr_b32 s6, s6, 7
    s_lshl_b32 s6, s6, 4
    s_add_u32 s6, s6, s3
    s_lshl_b32 s6, s6, 2
    s_add_u32 s74, s74, s6
    s_add_u32 s74, s74, 18011136
    v_mul_u32_u24 v14, 768, v0
    v_mov_b32 v15, 1
    s_waitcnt vmcnt(0)
    s_barrier
    s_mov_b64 exec, 0xff
    buffer_store_dword v15, v14, s[60:63], s74 offen sc1
    s_branch G2x
Q_w:
    s_waitcnt vmcnt(0)
    s_barrier
    s_branch G2
I_go:
    s_lshl_b32 s6, s3, 3
    s_add_u32 s6, s6, s5
    s_mul_i32 s12, s6, 1152
    s_add_u32 s12, s12, 17858560
    s_lshr_b32 s7, s6, 2
    s_mul_i32 s7, s7, 155648
    s_and_b32 s6, s6, 3
    s_mul_i32 s6, s6, 38912
    s_add_u32 s6, s6, s7
    s_add_u32 s6, s6, 10368
    s_add_u32 s7, s6, 19456
    v_lshrrev_b32 v1, 3, v0
    v_mul_u32_u24 v1, 1280, v1
    v_and_b32 v2, 7, v0
    v_lshl_add_u32 v1, v2, 4, v1
    v_bfe_u32 v2, v0, 2, 1
    v_subrev_u32 v2, 1, v2
    v_and_b32 v4, 0x3f803f80, v2
    v_mov_b32 v5, v4
    v_mov_b32 v6, v4
    v_mov_b32 v7, v4
    v_lshlrev_b32 v3, 4, v0
    v_mov_b32 v8, -1
    v_mov_b32 v9, -1
    v_mov_b32 v10, -1
    v_mov_b32 v11, -1
    s_mov_b32 s60, s44
    s_mov_b32 s61, s45
    s_mov_b32 s62, 18021376
    s_mov_b32 s63, 0x00020000
    s_mov_b32 s80, s42
    s_mov_b32 s81, s43
    s_mov_b32 s82, 256
    s_mov_b32 s83, 0x00020000
    buffer_store_dwordx4 v[4:7], v1, s[60:63], s6 offen sc1
    buffer_store_dwordx4 v[4:7], v1, s[60:63], s7 offen sc1
    buffer_store_dwordx4 v[8:11], v3, s[60:63], s12 offen sc1
    s_mov_b64 exec, 0xff
    buffer_store_dwordx4 v[8:11], v3, s[60:63], s12 offen offset:1024 sc1
    s_cmp_ge_u32 s3, 2
    s_cbranch_scc1 I_nz
    s_mov_b64 exec, -1
    v_mov_b32 v16, 0
    v_mov_b32 v17, 0
    v_mov_b32 v18, 0
    v_mov_b32 v19, 0
    s_lshl_b32 s6, s3, 3
    s_add_u32 s6, s6, s5
    s_lshl_b32 s6, s6, 10
    s_add_u32 s6, s6, 18006016
    buffer_store_dwordx4 v[16:19], v3, s[60:63], s6 offen sc1
I_nz:
    s_mov_b64 exec, -1
    s_waitcnt vmcnt(0)
    s_barrier
    s_cmp_lg_u32 s5, 3
    s_cbranch_scc1 I_na
    s_mov_b64 exec, 1
    v_mov_b32 v14, 0
    v_mov_b32 v15, 1
    buffer_atomic_add v15, v14, s[80:83], 0 offen offset:132 sc1
I_na:
    s_mov_b64 exec, -1
    s_lshl_b32 s6, s3, 3
    s_add_u32 s6, s6, s5
    v_lshlrev_b32 v12, 7, v0
    s_and_b32 s7, s6, 7
    s_mul_i32 s12, s7, 19456
    s_bfe_u32 s7, s6, 0x10003
    s_mul_i32 s7, s7, 1708032
    s_add_u32 s12, s12, s7
    s_bfe_u32 s7, s6, 0x10004
    s_mul_i32 s7, s7, 4980736
    s_add_u32 s12, s12, s7
    s_add_u32 s12, s12, 1560576
    v_min_u32 v13, 3968, v12
    s_cmp_lt_u32 s6, 32
    s_cbranch_scc0 I_nt
    buffer_load_dword v20, v13, s[60:63], s12 offen sc1
I_nt:
    s_waitcnt vmcnt(0)
    s_branch G2x
A_go:
    s_bfe_u32 s7, s2, 0x50003
    s_cmp_lt_u32 s7, 20
    s_cbranch_scc1 P_x
    s_sub_u32 s12, s7, 20
    s_lshl_b32 s12, s12, 3
    s_add_u32 s12, s12, s5
    v_mul_u32_u24 v1, 1152, v0
    v_mul_u32_u24 v2, 3456, v0
    s_waitcnt lgkmcnt(0)
    s_mov_b32 s48, s16
    s_mov_b32 s49, s17
    s_mov_b32 s50, 2359296
    s_mov_b32 s51, 0x00020000
    s_mov_b32 s52, s18
    s_mov_b32 s53, s19
    s_mov_b32 s54, 1990656
    s_mov_b32 s55, 0x00020000
    s_cmp_lt_u32 s12, 81
    s_cbranch_scc1 P_nb
    s_add_u32 s13, s12, 111
    s_mul_i32 s14, s13, 2850
    s_lshr_b32 s14, s14, 16
    s_mul_i32 s15, s14, 23
    s_sub_u32 s15, s13, s15
    s_cmp_ge_u32 s13, 207
    s_cbranch_scc1 P_nb
    s_cmp_lt_u32 s15, 8
    s_cbranch_scc0 P_wb
    s_lshr_b32 s68, s6, 1
    s_lshl_b32 s68, s68, 3
    s_add_u32 s15, s15, s68
    s_mul_i32 s15, s15, 73728
    s_lshl_b32 s14, s14, 7
    s_add_u32 s15, s15, s14
    buffer_load_dword v118, v1, s[48:51], s15 offen
    s_branch P_nb
P_wb:
    s_and_b32 s69, s6, 1
    s_mul_i32 s69, s69, 15
    s_add_u32 s15, s15, s69
    s_sub_u32 s15, s15, 8
    s_mul_i32 s14, s14, 221184
    s_cmp_lt_u32 s15, 27
    s_cselect_b32 s14, s14, 2130706432
    s_lshl_b32 s15, s15, 7
    s_add_u32 s15, s15, s14
    buffer_load_dword v118, v2, s[52:55], s15 offen
P_nb:
    s_lshr_b32 s68, s6, 1
    s_mul_i32 s68, s68, 589824
    s_and_b32 s71, s6, 1
    s_mul_i32 s71, s71, 331776
    v_min_u32 v2, 31, v0
    v_mul_u32_u24 v2, 1152, v2
P_x:
    s_and_b32 s3, s2, 7
    s_lshl_b32 s3, s3, 2
    s_bfe_u32 s6, s2, 0x20003
    s_add_u32 s3, s3, s6
    s_bfe_u32 s4, s2, 0x30005
    s_mul_i32 s75, s3, 155648
    s_and_b32 s76, s5, 3
    s_lshr_b32 s77, s5, 2
    s_mul_i32 s12, s77, 77824
    s_add_u32 s12, s12, s75
    s_lshl_b32 s13, s76, 10
    s_add_u32 s78, s76, 16
    s_min_u32 s78, s78, 18
    s_lshl_b32 s78, s78, 10
    v_lshlrev_b32 v3, 4, v0
    v_add_u32 v6, s13, v3
    v_add_u32 v7, s78, v3
    v_and_b32 v1, 31, v0
    v_lshrrev_b32 v2, 5, v0
    s_mov_b32 s8, 0
    s_mov_b32 s9, -1
    s_mov_b32 s10, 0xffff0000
    s_mov_b32 s11, 0xffff0000
    s_mul_i32 s14, s4, 19456
    s_add_u32 s14, s14, s75
    s_add_u32 s14, s14, 4980736
    v_lshlrev_b32 v16, 4, v1
    v_lshl_add_u32 v17, v2, 12, v16
    v_add_u32 v17, s13, v17
    s_lshr_b32 s6, s76, 1
    s_lshl_b32 s6, s6, 9
    s_and_b32 s7, s76, 1
    s_lshl_b32 s7, s7, 3
    s_add_u32 s6, s6, s7
    s_add_u32 s6, s6, 8192
    v_add_u32 v16, s6, v16
    s_mul_i32 s6, s77, 19456
    s_add_u32 s13, s13, s6
    s_add_u32 s78, s78, s6
    s_waitcnt lgkmcnt(0)
    s_mov_b32 s60, s44
    s_mov_b32 s61, s45
    s_mov_b32 s62, 18021376
    s_mov_b32 s63, 0x00020000
    v_and_b32 v18, 19, v1
    v_and_b32 v19, 4, v1
    v_lshl_add_u32 v18, v19, 1, v18
    v_and_b32 v19, 8, v1
    v_lshrrev_b32 v19, 1, v19
    v_add_u32 v18, v18, v19
    v_lshl_add_u32 v9, v18, 4, s6
    v_lshl_add_u32 v8, v2, 12, v9
    v_add_u32 v9, 8192, v9
    v_min_u32 v19, 19, v1
    v_cmp_gt_u32 vcc, 16, v1
    v_cmp_eq_u32 s[70:71], 28, v1
    s_add_u32 s6, s6, 9216
    v_cndmask_b32 v19, v19, v18, vcc
    s_nop 0
    v_cndmask_b32 v19, v19, 18, s[70:71]
    v_bfe_u32 v20, v19, 2, 2
    v_xor_b32 v20, v20, v2
    v_lshlrev_b32 v20, 4, v20
    v_lshl_add_u32 v10, v19, 6, v20
    v_add_u32 v10, s6, v10
    v_xor_b32 v11, 32, v10
    s_mov_b32 s70, 1051597459
    v_mov_b32 v48, 0
    v_mov_b32 v49, 0
    v_mov_b32 v50, 0
    v_mov_b32 v51, 0
    v_mov_b32 v52, 0
    v_mov_b32 v53, 0
    v_mov_b32 v54, 0
    v_mov_b32 v55, 0
    v_mov_b32 v56, 0
    v_mov_b32 v57, 0
    v_mov_b32 v58, 0
    v_mov_b32 v59, 0
    v_mov_b32 v60, 0
    v_mov_b32 v61, 0
    v_mov_b32 v62, 0
    v_mov_b32 v63, 0
    v_mov_b32 v64, 0
    v_mov_b32 v65, 0
    v_mov_b32 v66, 0
    v_mov_b32 v67, 0
    v_mov_b32 v68, 0
    v_mov_b32 v69, 0
    v_mov_b32 v70, 0
    v_mov_b32 v71, 0
    v_mov_b32 v72, 0
    v_mov_b32 v73, 0
    v_mov_b32 v74, 0
    v_mov_b32 v75, 0
    v_mov_b32 v76, 0
    v_mov_b32 v77, 0
    v_mov_b32 v78, 0
    v_mov_b32 v79, 0
    s_bfe_u32 s7, s2, 0x50003
    s_lshl_b32 s7, s7, 3
    s_add_u32 s7, s7, s5
    s_cmp_ge_u32 s7, 81
    s_cselect_b32 s48, s34, s32
    s_cselect_b32 s49, s35, s33
    s_cselect_b32 s69, 81, 0
    s_cmp_ge_u32 s7, 162
    s_cselect_b32 s48, s20, s48
    s_cselect_b32 s49, s21, s49
    s_cselect_b32 s69, 162, s69
    s_sub_u32 s7, s7, s69
    s_lshl_b32 s79, s7, 13
    s_mov_b32 s50, 663552
    s_mov_b32 s51, 0x00020000
    v_lshlrev_b32 v4, 7, v0
    s_mov_b32 s73, 0xffff0000
    s_cmp_lg_u32 s5, 0
    s_cbranch_scc1 A_w
    s_sleep 112
    s_sleep 127
    s_load_dword s73, s[42:43], 132
    s_waitcnt lgkmcnt(0)
    s_cmp_ge_u32 s73, 16
    s_cbranch_scc1 A_wi_c
    s_mov_b32 s80, s42
    s_mov_b32 s81, s43
    s_mov_b32 s82, 256
    s_mov_b32 s83, 0x00020000
    v_mov_b32 v14, 0
    s_mov_b32 exec_lo, 1
    s_mov_b32 exec_hi, 0
    s_mov_b32 s72, 0
A_wi:
    buffer_load_dword v15, v14, s[80:83], 0 offen offset:132 sc1
    s_waitcnt vmcnt(0)
    v_cmp_gt_u32 vcc, 16, v15
    s_add_u32 s72, s72, 1
    s_cbranch_vccz A_wi_ok
    s_sleep 8
    s_cmp_lt_u32 s72, 0x100000
    s_cbranch_scc1 A_wi
A_wi_ok:
    s_mov_b64 exec, -1
A_wi_c:
    s_mov_b32 s73, 0xffff0000
    s_and_b32 s74, s2, 7
    s_mul_i32 s74, s74, 768
    s_add_u32 s74, s74, 18011136
    s_cmp_gt_u32 s3, 10
    s_addc_u32 s6, 0, 0
    s_cmp_gt_u32 s3, 21
    s_addc_u32 s6, s6, 0
    s_lshl_b32 s6, s6, 8
    s_cmp_ge_u32 s3, 10
    s_addc_u32 s7, 0, 0
    s_cmp_ge_u32 s3, 21
    s_addc_u32 s7, s7, 0
    s_lshl_b32 s7, s7, 8
    s_add_u32 s71, s74, s7
    s_add_u32 s74, s74, s6
    v_lshlrev_b32 v14, 2, v0
    s_lshl_b32 s6, s4, 1
    s_lshl_b32 s80, 3, s6
    s_or_b32 s80, s80, 0x03030000
    s_movk_i32 s81, 0x303
    s_mov_b64 exec, s[80:81]
    s_mov_b32 s72, 0
A_wq:
    buffer_load_dword v15, v14, s[60:63], s74 offen sc1
    s_waitcnt vmcnt(0)
    v_cmp_gt_u32 vcc, 1, v15
    s_add_u32 s72, s72, 1
    s_cbranch_vccz A_wq_ok
    s_sleep 1
    s_cmp_lt_u32 s72, 0x100000
    s_cbranch_scc1 A_wq
A_wq_ok:
    s_mov_b64 exec, -1
    s_cmp_eq_u32 s71, s74
    s_cbranch_scc1 A_w
    s_mov_b64 exec, s[80:81]
    s_mov_b32 s72, 0
A_wr:
    buffer_load_dword v15, v14, s[60:63], s71 offen sc1
    s_waitcnt vmcnt(0)
    v_cmp_gt_u32 vcc, 1, v15
    s_add_u32 s72, s72, 1
    s_cbranch_vccz A_wr_ok
    s_sleep 1
    s_cmp_lt_u32 s72, 0x100000
    s_cbranch_scc1 A_wr
A_wr_ok:
    s_mov_b64 exec, -1
A_w:
    s_waitcnt vmcnt(0)
    s_barrier
    s_setprio 3
    buffer_load_dwordx4 v[116:119], v17, s[60:63], s14 offen sc1
    buffer_load_dwordx4 v[120:123], v17, s[60:63], s14 offen offset:512 sc1
    buffer_load_dwordx2 v[124:125], v16, s[60:63], s14 offen sc1
    s_add_u32 m0, s13, 0
    s_add_u32 s7, s12, 0
    buffer_load_dwordx4 v6, s[60:63], s7 offen sc1 lds
    s_add_u32 m0, s13, 4096
    s_add_u32 s7, s12, 4096
    buffer_load_dwordx4 v6, s[60:63], s7 offen sc1 lds
    s_add_u32 m0, s13, 8192
    s_add_u32 s7, s12, 8192
    buffer_load_dwordx4 v6, s[60:63], s7 offen sc1 lds
    s_add_u32 m0, s13, 12288
    s_add_u32 s7, s12, 12288
    buffer_load_dwordx4 v6, s[60:63], s7 offen sc1 lds
    s_add_u32 m0, s78, 0
    s_add_u32 s7, s12, 0
    buffer_load_dwordx4 v7, s[60:63], s7 offen sc1 lds
    s_cmp_lg_u32 s5, 0
    s_cbranch_scc1 A_w2
    v_lshlrev_b32 v14, 2, v0
    s_mov_b32 exec_lo, 4294967295
    s_mov_b32 exec_hi, 65535
    s_mov_b32 s72, 0
A_ws:
    buffer_load_dword v15, v14, s[60:63], s74 offen sc1
    s_waitcnt vmcnt(0)
    v_cmp_gt_u32 vcc, 1, v15
    s_add_u32 s72, s72, 1
    s_cbranch_vccz A_ws_ok
    s_sleep 1
    s_cmp_lt_u32 s72, 0x100000
    s_cbranch_scc1 A_ws
A_ws_ok:
    s_mov_b64 exec, -1
    s_cmp_eq_u32 s71, s74
    s_cbranch_scc1 A_w2
    s_mov_b32 exec_lo, 4294967295
    s_mov_b32 exec_hi, 65535
    s_mov_b32 s72, 0
A_wt:
    buffer_load_dword v15, v14, s[60:63], s71 offen sc1
    s_waitcnt vmcnt(0)
    v_cmp_gt_u32 vcc, 1, v15
    s_add_u32 s72, s72, 1
    s_cbranch_vccz A_wt_ok
    s_sleep 1
    s_cmp_lt_u32 s72, 0x100000
    s_cbranch_scc1 A_wt
A_wt_ok:
    s_mov_b64 exec, -1
A_w2:
    s_waitcnt vmcnt(5)
    v_mov_b32 v12, v125
    v_lshlrev_b32 v18, 16, v116
    v_and_b32 v19, s73, v116
    v_mul_f32 v18, s70, v18
    v_mul_f32 v19, s70, v19
    v_cvt_pk_bf16_f32 v116, v18, v19
    v_lshlrev_b32 v18, 16, v117
    v_and_b32 v19, s73, v117
    v_mul_f32 v18, s70, v18
    v_mul_f32 v19, s70, v19
    v_cvt_pk_bf16_f32 v117, v18, v19
    v_lshlrev_b32 v18, 16, v118
    v_and_b32 v19, s73, v118
    v_mul_f32 v18, s70, v18
    v_mul_f32 v19, s70, v19
    v_cvt_pk_bf16_f32 v118, v18, v19
    v_lshlrev_b32 v18, 16, v119
    v_and_b32 v19, s73, v119
    v_mul_f32 v18, s70, v18
    v_mul_f32 v19, s70, v19
    v_cvt_pk_bf16_f32 v119, v18, v19
    v_lshlrev_b32 v18, 16, v124
    v_and_b32 v19, s73, v124
    v_mul_f32 v18, s70, v18
    v_mul_f32 v19, s70, v19
    v_cvt_pk_bf16_f32 v124, v18, v19
    v_lshlrev_b32 v18, 16, v120
    v_and_b32 v19, s73, v120
    v_mul_f32 v18, s70, v18
    v_mul_f32 v19, s70, v19
    v_cvt_pk_bf16_f32 v120, v18, v19
    v_lshlrev_b32 v18, 16, v121
    v_and_b32 v19, s73, v121
    v_mul_f32 v18, s70, v18
    v_mul_f32 v19, s70, v19
    v_cvt_pk_bf16_f32 v121, v18, v19
    v_lshlrev_b32 v18, 16, v122
    v_and_b32 v19, s73, v122
    v_mul_f32 v18, s70, v18
    v_mul_f32 v19, s70, v19
    v_cvt_pk_bf16_f32 v122, v18, v19
    v_lshlrev_b32 v18, 16, v123
    v_and_b32 v19, s73, v123
    v_mul_f32 v18, s70, v18
    v_mul_f32 v19, s70, v19
    v_cvt_pk_bf16_f32 v123, v18, v19
    v_lshlrev_b32 v18, 16, v12
    v_and_b32 v19, s73, v12
    v_mul_f32 v18, s70, v18
    v_mul_f32 v19, s70, v19
    v_cvt_pk_bf16_f32 v12, v18, v19
    v_cndmask_b32 v124, v124, 0, s[8:9]
    v_mov_b32 v125, 0
    v_mov_b32 v126, 0
    v_mov_b32 v127, v124
    v_cndmask_b32 v12, v12, 0, s[8:9]
    v_mov_b32 v13, 0
    v_mov_b32 v14, 0
    v_mov_b32 v15, v12
    s_waitcnt vmcnt(0)
    s_barrier
    ds_read_b128 v[88:91], v8 offset:0
    ds_read_b128 v[96:99], v9 offset:0
    ds_read_b128 v[92:95], v8 offset:512
    ds_read_b128 v[100:103], v10 offset:0
    ds_read_b128 v[104:107], v11 offset:0
    s_waitcnt lgkmcnt(3)
    v_mfma_f32_32x32x16_bf16 v[16:31], v[88:91], v[116:119], 0
    v_mfma_f32_32x32x8bf16_1k v[16:31], v[96:97], v[124:125], v[16:31]
    s_waitcnt lgkmcnt(0)
    s_nop 7
.p2align 3
    v_mfma_f32_32x32x16_bf16 v[32:47], v[88:91], v[120:123], 0
    ds_read_b128 v[88:91], v8 offset:1024
    ds_read_b128 v[108:111], v10 offset:1280
    v_exp_f32 v16, v16
    v_exp_f32 v17, v17
    v_exp_f32 v18, v18
    v_exp_f32 v19, v19
    ds_read_b128 v[112:115], v11 offset:1280
    v_exp_f32 v20, v20
    v_exp_f32 v21, v21
    v_exp_f32 v22, v22
    v_exp_f32 v23, v23
    v_mfma_f32_32x32x8bf16_1k v[32:47], v[96:97], v[12:13], v[32:47]
    s_add_u32 m0, s13, 38912
    s_add_u32 s7, s12, 19456
    buffer_load_dwordx4 v6, s[60:63], s7 offen sc1 lds
    v_exp_f32 v24, v24
    v_exp_f32 v25, v25
    v_cvt_pk_bf16_f32 v80, v16, v17
    v_cvt_pk_bf16_f32 v81, v18, v19
    v_cvt_pk_bf16_f32 v82, v20, v21
    v_cvt_pk_bf16_f32 v83, v22, v23
    v_exp_f32 v26, v26
    v_exp_f32 v27, v27
    v_mfma_f32_32x32x16_bf16 v[48:63], v[100:103], v[80:83], v[48:63]
    v_exp_f32 v28, v28
    v_exp_f32 v29, v29
    v_exp_f32 v30, v30
    v_exp_f32 v31, v31
    v_cvt_pk_bf16_f32 v84, v24, v25
    v_cvt_pk_bf16_f32 v85, v26, v27
    v_cvt_pk_bf16_f32 v86, v28, v29
    v_cvt_pk_bf16_f32 v87, v30, v31
    v_mfma_f32_32x32x16_bf16 v[16:31], v[92:95], v[116:119], 0
    v_exp_f32 v32, v32
    v_exp_f32 v33, v33
    v_exp_f32 v34, v34
    v_exp_f32 v35, v35
    v_mfma_f32_32x32x16_bf16 v[48:63], v[104:107], v[84:87], v[48:63]
    v_exp_f32 v36, v36
    v_exp_f32 v37, v37
    v_exp_f32 v38, v38
    v_exp_f32_e64 v39, v39
    s_waitcnt lgkmcnt(0)
    v_mfma_f32_32x32x8bf16_1k v[16:31], v[96:97], v[126:127], v[16:31]
    s_add_u32 m0, s13, 43008
    s_add_u32 s7, s12, 23552
    buffer_load_dwordx4 v6, s[60:63], s7 offen sc1 lds
    v_exp_f32 v40, v40
    v_exp_f32 v41, v41
    v_cvt_pk_bf16_f32 v80, v32, v33
    v_cvt_pk_bf16_f32 v81, v34, v35
    v_cvt_pk_bf16_f32 v82, v36, v37
    v_cvt_pk_bf16_f32 v83, v38, v39
    v_exp_f32 v42, v42
    v_exp_f32 v43, v43
    v_mfma_f32_32x32x16_bf16 v[64:79], v[100:103], v[80:83], v[64:79]
    v_exp_f32 v44, v44
    v_exp_f32 v45, v45
    v_exp_f32 v46, v46
    v_exp_f32 v47, v47
    v_cvt_pk_bf16_f32 v84, v40, v41
    v_cvt_pk_bf16_f32 v85, v42, v43
    v_cvt_pk_bf16_f32 v86, v44, v45
    v_cvt_pk_bf16_f32 v87, v46, v47
    v_mfma_f32_32x32x16_bf16 v[32:47], v[92:95], v[120:123], 0
    ds_read_b128 v[92:95], v8 offset:1536
    ds_read_b128 v[100:103], v10 offset:2560
    v_exp_f32 v16, v16
    v_exp_f32 v17, v17
    v_exp_f32 v18, v18
    v_exp_f32 v19, v19
    v_mfma_f32_32x32x16_bf16 v[64:79], v[104:107], v[84:87], v[64:79]
    ds_read_b128 v[104:107], v11 offset:2560
    v_exp_f32 v20, v20
    v_exp_f32 v21, v21
    v_exp_f32 v22, v22
    v_exp_f32 v23, v23
    v_mfma_f32_32x32x8bf16_1k v[32:47], v[96:97], v[14:15], v[32:47]
    s_add_u32 m0, s13, 47104
    s_add_u32 s7, s12, 27648
    buffer_load_dwordx4 v6, s[60:63], s7 offen sc1 lds
    v_exp_f32 v24, v24
    v_exp_f32 v25, v25
    v_cvt_pk_bf16_f32 v80, v16, v17
    v_cvt_pk_bf16_f32 v81, v18, v19
    v_cvt_pk_bf16_f32 v82, v20, v21
    v_cvt_pk_bf16_f32 v83, v22, v23
    v_exp_f32 v26, v26
    v_exp_f32 v27, v27
    v_mfma_f32_32x32x16_bf16 v[48:63], v[108:111], v[80:83], v[48:63]
    v_exp_f32 v28, v28
    v_exp_f32 v29, v29
    v_exp_f32 v30, v30
    v_exp_f32 v31, v31
    v_cvt_pk_bf16_f32 v84, v24, v25
    v_cvt_pk_bf16_f32 v85, v26, v27
    v_cvt_pk_bf16_f32 v86, v28, v29
    v_cvt_pk_bf16_f32 v87, v30, v31
    v_mfma_f32_32x32x16_bf16 v[16:31], v[88:91], v[116:119], 0
    v_exp_f32 v32, v32
    v_exp_f32 v33, v33
    v_exp_f32 v34, v34
    v_exp_f32 v35, v35
    v_mfma_f32_32x32x16_bf16 v[48:63], v[112:115], v[84:87], v[48:63]
    v_exp_f32 v36, v36
    v_exp_f32 v37, v37
    v_exp_f32 v38, v38
    v_exp_f32_e64 v39, v39
    s_waitcnt lgkmcnt(0)
    v_mfma_f32_32x32x8bf16_1k v[16:31], v[98:99], v[124:125], v[16:31]
    s_add_u32 m0, s13, 51200
    s_add_u32 s7, s12, 31744
    buffer_load_dwordx4 v6, s[60:63], s7 offen sc1 lds
    v_exp_f32 v40, v40
    v_exp_f32 v41, v41
    v_cvt_pk_bf16_f32 v80, v32, v33
    v_cvt_pk_bf16_f32 v81, v34, v35
    v_cvt_pk_bf16_f32 v82, v36, v37
    v_cvt_pk_bf16_f32 v83, v38, v39
    v_exp_f32 v42, v42
    v_exp_f32 v43, v43
    v_mfma_f32_32x32x16_bf16 v[64:79], v[108:111], v[80:83], v[64:79]
    v_exp_f32 v44, v44
    v_exp_f32 v45, v45
    v_exp_f32 v46, v46
    v_exp_f32 v47, v47
    v_cvt_pk_bf16_f32 v84, v40, v41
    v_cvt_pk_bf16_f32 v85, v42, v43
    v_cvt_pk_bf16_f32 v86, v44, v45
    v_cvt_pk_bf16_f32 v87, v46, v47
    v_mfma_f32_32x32x16_bf16 v[32:47], v[88:91], v[120:123], 0
    ds_read_b128 v[88:91], v8 offset:2048
    ds_read_b128 v[108:111], v10 offset:3840
    v_exp_f32 v16, v16
    v_exp_f32 v17, v17
    v_exp_f32 v18, v18
    v_exp_f32 v19, v19
    v_mfma_f32_32x32x16_bf16 v[64:79], v[112:115], v[84:87], v[64:79]
    ds_read_b128 v[112:115], v11 offset:3840
    v_exp_f32 v20, v20
    v_exp_f32 v21, v21
    v_exp_f32 v22, v22
    v_exp_f32 v23, v23
    v_mfma_f32_32x32x8bf16_1k v[32:47], v[98:99], v[12:13], v[32:47]
    s_add_u32 m0, s78, 38912
    s_add_u32 s7, s12, 19456
    buffer_load_dwordx4 v7, s[60:63], s7 offen sc1 lds
    v_exp_f32 v24, v24
    v_exp_f32 v25, v25
    v_cvt_pk_bf16_f32 v80, v16, v17
    v_cvt_pk_bf16_f32 v81, v18, v19
    v_cvt_pk_bf16_f32 v82, v20, v21
    v_cvt_pk_bf16_f32 v83, v22, v23
    v_exp_f32 v26, v26
    v_exp_f32 v27, v27
    v_mfma_f32_32x32x16_bf16 v[48:63], v[100:103], v[80:83], v[48:63]
    v_exp_f32 v28, v28
    v_exp_f32 v29, v29
    v_exp_f32 v30, v30
    v_exp_f32 v31, v31
    v_cvt_pk_bf16_f32 v84, v24, v25
    v_cvt_pk_bf16_f32 v85, v26, v27
    v_cvt_pk_bf16_f32 v86, v28, v29
    v_cvt_pk_bf16_f32 v87, v30, v31
    v_mfma_f32_32x32x16_bf16 v[16:31], v[92:95], v[116:119], 0
    v_exp_f32 v32, v32
    v_exp_f32 v33, v33
    v_exp_f32 v34, v34
    v_exp_f32 v35, v35
    v_mfma_f32_32x32x16_bf16 v[48:63], v[104:107], v[84:87], v[48:63]
    v_exp_f32 v36, v36
    v_exp_f32 v37, v37
    v_exp_f32 v38, v38
    v_exp_f32 v39, v39
    s_waitcnt lgkmcnt(0)
    s_setprio 2
    v_mfma_f32_32x32x8bf16_1k v[16:31], v[98:99], v[126:127], v[16:31]
    v_exp_f32 v40, v40
    v_exp_f32 v41, v41
    v_cvt_pk_bf16_f32 v80, v32, v33
    v_cvt_pk_bf16_f32 v81, v34, v35
    v_cvt_pk_bf16_f32 v82, v36, v37
    v_cvt_pk_bf16_f32 v83, v38, v39
    v_exp_f32 v42, v42
    v_exp_f32 v43, v43
    v_mfma_f32_32x32x16_bf16 v[64:79], v[100:103], v[80:83], v[64:79]
    v_exp_f32 v44, v44
    v_exp_f32 v45, v45
    v_exp_f32 v46, v46
    v_exp_f32 v47, v47
    v_cvt_pk_bf16_f32 v84, v40, v41
    v_cvt_pk_bf16_f32 v85, v42, v43
    v_cvt_pk_bf16_f32 v86, v44, v45
    v_cvt_pk_bf16_f32 v87, v46, v47
    v_mfma_f32_32x32x16_bf16 v[32:47], v[92:95], v[120:123], 0
    ds_read_b128 v[92:95], v8 offset:2560
    ds_read_b128 v[100:103], v10 offset:5120
    v_exp_f32 v16, v16
    v_exp_f32 v17, v17
    v_exp_f32 v18, v18
    v_exp_f32 v19, v19
    v_mfma_f32_32x32x16_bf16 v[64:79], v[104:107], v[84:87], v[64:79]
    ds_read_b128 v[104:107], v11 offset:5120
    v_exp_f32 v20, v20
    v_exp_f32 v21, v21
    v_exp_f32 v22, v22
    v_exp_f32 v23, v23
    v_mfma_f32_32x32x8bf16_1k v[32:47], v[98:99], v[14:15], v[32:47]
    ds_read_b128 v[96:99], v9 offset:512
    v_exp_f32 v24, v24
    v_exp_f32 v25, v25
    v_cvt_pk_bf16_f32 v80, v16, v17
    v_cvt_pk_bf16_f32 v81, v18, v19
    v_cvt_pk_bf16_f32 v82, v20, v21
    v_cvt_pk_bf16_f32 v83, v22, v23
    v_exp_f32 v26, v26
    v_exp_f32 v27, v27
    v_mfma_f32_32x32x16_bf16 v[48:63], v[108:111], v[80:83], v[48:63]
    v_exp_f32 v28, v28
    v_exp_f32 v29, v29
    v_exp_f32 v30, v30
    v_exp_f32 v31, v31
    v_cvt_pk_bf16_f32 v84, v24, v25
    v_cvt_pk_bf16_f32 v85, v26, v27
    v_cvt_pk_bf16_f32 v86, v28, v29
    v_cvt_pk_bf16_f32 v87, v30, v31
    v_mfma_f32_32x32x16_bf16 v[16:31], v[88:91], v[116:119], 0
    v_exp_f32 v32, v32
    v_exp_f32 v33, v33
    v_exp_f32 v34, v34
    v_exp_f32 v35, v35
    v_mfma_f32_32x32x16_bf16 v[48:63], v[112:115], v[84:87], v[48:63]
    v_exp_f32 v36, v36
    v_exp_f32 v37, v37
    v_exp_f32 v38, v38
    v_exp_f32_e64 v39, v39
    s_waitcnt lgkmcnt(0)
    v_mfma_f32_32x32x8bf16_1k v[16:31], v[96:97], v[124:125], v[16:31]
    v_exp_f32 v40, v40
    v_exp_f32 v41, v41
    v_cvt_pk_bf16_f32 v80, v32, v33
    v_cvt_pk_bf16_f32 v81, v34, v35
    v_cvt_pk_bf16_f32 v82, v36, v37
    v_cvt_pk_bf16_f32 v83, v38, v39
    v_exp_f32 v42, v42
    v_exp_f32 v43, v43
    v_mfma_f32_32x32x16_bf16 v[64:79], v[108:111], v[80:83], v[64:79]
    v_exp_f32 v44, v44
    v_exp_f32 v45, v45
    v_exp_f32 v46, v46
    v_exp_f32 v47, v47
    v_cvt_pk_bf16_f32 v84, v40, v41
    v_cvt_pk_bf16_f32 v85, v42, v43
    v_cvt_pk_bf16_f32 v86, v44, v45
    v_cvt_pk_bf16_f32 v87, v46, v47
    v_mfma_f32_32x32x16_bf16 v[32:47], v[88:91], v[120:123], 0
    ds_read_b128 v[88:91], v8 offset:3072
    ds_read_b128 v[108:111], v10 offset:6400
    v_exp_f32 v16, v16
    v_exp_f32 v17, v17
    v_exp_f32 v18, v18
    v_exp_f32 v19, v19
    v_mfma_f32_32x32x16_bf16 v[64:79], v[112:115], v[84:87], v[64:79]
    ds_read_b128 v[112:115], v11 offset:6400
    v_exp_f32 v20, v20
    v_exp_f32 v21, v21
    v_exp_f32 v22, v22
    v_exp_f32 v23, v23
    v_mfma_f32_32x32x8bf16_1k v[32:47], v[96:97], v[12:13], v[32:47]
    v_exp_f32 v24, v24
    v_exp_f32 v25, v25
    v_cvt_pk_bf16_f32 v80, v16, v17
    v_cvt_pk_bf16_f32 v81, v18, v19
    v_cvt_pk_bf16_f32 v82, v20, v21
    v_cvt_pk_bf16_f32 v83, v22, v23
    v_exp_f32 v26, v26
    v_exp_f32 v27, v27
    v_mfma_f32_32x32x16_bf16 v[48:63], v[100:103], v[80:83], v[48:63]
    v_exp_f32 v28, v28
    v_exp_f32 v29, v29
    v_exp_f32 v30, v30
    v_exp_f32 v31, v31
    v_cvt_pk_bf16_f32 v84, v24, v25
    v_cvt_pk_bf16_f32 v85, v26, v27
    v_cvt_pk_bf16_f32 v86, v28, v29
    v_cvt_pk_bf16_f32 v87, v30, v31
    v_mfma_f32_32x32x16_bf16 v[16:31], v[92:95], v[116:119], 0
    v_exp_f32 v32, v32
    v_exp_f32 v33, v33
    v_exp_f32 v34, v34
    v_exp_f32 v35, v35
    v_mfma_f32_32x32x16_bf16 v[48:63], v[104:107], v[84:87], v[48:63]
    v_exp_f32 v36, v36
    v_exp_f32 v37, v37
    v_exp_f32 v38, v38
    v_exp_f32_e64 v39, v39
    s_waitcnt lgkmcnt(0)
    v_mfma_f32_32x32x8bf16_1k v[16:31], v[96:97], v[126:127], v[16:31]
    v_exp_f32 v40, v40
    v_exp_f32 v41, v41
    v_cvt_pk_bf16_f32 v80, v32, v33
    v_cvt_pk_bf16_f32 v81, v34, v35
    v_cvt_pk_bf16_f32 v82, v36, v37
    v_cvt_pk_bf16_f32 v83, v38, v39
    v_exp_f32 v42, v42
    v_exp_f32 v43, v43
    v_mfma_f32_32x32x16_bf16 v[64:79], v[100:103], v[80:83], v[64:79]
    v_exp_f32 v44, v44
    v_exp_f32 v45, v45
    v_exp_f32 v46, v46
    v_exp_f32 v47, v47
    v_cvt_pk_bf16_f32 v84, v40, v41
    v_cvt_pk_bf16_f32 v85, v42, v43
    v_cvt_pk_bf16_f32 v86, v44, v45
    v_cvt_pk_bf16_f32 v87, v46, v47
    v_mfma_f32_32x32x16_bf16 v[32:47], v[92:95], v[120:123], 0
    ds_read_b128 v[92:95], v8 offset:3584
    ds_read_b128 v[100:103], v10 offset:7680
    v_exp_f32 v16, v16
    v_exp_f32 v17, v17
    v_exp_f32 v18, v18
    v_exp_f32 v19, v19
    v_mfma_f32_32x32x16_bf16 v[64:79], v[104:107], v[84:87], v[64:79]
    ds_read_b128 v[104:107], v11 offset:7680
    v_exp_f32 v20, v20
    v_exp_f32 v21, v21
    v_exp_f32 v22, v22
    v_exp_f32 v23, v23
    v_mfma_f32_32x32x8bf16_1k v[32:47], v[96:97], v[14:15], v[32:47]
    v_exp_f32 v24, v24
    v_exp_f32 v25, v25
    v_cvt_pk_bf16_f32 v80, v16, v17
    v_cvt_pk_bf16_f32 v81, v18, v19
    v_cvt_pk_bf16_f32 v82, v20, v21
    v_cvt_pk_bf16_f32 v83, v22, v23
    v_exp_f32 v26, v26
    v_exp_f32 v27, v27
    v_mfma_f32_32x32x16_bf16 v[48:63], v[108:111], v[80:83], v[48:63]
    v_exp_f32 v28, v28
    v_exp_f32 v29, v29
    v_exp_f32 v30, v30
    v_exp_f32 v31, v31
    v_cvt_pk_bf16_f32 v84, v24, v25
    v_cvt_pk_bf16_f32 v85, v26, v27
    v_cvt_pk_bf16_f32 v86, v28, v29
    v_cvt_pk_bf16_f32 v87, v30, v31
    v_mfma_f32_32x32x16_bf16 v[16:31], v[88:91], v[116:119], 0
    v_exp_f32 v32, v32
    v_exp_f32 v33, v33
    v_exp_f32 v34, v34
    v_exp_f32 v35, v35
    v_mfma_f32_32x32x16_bf16 v[48:63], v[112:115], v[84:87], v[48:63]
    v_exp_f32 v36, v36
    v_exp_f32 v37, v37
    v_exp_f32 v38, v38
    v_exp_f32 v39, v39
    s_waitcnt vmcnt(0) lgkmcnt(0)
    s_barrier
    s_setprio 1
    s_nop 0
    v_mfma_f32_32x32x8bf16_1k v[16:31], v[98:99], v[124:125], v[16:31]
    v_exp_f32 v40, v40
    v_exp_f32 v41, v41
    v_cvt_pk_bf16_f32 v80, v32, v33
    v_cvt_pk_bf16_f32 v81, v34, v35
    v_cvt_pk_bf16_f32 v82, v36, v37
    v_cvt_pk_bf16_f32 v83, v38, v39
    v_exp_f32 v42, v42
    v_exp_f32 v43, v43
    v_mfma_f32_32x32x16_bf16 v[64:79], v[108:111], v[80:83], v[64:79]
    v_exp_f32 v44, v44
    v_exp_f32 v45, v45
    v_exp_f32 v46, v46
    v_exp_f32 v47, v47
    v_cvt_pk_bf16_f32 v84, v40, v41
    v_cvt_pk_bf16_f32 v85, v42, v43
    v_cvt_pk_bf16_f32 v86, v44, v45
    v_cvt_pk_bf16_f32 v87, v46, v47
    v_mfma_f32_32x32x16_bf16 v[32:47], v[88:91], v[120:123], 0
    ds_read_b128 v[88:91], v8 offset:38912
    ds_read_b128 v[108:111], v10 offset:8960
    v_exp_f32 v16, v16
    v_exp_f32 v17, v17
    v_exp_f32 v18, v18
    v_exp_f32 v19, v19
    v_mfma_f32_32x32x16_bf16 v[64:79], v[112:115], v[84:87], v[64:79]
    ds_read_b128 v[112:115], v11 offset:8960
    v_exp_f32 v20, v20
    v_exp_f32 v21, v21
    v_exp_f32 v22, v22
    v_exp_f32 v23, v23
    v_mfma_f32_32x32x8bf16_1k v[32:47], v[98:99], v[12:13], v[32:47]
    v_exp_f32 v24, v24
    v_exp_f32 v25, v25
    v_cvt_pk_bf16_f32 v80, v16, v17
    v_cvt_pk_bf16_f32 v81, v18, v19
    v_cvt_pk_bf16_f32 v82, v20, v21
    v_cvt_pk_bf16_f32 v83, v22, v23
    v_exp_f32 v26, v26
    v_exp_f32 v27, v27
    v_mfma_f32_32x32x16_bf16 v[48:63], v[100:103], v[80:83], v[48:63]
    v_exp_f32 v28, v28
    v_exp_f32 v29, v29
    v_exp_f32 v30, v30
    v_exp_f32 v31, v31
    v_cvt_pk_bf16_f32 v84, v24, v25
    v_cvt_pk_bf16_f32 v85, v26, v27
    v_cvt_pk_bf16_f32 v86, v28, v29
    v_cvt_pk_bf16_f32 v87, v30, v31
    v_mfma_f32_32x32x16_bf16 v[16:31], v[92:95], v[116:119], 0
    buffer_load_dword v5, v4, s[48:51], s79 offen
    v_exp_f32 v32, v32
    v_exp_f32 v33, v33
    v_exp_f32 v34, v34
    v_exp_f32 v35, v35
    v_mfma_f32_32x32x16_bf16 v[48:63], v[104:107], v[84:87], v[48:63]
    v_exp_f32 v36, v36
    v_exp_f32 v37, v37
    v_exp_f32 v38, v38
    v_exp_f32_e64 v39, v39
    s_waitcnt lgkmcnt(0)
    v_mfma_f32_32x32x8bf16_1k v[16:31], v[98:99], v[126:127], v[16:31]
    v_exp_f32 v40, v40
    v_exp_f32 v41, v41
    v_cvt_pk_bf16_f32 v80, v32, v33
    v_cvt_pk_bf16_f32 v81, v34, v35
    v_cvt_pk_bf16_f32 v82, v36, v37
    v_cvt_pk_bf16_f32 v83, v38, v39
    v_exp_f32 v42, v42
    v_exp_f32 v43, v43
    v_mfma_f32_32x32x16_bf16 v[64:79], v[100:103], v[80:83], v[64:79]
    v_exp_f32 v44, v44
    v_exp_f32 v45, v45
    v_exp_f32 v46, v46
    v_exp_f32 v47, v47
    v_cvt_pk_bf16_f32 v84, v40, v41
    v_cvt_pk_bf16_f32 v85, v42, v43
    v_cvt_pk_bf16_f32 v86, v44, v45
    v_cvt_pk_bf16_f32 v87, v46, v47
    v_mfma_f32_32x32x16_bf16 v[32:47], v[92:95], v[120:123], 0
    ds_read_b128 v[92:95], v8 offset:39424
    ds_read_b128 v[100:103], v10 offset:38912
    v_exp_f32 v16, v16
    v_exp_f32 v17, v17
    v_exp_f32 v18, v18
    v_exp_f32 v19, v19
    v_mfma_f32_32x32x16_bf16 v[64:79], v[104:107], v[84:87], v[64:79]
    ds_read_b128 v[104:107], v11 offset:38912
    v_exp_f32 v20, v20
    v_exp_f32 v21, v21
    v_exp_f32 v22, v22
    v_exp_f32 v23, v23
    v_mfma_f32_32x32x8bf16_1k v[32:47], v[98:99], v[14:15], v[32:47]
    ds_read_b128 v[96:99], v9 offset:38912
    v_exp_f32 v24, v24
    v_exp_f32 v25, v25
    v_cvt_pk_bf16_f32 v80, v16, v17
    v_cvt_pk_bf16_f32 v81, v18, v19
    v_cvt_pk_bf16_f32 v82, v20, v21
    v_cvt_pk_bf16_f32 v83, v22, v23
    v_exp_f32 v26, v26
    v_exp_f32 v27, v27
    v_mfma_f32_32x32x16_bf16 v[48:63], v[108:111], v[80:83], v[48:63]
    v_exp_f32 v28, v28
    v_exp_f32 v29, v29
    v_exp_f32 v30, v30
    v_exp_f32 v31, v31
    v_cvt_pk_bf16_f32 v84, v24, v25
    v_cvt_pk_bf16_f32 v85, v26, v27
    v_cvt_pk_bf16_f32 v86, v28, v29
    v_cvt_pk_bf16_f32 v87, v30, v31
    v_mfma_f32_32x32x16_bf16 v[16:31], v[88:91], v[116:119], 0
    v_exp_f32 v32, v32
    v_exp_f32 v33, v33
    v_exp_f32 v34, v34
    v_exp_f32 v35, v35
    v_mfma_f32_32x32x16_bf16 v[48:63], v[112:115], v[84:87], v[48:63]
    v_exp_f32 v36, v36
    v_exp_f32 v37, v37
    v_exp_f32 v38, v38
    v_exp_f32 v39, v39
    s_waitcnt lgkmcnt(0)
    s_barrier
    s_setprio 3
    s_nop 0
    v_mfma_f32_32x32x8bf16_1k v[16:31], v[96:97], v[124:125], v[16:31]
    v_exp_f32 v40, v40
    v_exp_f32 v41, v41
    v_cvt_pk_bf16_f32 v80, v32, v33
    v_cvt_pk_bf16_f32 v81, v34, v35
    v_cvt_pk_bf16_f32 v82, v36, v37
    v_cvt_pk_bf16_f32 v83, v38, v39
    v_exp_f32 v42, v42
    v_exp_f32 v43, v43
    v_mfma_f32_32x32x16_bf16 v[64:79], v[108:111], v[80:83], v[64:79]
    v_exp_f32 v44, v44
    v_exp_f32 v45, v45
    v_exp_f32 v46, v46
    v_exp_f32 v47, v47
    v_cvt_pk_bf16_f32 v84, v40, v41
    v_cvt_pk_bf16_f32 v85, v42, v43
    v_cvt_pk_bf16_f32 v86, v44, v45
    v_cvt_pk_bf16_f32 v87, v46, v47
    v_mfma_f32_32x32x16_bf16 v[32:47], v[88:91], v[120:123], 0
    ds_read_b128 v[88:91], v8 offset:39936
    ds_read_b128 v[108:111], v10 offset:40192
    v_exp_f32 v16, v16
    v_exp_f32 v17, v17
    v_exp_f32 v18, v18
    v_exp_f32 v19, v19
    v_mfma_f32_32x32x16_bf16 v[64:79], v[112:115], v[84:87], v[64:79]
    ds_read_b128 v[112:115], v11 offset:40192
    v_exp_f32 v20, v20
    v_exp_f32 v21, v21
    v_exp_f32 v22, v22
    v_exp_f32 v23, v23
    v_mfma_f32_32x32x8bf16_1k v[32:47], v[96:97], v[12:13], v[32:47]
    v_exp_f32 v24, v24
    v_exp_f32 v25, v25
    v_cvt_pk_bf16_f32 v80, v16, v17
    v_cvt_pk_bf16_f32 v81, v18, v19
    v_cvt_pk_bf16_f32 v82, v20, v21
    v_cvt_pk_bf16_f32 v83, v22, v23
    v_exp_f32 v26, v26
    v_exp_f32 v27, v27
    v_mfma_f32_32x32x16_bf16 v[48:63], v[100:103], v[80:83], v[48:63]
    v_exp_f32 v28, v28
    v_exp_f32 v29, v29
    v_exp_f32 v30, v30
    v_exp_f32 v31, v31
    v_cvt_pk_bf16_f32 v84, v24, v25
    v_cvt_pk_bf16_f32 v85, v26, v27
    v_cvt_pk_bf16_f32 v86, v28, v29
    v_cvt_pk_bf16_f32 v87, v30, v31
    v_mfma_f32_32x32x16_bf16 v[16:31], v[92:95], v[116:119], 0
    s_add_u32 m0, s13, 0
    s_add_u32 s7, s12, 38912
    buffer_load_dwordx4 v6, s[60:63], s7 offen sc1 lds
    v_exp_f32 v32, v32
    v_exp_f32 v33, v33
    v_exp_f32 v34, v34
    v_exp_f32 v35, v35
    v_mfma_f32_32x32x16_bf16 v[48:63], v[104:107], v[84:87], v[48:63]
    v_exp_f32 v36, v36
    v_exp_f32 v37, v37
    v_exp_f32 v38, v38
    v_exp_f32_e64 v39, v39
    s_waitcnt lgkmcnt(0)
    v_mfma_f32_32x32x8bf16_1k v[16:31], v[96:97], v[126:127], v[16:31]
    v_exp_f32 v40, v40
    v_exp_f32 v41, v41
    v_cvt_pk_bf16_f32 v80, v32, v33
    v_cvt_pk_bf16_f32 v81, v34, v35
    v_cvt_pk_bf16_f32 v82, v36, v37
    v_cvt_pk_bf16_f32 v83, v38, v39
    v_exp_f32 v42, v42
    v_exp_f32 v43, v43
    v_mfma_f32_32x32x16_bf16 v[64:79], v[100:103], v[80:83], v[64:79]
    v_exp_f32 v44, v44
    v_exp_f32 v45, v45
    v_exp_f32 v46, v46
    v_exp_f32 v47, v47
    v_cvt_pk_bf16_f32 v84, v40, v41
    v_cvt_pk_bf16_f32 v85, v42, v43
    v_cvt_pk_bf16_f32 v86, v44, v45
    v_cvt_pk_bf16_f32 v87, v46, v47
    v_mfma_f32_32x32x16_bf16 v[32:47], v[92:95], v[120:123], 0
    ds_read_b128 v[92:95], v8 offset:40448
    ds_read_b128 v[100:103], v10 offset:41472
    v_exp_f32 v16, v16
    v_exp_f32 v17, v17
    v_exp_f32 v18, v18
    v_exp_f32 v19, v19
    v_mfma_f32_32x32x16_bf16 v[64:79], v[104:107], v[84:87], v[64:79]
    ds_read_b128 v[104:107], v11 offset:41472
    v_exp_f32 v20, v20
    v_exp_f32 v21, v21
    v_exp_f32 v22, v22
    v_exp_f32 v23, v23
    v_mfma_f32_32x32x8bf16_1k v[32:47], v[96:97], v[14:15], v[32:47]
    v_exp_f32 v24, v24
    v_exp_f32 v25, v25
    v_cvt_pk_bf16_f32 v80, v16, v17
    v_cvt_pk_bf16_f32 v81, v18, v19
    v_cvt_pk_bf16_f32 v82, v20, v21
    v_cvt_pk_bf16_f32 v83, v22, v23
    v_exp_f32 v26, v26
    v_exp_f32 v27, v27
    v_mfma_f32_32x32x16_bf16 v[48:63], v[108:111], v[80:83], v[48:63]
    v_exp_f32 v28, v28
    v_exp_f32 v29, v29
    v_exp_f32 v30, v30
    v_exp_f32 v31, v31
    v_cvt_pk_bf16_f32 v84, v24, v25
    v_cvt_pk_bf16_f32 v85, v26, v27
    v_cvt_pk_bf16_f32 v86, v28, v29
    v_cvt_pk_bf16_f32 v87, v30, v31
    v_mfma_f32_32x32x16_bf16 v[16:31], v[88:91], v[116:119], 0
    s_add_u32 m0, s13, 4096
    s_add_u32 s7, s12, 43008
    buffer_load_dwordx4 v6, s[60:63], s7 offen sc1 lds
    v_exp_f32 v32, v32
    v_exp_f32 v33, v33
    v_exp_f32 v34, v34
    v_exp_f32 v35, v35
    v_mfma_f32_32x32x16_bf16 v[48:63], v[112:115], v[84:87], v[48:63]
    v_exp_f32 v36, v36
    v_exp_f32 v37, v37
    v_exp_f32 v38, v38
    v_exp_f32_e64 v39, v39
    s_waitcnt lgkmcnt(0)
    v_mfma_f32_32x32x8bf16_1k v[16:31], v[98:99], v[124:125], v[16:31]
    v_exp_f32 v40, v40
    v_exp_f32 v41, v41
    v_cvt_pk_bf16_f32 v80, v32, v33
    v_cvt_pk_bf16_f32 v81, v34, v35
    v_cvt_pk_bf16_f32 v82, v36, v37
    v_cvt_pk_bf16_f32 v83, v38, v39
    v_exp_f32 v42, v42
    v_exp_f32 v43, v43
    v_mfma_f32_32x32x16_bf16 v[64:79], v[108:111], v[80:83], v[64:79]
    v_exp_f32 v44, v44
    v_exp_f32 v45, v45
    v_exp_f32 v46, v46
    v_exp_f32 v47, v47
    v_cvt_pk_bf16_f32 v84, v40, v41
    v_cvt_pk_bf16_f32 v85, v42, v43
    v_cvt_pk_bf16_f32 v86, v44, v45
    v_cvt_pk_bf16_f32 v87, v46, v47
    v_mfma_f32_32x32x16_bf16 v[32:47], v[88:91], v[120:123], 0
    ds_read_b128 v[88:91], v8 offset:40960
    ds_read_b128 v[108:111], v10 offset:42752
    v_exp_f32 v16, v16
    v_exp_f32 v17, v17
    v_exp_f32 v18, v18
    v_exp_f32 v19, v19
    v_mfma_f32_32x32x16_bf16 v[64:79], v[112:115], v[84:87], v[64:79]
    ds_read_b128 v[112:115], v11 offset:42752
    v_exp_f32 v20, v20
    v_exp_f32 v21, v21
    v_exp_f32 v22, v22
    v_exp_f32 v23, v23
    v_mfma_f32_32x32x8bf16_1k v[32:47], v[98:99], v[12:13], v[32:47]
    v_exp_f32 v24, v24
    v_exp_f32 v25, v25
    v_cvt_pk_bf16_f32 v80, v16, v17
    v_cvt_pk_bf16_f32 v81, v18, v19
    v_cvt_pk_bf16_f32 v82, v20, v21
    v_cvt_pk_bf16_f32 v83, v22, v23
    v_exp_f32 v26, v26
    v_exp_f32 v27, v27
    v_mfma_f32_32x32x16_bf16 v[48:63], v[100:103], v[80:83], v[48:63]
    v_exp_f32 v28, v28
    v_exp_f32 v29, v29
    v_exp_f32 v30, v30
    v_exp_f32 v31, v31
    v_cvt_pk_bf16_f32 v84, v24, v25
    v_cvt_pk_bf16_f32 v85, v26, v27
    v_cvt_pk_bf16_f32 v86, v28, v29
    v_cvt_pk_bf16_f32 v87, v30, v31
    v_mfma_f32_32x32x16_bf16 v[16:31], v[92:95], v[116:119], 0
    s_add_u32 m0, s13, 8192
    s_add_u32 s7, s12, 47104
    buffer_load_dwordx4 v6, s[60:63], s7 offen sc1 lds
    v_exp_f32 v32, v32
    v_exp_f32 v33, v33
    v_exp_f32 v34, v34
    v_exp_f32 v35, v35
    v_mfma_f32_32x32x16_bf16 v[48:63], v[104:107], v[84:87], v[48:63]
    v_exp_f32 v36, v36
    v_exp_f32 v37, v37
    v_exp_f32 v38, v38
    v_exp_f32 v39, v39
    s_waitcnt lgkmcnt(0)
    s_setprio 2
    v_mfma_f32_32x32x8bf16_1k v[16:31], v[98:99], v[126:127], v[16:31]
    v_exp_f32 v40, v40
    v_exp_f32 v41, v41
    v_cvt_pk_bf16_f32 v80, v32, v33
    v_cvt_pk_bf16_f32 v81, v34, v35
    v_cvt_pk_bf16_f32 v82, v36, v37
    v_cvt_pk_bf16_f32 v83, v38, v39
    v_exp_f32 v42, v42
    v_exp_f32 v43, v43
    v_mfma_f32_32x32x16_bf16 v[64:79], v[100:103], v[80:83], v[64:79]
    v_exp_f32 v44, v44
    v_exp_f32 v45, v45
    v_exp_f32 v46, v46
    v_exp_f32 v47, v47
    v_cvt_pk_bf16_f32 v84, v40, v41
    v_cvt_pk_bf16_f32 v85, v42, v43
    v_cvt_pk_bf16_f32 v86, v44, v45
    v_cvt_pk_bf16_f32 v87, v46, v47
    v_mfma_f32_32x32x16_bf16 v[32:47], v[92:95], v[120:123], 0
    ds_read_b128 v[92:95], v8 offset:41472
    ds_read_b128 v[100:103], v10 offset:44032
    v_exp_f32 v16, v16
    v_exp_f32 v17, v17
    v_exp_f32 v18, v18
    v_exp_f32 v19, v19
    v_mfma_f32_32x32x16_bf16 v[64:79], v[104:107], v[84:87], v[64:79]
    ds_read_b128 v[104:107], v11 offset:44032
    v_exp_f32 v20, v20
    v_exp_f32 v21, v21
    v_exp_f32 v22, v22
    v_exp_f32 v23, v23
    v_mfma_f32_32x32x8bf16_1k v[32:47], v[98:99], v[14:15], v[32:47]
    ds_read_b128 v[96:99], v9 offset:39424
    v_exp_f32 v24, v24
    v_exp_f32 v25, v25
    v_cvt_pk_bf16_f32 v80, v16, v17
    v_cvt_pk_bf16_f32 v81, v18, v19
    v_cvt_pk_bf16_f32 v82, v20, v21
    v_cvt_pk_bf16_f32 v83, v22, v23
    v_exp_f32 v26, v26
    v_exp_f32 v27, v27
    v_mfma_f32_32x32x16_bf16 v[48:63], v[108:111], v[80:83], v[48:63]
    v_exp_f32 v28, v28
    v_exp_f32 v29, v29
    v_exp_f32 v30, v30
    v_exp_f32 v31, v31
    v_cvt_pk_bf16_f32 v84, v24, v25
    v_cvt_pk_bf16_f32 v85, v26, v27
    v_cvt_pk_bf16_f32 v86, v28, v29
    v_cvt_pk_bf16_f32 v87, v30, v31
    v_mfma_f32_32x32x16_bf16 v[16:31], v[88:91], v[116:119], 0
    s_add_u32 m0, s13, 12288
    s_add_u32 s7, s12, 51200
    buffer_load_dwordx4 v6, s[60:63], s7 offen sc1 lds
    v_exp_f32 v32, v32
    v_exp_f32 v33, v33
    v_exp_f32 v34, v34
    v_exp_f32 v35, v35
    v_mfma_f32_32x32x16_bf16 v[48:63], v[112:115], v[84:87], v[48:63]
    v_exp_f32 v36, v36
    v_exp_f32 v37, v37
    v_exp_f32 v38, v38
    v_exp_f32_e64 v39, v39
    s_waitcnt lgkmcnt(0)
    v_mfma_f32_32x32x8bf16_1k v[16:31], v[96:97], v[124:125], v[16:31]
    v_exp_f32 v40, v40
    v_exp_f32 v41, v41
    v_cvt_pk_bf16_f32 v80, v32, v33
    v_cvt_pk_bf16_f32 v81, v34, v35
    v_cvt_pk_bf16_f32 v82, v36, v37
    v_cvt_pk_bf16_f32 v83, v38, v39
    v_exp_f32 v42, v42
    v_exp_f32 v43, v43
    v_mfma_f32_32x32x16_bf16 v[64:79], v[108:111], v[80:83], v[64:79]
    v_exp_f32 v44, v44
    v_exp_f32 v45, v45
    v_exp_f32 v46, v46
    v_exp_f32 v47, v47
    v_cvt_pk_bf16_f32 v84, v40, v41
    v_cvt_pk_bf16_f32 v85, v42, v43
    v_cvt_pk_bf16_f32 v86, v44, v45
    v_cvt_pk_bf16_f32 v87, v46, v47
    v_mfma_f32_32x32x16_bf16 v[32:47], v[88:91], v[120:123], 0
    ds_read_b128 v[88:91], v8 offset:41984
    ds_read_b128 v[108:111], v10 offset:45312
    v_exp_f32 v16, v16
    v_exp_f32 v17, v17
    v_exp_f32 v18, v18
    v_exp_f32 v19, v19
    v_mfma_f32_32x32x16_bf16 v[64:79], v[112:115], v[84:87], v[64:79]
    ds_read_b128 v[112:115], v11 offset:45312
    v_exp_f32 v20, v20
    v_exp_f32 v21, v21
    v_exp_f32 v22, v22
    v_exp_f32 v23, v23
    v_mfma_f32_32x32x8bf16_1k v[32:47], v[96:97], v[12:13], v[32:47]
    v_exp_f32 v24, v24
    v_exp_f32 v25, v25
    v_cvt_pk_bf16_f32 v80, v16, v17
    v_cvt_pk_bf16_f32 v81, v18, v19
    v_cvt_pk_bf16_f32 v82, v20, v21
    v_cvt_pk_bf16_f32 v83, v22, v23
    v_exp_f32 v26, v26
    v_exp_f32 v27, v27
    v_mfma_f32_32x32x16_bf16 v[48:63], v[100:103], v[80:83], v[48:63]
    v_exp_f32 v28, v28
    v_exp_f32 v29, v29
    v_exp_f32 v30, v30
    v_exp_f32 v31, v31
    v_cvt_pk_bf16_f32 v84, v24, v25
    v_cvt_pk_bf16_f32 v85, v26, v27
    v_cvt_pk_bf16_f32 v86, v28, v29
    v_cvt_pk_bf16_f32 v87, v30, v31
    v_mfma_f32_32x32x16_bf16 v[16:31], v[92:95], v[116:119], 0
    s_add_u32 m0, s78, 0
    s_add_u32 s7, s12, 38912
    buffer_load_dwordx4 v7, s[60:63], s7 offen sc1 lds
    v_exp_f32 v32, v32
    v_exp_f32 v33, v33
    v_exp_f32 v34, v34
    v_exp_f32 v35, v35
    v_mfma_f32_32x32x16_bf16 v[48:63], v[104:107], v[84:87], v[48:63]
    v_exp_f32 v36, v36
    v_exp_f32 v37, v37
    v_exp_f32 v38, v38
    v_exp_f32_e64 v39, v39
    s_waitcnt lgkmcnt(0)
    v_mfma_f32_32x32x8bf16_1k v[16:31], v[96:97], v[126:127], v[16:31]
    v_exp_f32 v40, v40
    v_exp_f32 v41, v41
    v_cvt_pk_bf16_f32 v80, v32, v33
    v_cvt_pk_bf16_f32 v81, v34, v35
    v_cvt_pk_bf16_f32 v82, v36, v37
    v_cvt_pk_bf16_f32 v83, v38, v39
    v_exp_f32 v42, v42
    v_exp_f32 v43, v43
    v_mfma_f32_32x32x16_bf16 v[64:79], v[100:103], v[80:83], v[64:79]
    v_exp_f32 v44, v44
    v_exp_f32 v45, v45
    v_exp_f32 v46, v46
    v_exp_f32 v47, v47
    v_cvt_pk_bf16_f32 v84, v40, v41
    v_cvt_pk_bf16_f32 v85, v42, v43
    v_cvt_pk_bf16_f32 v86, v44, v45
    v_cvt_pk_bf16_f32 v87, v46, v47
    v_mfma_f32_32x32x16_bf16 v[32:47], v[92:95], v[120:123], 0
    ds_read_b128 v[92:95], v8 offset:42496
    ds_read_b128 v[100:103], v10 offset:46592
    v_exp_f32 v16, v16
    v_exp_f32 v17, v17
    v_exp_f32 v18, v18
    v_exp_f32 v19, v19
    v_mfma_f32_32x32x16_bf16 v[64:79], v[104:107], v[84:87], v[64:79]
    ds_read_b128 v[104:107], v11 offset:46592
    v_exp_f32 v20, v20
    v_exp_f32 v21, v21
    v_exp_f32 v22, v22
    v_exp_f32 v23, v23
    v_mfma_f32_32x32x8bf16_1k v[32:47], v[96:97], v[14:15], v[32:47]
    v_exp_f32 v24, v24
    v_exp_f32 v25, v25
    v_cvt_pk_bf16_f32 v80, v16, v17
    v_cvt_pk_bf16_f32 v81, v18, v19
    v_cvt_pk_bf16_f32 v82, v20, v21
    v_cvt_pk_bf16_f32 v83, v22, v23
    v_exp_f32 v26, v26
    v_exp_f32 v27, v27
    v_mfma_f32_32x32x16_bf16 v[48:63], v[108:111], v[80:83], v[48:63]
    v_exp_f32 v28, v28
    v_exp_f32 v29, v29
    v_exp_f32 v30, v30
    v_exp_f32 v31, v31
    v_cvt_pk_bf16_f32 v84, v24, v25
    v_cvt_pk_bf16_f32 v85, v26, v27
    v_cvt_pk_bf16_f32 v86, v28, v29
    v_cvt_pk_bf16_f32 v87, v30, v31
    v_mfma_f32_32x32x16_bf16 v[16:31], v[88:91], v[116:119], 0
    v_exp_f32 v32, v32
    v_exp_f32 v33, v33
    v_exp_f32 v34, v34
    v_exp_f32 v35, v35
    v_mfma_f32_32x32x16_bf16 v[48:63], v[112:115], v[84:87], v[48:63]
    v_exp_f32 v36, v36
    v_exp_f32 v37, v37
    v_exp_f32 v38, v38
    v_exp_f32 v39, v39
    s_waitcnt vmcnt(0) lgkmcnt(0)
    s_barrier
    s_setprio 1
    s_nop 0
    v_mfma_f32_32x32x8bf16_1k v[16:31], v[98:99], v[124:125], v[16:31]
    v_exp_f32 v40, v40
    v_exp_f32 v41, v41
    v_cvt_pk_bf16_f32 v80, v32, v33
    v_cvt_pk_bf16_f32 v81, v34, v35
    v_cvt_pk_bf16_f32 v82, v36, v37
    v_cvt_pk_bf16_f32 v83, v38, v39
    v_exp_f32 v42, v42
    v_exp_f32 v43, v43
    v_mfma_f32_32x32x16_bf16 v[64:79], v[108:111], v[80:83], v[64:79]
    v_exp_f32 v44, v44
    v_exp_f32 v45, v45
    v_exp_f32 v46, v46
    v_exp_f32 v47, v47
    v_cvt_pk_bf16_f32 v84, v40, v41
    v_cvt_pk_bf16_f32 v85, v42, v43
    v_cvt_pk_bf16_f32 v86, v44, v45
    v_cvt_pk_bf16_f32 v87, v46, v47
    v_mfma_f32_32x32x16_bf16 v[32:47], v[88:91], v[120:123], 0
    ds_read_b128 v[88:91], v8 offset:0
    ds_read_b128 v[108:111], v10 offset:47872
    v_exp_f32 v16, v16
    v_exp_f32 v17, v17
    v_exp_f32 v18, v18
    v_exp_f32 v19, v19
    v_mfma_f32_32x32x16_bf16 v[64:79], v[112:115], v[84:87], v[64:79]
    ds_read_b128 v[112:115], v11 offset:47872
    v_exp_f32 v20, v20
    v_exp_f32 v21, v21
    v_exp_f32 v22, v22
    v_exp_f32 v23, v23
    v_mfma_f32_32x32x8bf16_1k v[32:47], v[98:99], v[12:13], v[32:47]
    v_exp_f32 v24, v24
    v_exp_f32 v25, v25
    v_cvt_pk_bf16_f32 v80, v16, v17
    v_cvt_pk_bf16_f32 v81, v18, v19
    v_cvt_pk_bf16_f32 v82, v20, v21
    v_cvt_pk_bf16_f32 v83, v22, v23
    v_exp_f32 v26, v26
    v_exp_f32 v27, v27
    v_mfma_f32_32x32x16_bf16 v[48:63], v[100:103], v[80:83], v[48:63]
    v_exp_f32 v28, v28
    v_exp_f32 v29, v29
    v_exp_f32 v30, v30
    v_exp_f32 v31, v31
    v_cvt_pk_bf16_f32 v84, v24, v25
    v_cvt_pk_bf16_f32 v85, v26, v27
    v_cvt_pk_bf16_f32 v86, v28, v29
    v_cvt_pk_bf16_f32 v87, v30, v31
    v_mfma_f32_32x32x16_bf16 v[16:31], v[92:95], v[116:119], 0
    v_exp_f32 v32, v32
    v_exp_f32 v33, v33
    v_exp_f32 v34, v34
    v_exp_f32 v35, v35
    v_mfma_f32_32x32x16_bf16 v[48:63], v[104:107], v[84:87], v[48:63]
    v_exp_f32 v36, v36
    v_exp_f32 v37, v37
    v_exp_f32 v38, v38
    v_exp_f32_e64 v39, v39
    s_waitcnt lgkmcnt(0)
    v_mfma_f32_32x32x8bf16_1k v[16:31], v[98:99], v[126:127], v[16:31]
    v_exp_f32 v40, v40
    v_exp_f32 v41, v41
    v_cvt_pk_bf16_f32 v80, v32, v33
    v_cvt_pk_bf16_f32 v81, v34, v35
    v_cvt_pk_bf16_f32 v82, v36, v37
    v_cvt_pk_bf16_f32 v83, v38, v39
    v_exp_f32 v42, v42
    v_exp_f32 v43, v43
    v_mfma_f32_32x32x16_bf16 v[64:79], v[100:103], v[80:83], v[64:79]
    v_exp_f32 v44, v44
    v_exp_f32 v45, v45
    v_exp_f32 v46, v46
    v_exp_f32 v47, v47
    v_cvt_pk_bf16_f32 v84, v40, v41
    v_cvt_pk_bf16_f32 v85, v42, v43
    v_cvt_pk_bf16_f32 v86, v44, v45
    v_cvt_pk_bf16_f32 v87, v46, v47
    v_mfma_f32_32x32x16_bf16 v[32:47], v[92:95], v[120:123], 0
    ds_read_b128 v[92:95], v8 offset:512
    ds_read_b128 v[100:103], v10 offset:0
    v_exp_f32 v16, v16
    v_exp_f32 v17, v17
    v_exp_f32 v18, v18
    v_exp_f32 v19, v19
    v_mfma_f32_32x32x16_bf16 v[64:79], v[104:107], v[84:87], v[64:79]
    ds_read_b128 v[104:107], v11 offset:0
    v_exp_f32 v20, v20
    v_exp_f32 v21, v21
    v_exp_f32 v22, v22
    v_exp_f32 v23, v23
    v_mfma_f32_32x32x8bf16_1k v[32:47], v[98:99], v[14:15], v[32:47]
    ds_read_b128 v[96:99], v9 offset:0
    v_exp_f32 v24, v24
    v_exp_f32 v25, v25
    v_cvt_pk_bf16_f32 v80, v16, v17
    v_cvt_pk_bf16_f32 v81, v18, v19
    v_cvt_pk_bf16_f32 v82, v20, v21
    v_cvt_pk_bf16_f32 v83, v22, v23
    v_exp_f32 v26, v26
    v_exp_f32 v27, v27
    v_mfma_f32_32x32x16_bf16 v[48:63], v[108:111], v[80:83], v[48:63]
    v_exp_f32 v28, v28
    v_exp_f32 v29, v29
    v_exp_f32 v30, v30
    v_exp_f32 v31, v31
    v_cvt_pk_bf16_f32 v84, v24, v25
    v_cvt_pk_bf16_f32 v85, v26, v27
    v_cvt_pk_bf16_f32 v86, v28, v29
    v_cvt_pk_bf16_f32 v87, v30, v31
    v_mfma_f32_32x32x16_bf16 v[16:31], v[88:91], v[116:119], 0
    v_exp_f32 v32, v32
    v_exp_f32 v33, v33
    v_exp_f32 v34, v34
    v_exp_f32 v35, v35
    v_mfma_f32_32x32x16_bf16 v[48:63], v[112:115], v[84:87], v[48:63]
    v_exp_f32 v36, v36
    v_exp_f32 v37, v37
    v_exp_f32 v38, v38
    v_exp_f32 v39, v39
    s_waitcnt lgkmcnt(0)
    s_barrier
    s_setprio 3
    s_nop 0
    v_mfma_f32_32x32x8bf16_1k v[16:31], v[96:97], v[124:125], v[16:31]
    v_exp_f32 v40, v40
    v_exp_f32 v41, v41
    v_cvt_pk_bf16_f32 v80, v32, v33
    v_cvt_pk_bf16_f32 v81, v34, v35
    v_cvt_pk_bf16_f32 v82, v36, v37
    v_cvt_pk_bf16_f32 v83, v38, v39
    v_exp_f32 v42, v42
    v_exp_f32 v43, v43
    v_mfma_f32_32x32x16_bf16 v[64:79], v[108:111], v[80:83], v[64:79]
    v_exp_f32 v44, v44
    v_exp_f32 v45, v45
    v_exp_f32 v46, v46
    v_exp_f32 v47, v47
    v_cvt_pk_bf16_f32 v84, v40, v41
    v_cvt_pk_bf16_f32 v85, v42, v43
    v_cvt_pk_bf16_f32 v86, v44, v45
    v_cvt_pk_bf16_f32 v87, v46, v47
    v_mfma_f32_32x32x16_bf16 v[32:47], v[88:91], v[120:123], 0
    ds_read_b128 v[88:91], v8 offset:1024
    ds_read_b128 v[108:111], v10 offset:1280
    v_exp_f32 v16, v16
    v_exp_f32 v17, v17
    v_exp_f32 v18, v18
    v_exp_f32 v19, v19
    v_mfma_f32_32x32x16_bf16 v[64:79], v[112:115], v[84:87], v[64:79]
    ds_read_b128 v[112:115], v11 offset:1280
    v_exp_f32 v20, v20
    v_exp_f32 v21, v21
    v_exp_f32 v22, v22
    v_exp_f32 v23, v23
    v_mfma_f32_32x32x8bf16_1k v[32:47], v[96:97], v[12:13], v[32:47]
    v_exp_f32 v24, v24
    v_exp_f32 v25, v25
    v_cvt_pk_bf16_f32 v80, v16, v17
    v_cvt_pk_bf16_f32 v81, v18, v19
    v_cvt_pk_bf16_f32 v82, v20, v21
    v_cvt_pk_bf16_f32 v83, v22, v23
    v_exp_f32 v26, v26
    v_exp_f32 v27, v27
    v_mfma_f32_32x32x16_bf16 v[48:63], v[100:103], v[80:83], v[48:63]
    v_exp_f32 v28, v28
    v_exp_f32 v29, v29
    v_exp_f32 v30, v30
    v_exp_f32 v31, v31
    v_cvt_pk_bf16_f32 v84, v24, v25
    v_cvt_pk_bf16_f32 v85, v26, v27
    v_cvt_pk_bf16_f32 v86, v28, v29
    v_cvt_pk_bf16_f32 v87, v30, v31
    v_mfma_f32_32x32x16_bf16 v[16:31], v[92:95], v[116:119], 0
    s_add_u32 m0, s13, 38912
    s_add_u32 s7, s12, 58368
    buffer_load_dwordx4 v6, s[60:63], s7 offen sc1 lds
    v_exp_f32 v32, v32
    v_exp_f32 v33, v33
    v_exp_f32 v34, v34
    v_exp_f32 v35, v35
    v_mfma_f32_32x32x16_bf16 v[48:63], v[104:107], v[84:87], v[48:63]
    v_exp_f32 v36, v36
    v_exp_f32 v37, v37
    v_exp_f32 v38, v38
    v_exp_f32_e64 v39, v39
    s_waitcnt lgkmcnt(0)
    v_mfma_f32_32x32x8bf16_1k v[16:31], v[96:97], v[126:127], v[16:31]
    v_exp_f32 v40, v40
    v_exp_f32 v41, v41
    v_cvt_pk_bf16_f32 v80, v32, v33
    v_cvt_pk_bf16_f32 v81, v34, v35
    v_cvt_pk_bf16_f32 v82, v36, v37
    v_cvt_pk_bf16_f32 v83, v38, v39
    v_exp_f32 v42, v42
    v_exp_f32 v43, v43
    v_mfma_f32_32x32x16_bf16 v[64:79], v[100:103], v[80:83], v[64:79]
    v_exp_f32 v44, v44
    v_exp_f32 v45, v45
    v_exp_f32 v46, v46
    v_exp_f32 v47, v47
    v_cvt_pk_bf16_f32 v84, v40, v41
    v_cvt_pk_bf16_f32 v85, v42, v43
    v_cvt_pk_bf16_f32 v86, v44, v45
    v_cvt_pk_bf16_f32 v87, v46, v47
    v_mfma_f32_32x32x16_bf16 v[32:47], v[92:95], v[120:123], 0
    ds_read_b128 v[92:95], v8 offset:1536
    ds_read_b128 v[100:103], v10 offset:2560
    v_exp_f32 v16, v16
    v_exp_f32 v17, v17
    v_exp_f32 v18, v18
    v_exp_f32 v19, v19
    v_mfma_f32_32x32x16_bf16 v[64:79], v[104:107], v[84:87], v[64:79]
    ds_read_b128 v[104:107], v11 offset:2560
    v_exp_f32 v20, v20
    v_exp_f32 v21, v21
    v_exp_f32 v22, v22
    v_exp_f32 v23, v23
    v_mfma_f32_32x32x8bf16_1k v[32:47], v[96:97], v[14:15], v[32:47]
    v_exp_f32 v24, v24
    v_exp_f32 v25, v25
    v_cvt_pk_bf16_f32 v80, v16, v17
    v_cvt_pk_bf16_f32 v81, v18, v19
    v_cvt_pk_bf16_f32 v82, v20, v21
    v_cvt_pk_bf16_f32 v83, v22, v23
    v_exp_f32 v26, v26
    v_exp_f32 v27, v27
    v_mfma_f32_32x32x16_bf16 v[48:63], v[108:111], v[80:83], v[48:63]
    v_exp_f32 v28, v28
    v_exp_f32 v29, v29
    v_exp_f32 v30, v30
    v_exp_f32 v31, v31
    v_cvt_pk_bf16_f32 v84, v24, v25
    v_cvt_pk_bf16_f32 v85, v26, v27
    v_cvt_pk_bf16_f32 v86, v28, v29
    v_cvt_pk_bf16_f32 v87, v30, v31
    v_mfma_f32_32x32x16_bf16 v[16:31], v[88:91], v[116:119], 0
    s_add_u32 m0, s13, 43008
    s_add_u32 s7, s12, 62464
    buffer_load_dwordx4 v6, s[60:63], s7 offen sc1 lds
    v_exp_f32 v32, v32
    v_exp_f32 v33, v33
    v_exp_f32 v34, v34
    v_exp_f32 v35, v35
    v_mfma_f32_32x32x16_bf16 v[48:63], v[112:115], v[84:87], v[48:63]
    v_exp_f32 v36, v36
    v_exp_f32 v37, v37
    v_exp_f32 v38, v38
    v_exp_f32_e64 v39, v39
    s_waitcnt lgkmcnt(0)
    v_mfma_f32_32x32x8bf16_1k v[16:31], v[98:99], v[124:125], v[16:31]
    v_exp_f32 v40, v40
    v_exp_f32 v41, v41
    v_cvt_pk_bf16_f32 v80, v32, v33
    v_cvt_pk_bf16_f32 v81, v34, v35
    v_cvt_pk_bf16_f32 v82, v36, v37
    v_cvt_pk_bf16_f32 v83, v38, v39
    v_exp_f32 v42, v42
    v_exp_f32 v43, v43
    v_mfma_f32_32x32x16_bf16 v[64:79], v[108:111], v[80:83], v[64:79]
    v_exp_f32 v44, v44
    v_exp_f32 v45, v45
    v_exp_f32 v46, v46
    v_exp_f32 v47, v47
    v_cvt_pk_bf16_f32 v84, v40, v41
    v_cvt_pk_bf16_f32 v85, v42, v43
    v_cvt_pk_bf16_f32 v86, v44, v45
    v_cvt_pk_bf16_f32 v87, v46, v47
    v_mfma_f32_32x32x16_bf16 v[32:47], v[88:91], v[120:123], 0
    ds_read_b128 v[88:91], v8 offset:2048
    ds_read_b128 v[108:111], v10 offset:3840
    v_exp_f32 v16, v16
    v_exp_f32 v17, v17
    v_exp_f32 v18, v18
    v_exp_f32 v19, v19
    v_mfma_f32_32x32x16_bf16 v[64:79], v[112:115], v[84:87], v[64:79]
    ds_read_b128 v[112:115], v11 offset:3840
    v_exp_f32 v20, v20
    v_exp_f32 v21, v21
    v_exp_f32 v22, v22
    v_exp_f32 v23, v23
    v_mfma_f32_32x32x8bf16_1k v[32:47], v[98:99], v[12:13], v[32:47]
    v_exp_f32 v24, v24
    v_exp_f32 v25, v25
    v_cvt_pk_bf16_f32 v80, v16, v17
    v_cvt_pk_bf16_f32 v81, v18, v19
    v_cvt_pk_bf16_f32 v82, v20, v21
    v_cvt_pk_bf16_f32 v83, v22, v23
    v_exp_f32 v26, v26
    v_exp_f32 v27, v27
    v_mfma_f32_32x32x16_bf16 v[48:63], v[100:103], v[80:83], v[48:63]
    v_exp_f32 v28, v28
    v_exp_f32 v29, v29
    v_exp_f32 v30, v30
    v_exp_f32 v31, v31
    v_cvt_pk_bf16_f32 v84, v24, v25
    v_cvt_pk_bf16_f32 v85, v26, v27
    v_cvt_pk_bf16_f32 v86, v28, v29
    v_cvt_pk_bf16_f32 v87, v30, v31
    v_mfma_f32_32x32x16_bf16 v[16:31], v[92:95], v[116:119], 0
    s_add_u32 m0, s13, 47104
    s_add_u32 s7, s12, 66560
    buffer_load_dwordx4 v6, s[60:63], s7 offen sc1 lds
    v_exp_f32 v32, v32
    v_exp_f32 v33, v33
    v_exp_f32 v34, v34
    v_exp_f32 v35, v35
    v_mfma_f32_32x32x16_bf16 v[48:63], v[104:107], v[84:87], v[48:63]
    v_exp_f32 v36, v36
    v_exp_f32 v37, v37
    v_exp_f32 v38, v38
    v_exp_f32 v39, v39
    s_waitcnt lgkmcnt(0)
    s_setprio 2
    v_mfma_f32_32x32x8bf16_1k v[16:31], v[98:99], v[126:127], v[16:31]
    v_exp_f32 v40, v40
    v_exp_f32 v41, v41
    v_cvt_pk_bf16_f32 v80, v32, v33
    v_cvt_pk_bf16_f32 v81, v34, v35
    v_cvt_pk_bf16_f32 v82, v36, v37
    v_cvt_pk_bf16_f32 v83, v38, v39
    v_exp_f32 v42, v42
    v_exp_f32 v43, v43
    v_mfma_f32_32x32x16_bf16 v[64:79], v[100:103], v[80:83], v[64:79]
    v_exp_f32 v44, v44
    v_exp_f32 v45, v45
    v_exp_f32 v46, v46
    v_exp_f32 v47, v47
    v_cvt_pk_bf16_f32 v84, v40, v41
    v_cvt_pk_bf16_f32 v85, v42, v43
    v_cvt_pk_bf16_f32 v86, v44, v45
    v_cvt_pk_bf16_f32 v87, v46, v47
    v_mfma_f32_32x32x16_bf16 v[32:47], v[92:95], v[120:123], 0
    ds_read_b128 v[92:95], v8 offset:2560
    ds_read_b128 v[100:103], v10 offset:5120
    v_exp_f32 v16, v16
    v_exp_f32 v17, v17
    v_exp_f32 v18, v18
    v_exp_f32 v19, v19
    v_mfma_f32_32x32x16_bf16 v[64:79], v[104:107], v[84:87], v[64:79]
    ds_read_b128 v[104:107], v11 offset:5120
    v_exp_f32 v20, v20
    v_exp_f32 v21, v21
    v_exp_f32 v22, v22
    v_exp_f32 v23, v23
    v_mfma_f32_32x32x8bf16_1k v[32:47], v[98:99], v[14:15], v[32:47]
    ds_read_b128 v[96:99], v9 offset:512
    v_exp_f32 v24, v24
    v_exp_f32 v25, v25
    v_cvt_pk_bf16_f32 v80, v16, v17
    v_cvt_pk_bf16_f32 v81, v18, v19
    v_cvt_pk_bf16_f32 v82, v20, v21
    v_cvt_pk_bf16_f32 v83, v22, v23
    v_exp_f32 v26, v26
    v_exp_f32 v27, v27
    v_mfma_f32_32x32x16_bf16 v[48:63], v[108:111], v[80:83], v[48:63]
    v_exp_f32 v28, v28
    v_exp_f32 v29, v29
    v_exp_f32 v30, v30
    v_exp_f32 v31, v31
    v_cvt_pk_bf16_f32 v84, v24, v25
    v_cvt_pk_bf16_f32 v85, v26, v27
    v_cvt_pk_bf16_f32 v86, v28, v29
    v_cvt_pk_bf16_f32 v87, v30, v31
    v_mfma_f32_32x32x16_bf16 v[16:31], v[88:91], v[116:119], 0
    s_add_u32 m0, s13, 51200
    s_add_u32 s7, s12, 70656
    buffer_load_dwordx4 v6, s[60:63], s7 offen sc1 lds
    v_exp_f32 v32, v32
    v_exp_f32 v33, v33
    v_exp_f32 v34, v34
    v_exp_f32 v35, v35
    v_mfma_f32_32x32x16_bf16 v[48:63], v[112:115], v[84:87], v[48:63]
    v_exp_f32 v36, v36
    v_exp_f32 v37, v37
    v_exp_f32 v38, v38
    v_exp_f32_e64 v39, v39
    s_waitcnt lgkmcnt(0)
    v_mfma_f32_32x32x8bf16_1k v[16:31], v[96:97], v[124:125], v[16:31]
    v_exp_f32 v40, v40
    v_exp_f32 v41, v41
    v_cvt_pk_bf16_f32 v80, v32, v33
    v_cvt_pk_bf16_f32 v81, v34, v35
    v_cvt_pk_bf16_f32 v82, v36, v37
    v_cvt_pk_bf16_f32 v83, v38, v39
    v_exp_f32 v42, v42
    v_exp_f32 v43, v43
    v_mfma_f32_32x32x16_bf16 v[64:79], v[108:111], v[80:83], v[64:79]
    v_exp_f32 v44, v44
    v_exp_f32 v45, v45
    v_exp_f32 v46, v46
    v_exp_f32 v47, v47
    v_cvt_pk_bf16_f32 v84, v40, v41
    v_cvt_pk_bf16_f32 v85, v42, v43
    v_cvt_pk_bf16_f32 v86, v44, v45
    v_cvt_pk_bf16_f32 v87, v46, v47
    v_mfma_f32_32x32x16_bf16 v[32:47], v[88:91], v[120:123], 0
    ds_read_b128 v[88:91], v8 offset:3072
    ds_read_b128 v[108:111], v10 offset:6400
    v_exp_f32 v16, v16
    v_exp_f32 v17, v17
    v_exp_f32 v18, v18
    v_exp_f32 v19, v19
    v_mfma_f32_32x32x16_bf16 v[64:79], v[112:115], v[84:87], v[64:79]
    ds_read_b128 v[112:115], v11 offset:6400
    v_exp_f32 v20, v20
    v_exp_f32 v21, v21
    v_exp_f32 v22, v22
    v_exp_f32 v23, v23
    v_mfma_f32_32x32x8bf16_1k v[32:47], v[96:97], v[12:13], v[32:47]
    v_exp_f32 v24, v24
    v_exp_f32 v25, v25
    v_cvt_pk_bf16_f32 v80, v16, v17
    v_cvt_pk_bf16_f32 v81, v18, v19
    v_cvt_pk_bf16_f32 v82, v20, v21
    v_cvt_pk_bf16_f32 v83, v22, v23
    v_exp_f32 v26, v26
    v_exp_f32 v27, v27
    v_mfma_f32_32x32x16_bf16 v[48:63], v[100:103], v[80:83], v[48:63]
    v_exp_f32 v28, v28
    v_exp_f32 v29, v29
    v_exp_f32 v30, v30
    v_exp_f32 v31, v31
    v_cvt_pk_bf16_f32 v84, v24, v25
    v_cvt_pk_bf16_f32 v85, v26, v27
    v_cvt_pk_bf16_f32 v86, v28, v29
    v_cvt_pk_bf16_f32 v87, v30, v31
    v_mfma_f32_32x32x16_bf16 v[16:31], v[92:95], v[116:119], 0
    s_add_u32 m0, s78, 38912
    s_add_u32 s7, s12, 58368
    buffer_load_dwordx4 v7, s[60:63], s7 offen sc1 lds
    v_exp_f32 v32, v32
    v_exp_f32 v33, v33
    v_exp_f32 v34, v34
    v_exp_f32 v35, v35
    v_mfma_f32_32x32x16_bf16 v[48:63], v[104:107], v[84:87], v[48:63]
    v_exp_f32 v36, v36
    v_exp_f32 v37, v37
    v_exp_f32 v38, v38
    v_exp_f32_e64 v39, v39
    s_waitcnt lgkmcnt(0)
    v_mfma_f32_32x32x8bf16_1k v[16:31], v[96:97], v[126:127], v[16:31]
    v_exp_f32 v40, v40
    v_exp_f32 v41, v41
    v_cvt_pk_bf16_f32 v80, v32, v33
    v_cvt_pk_bf16_f32 v81, v34, v35
    v_cvt_pk_bf16_f32 v82, v36, v37
    v_cvt_pk_bf16_f32 v83, v38, v39
    v_exp_f32 v42, v42
    v_exp_f32 v43, v43
    v_mfma_f32_32x32x16_bf16 v[64:79], v[100:103], v[80:83], v[64:79]
    v_exp_f32 v44, v44
    v_exp_f32 v45, v45
    v_exp_f32 v46, v46
    v_exp_f32 v47, v47
    v_cvt_pk_bf16_f32 v84, v40, v41
    v_cvt_pk_bf16_f32 v85, v42, v43
    v_cvt_pk_bf16_f32 v86, v44, v45
    v_cvt_pk_bf16_f32 v87, v46, v47
    v_mfma_f32_32x32x16_bf16 v[32:47], v[92:95], v[120:123], 0
    ds_read_b128 v[92:95], v8 offset:3584
    ds_read_b128 v[100:103], v10 offset:7680
    v_exp_f32 v16, v16
    v_exp_f32 v17, v17
    v_exp_f32 v18, v18
    v_exp_f32 v19, v19
    v_mfma_f32_32x32x16_bf16 v[64:79], v[104:107], v[84:87], v[64:79]
    ds_read_b128 v[104:107], v11 offset:7680
    v_exp_f32 v20, v20
    v_exp_f32 v21, v21
    v_exp_f32 v22, v22
    v_exp_f32 v23, v23
    v_mfma_f32_32x32x8bf16_1k v[32:47], v[96:97], v[14:15], v[32:47]
    v_exp_f32 v24, v24
    v_exp_f32 v25, v25
    v_cvt_pk_bf16_f32 v80, v16, v17
    v_cvt_pk_bf16_f32 v81, v18, v19
    v_cvt_pk_bf16_f32 v82, v20, v21
    v_cvt_pk_bf16_f32 v83, v22, v23
    v_exp_f32 v26, v26
    v_exp_f32 v27, v27
    v_mfma_f32_32x32x16_bf16 v[48:63], v[108:111], v[80:83], v[48:63]
    v_exp_f32 v28, v28
    v_exp_f32 v29, v29
    v_exp_f32 v30, v30
    v_exp_f32 v31, v31
    v_cvt_pk_bf16_f32 v84, v24, v25
    v_cvt_pk_bf16_f32 v85, v26, v27
    v_cvt_pk_bf16_f32 v86, v28, v29
    v_cvt_pk_bf16_f32 v87, v30, v31
    v_mfma_f32_32x32x16_bf16 v[16:31], v[88:91], v[116:119], 0
    v_exp_f32 v32, v32
    v_exp_f32 v33, v33
    v_exp_f32 v34, v34
    v_exp_f32 v35, v35
    v_mfma_f32_32x32x16_bf16 v[48:63], v[112:115], v[84:87], v[48:63]
    v_exp_f32 v36, v36
    v_exp_f32 v37, v37
    v_exp_f32 v38, v38
    v_exp_f32 v39, v39
    s_waitcnt vmcnt(0) lgkmcnt(0)
    s_barrier
    s_setprio 1
    s_nop 0
    v_mfma_f32_32x32x8bf16_1k v[16:31], v[98:99], v[124:125], v[16:31]
    v_exp_f32 v40, v40
    v_exp_f32 v41, v41
    v_cvt_pk_bf16_f32 v80, v32, v33
    v_cvt_pk_bf16_f32 v81, v34, v35
    v_cvt_pk_bf16_f32 v82, v36, v37
    v_cvt_pk_bf16_f32 v83, v38, v39
    v_exp_f32 v42, v42
    v_exp_f32 v43, v43
    v_mfma_f32_32x32x16_bf16 v[64:79], v[108:111], v[80:83], v[64:79]
    v_exp_f32 v44, v44
    v_exp_f32 v45, v45
    v_exp_f32 v46, v46
    v_exp_f32 v47, v47
    v_cvt_pk_bf16_f32 v84, v40, v41
    v_cvt_pk_bf16_f32 v85, v42, v43
    v_cvt_pk_bf16_f32 v86, v44, v45
    v_cvt_pk_bf16_f32 v87, v46, v47
    v_mfma_f32_32x32x16_bf16 v[32:47], v[88:91], v[120:123], 0
    ds_read_b128 v[88:91], v8 offset:38912
    ds_read_b128 v[108:111], v10 offset:8960
    v_exp_f32 v16, v16
    v_exp_f32 v17, v17
    v_exp_f32 v18, v18
    v_exp_f32 v19, v19
    v_mfma_f32_32x32x16_bf16 v[64:79], v[112:115], v[84:87], v[64:79]
    ds_read_b128 v[112:115], v11 offset:8960
    v_exp_f32 v20, v20
    v_exp_f32 v21, v21
    v_exp_f32 v22, v22
    v_exp_f32 v23, v23
    v_mfma_f32_32x32x8bf16_1k v[32:47], v[98:99], v[12:13], v[32:47]
    v_exp_f32 v24, v24
    v_exp_f32 v25, v25
    v_cvt_pk_bf16_f32 v80, v16, v17
    v_cvt_pk_bf16_f32 v81, v18, v19
    v_cvt_pk_bf16_f32 v82, v20, v21
    v_cvt_pk_bf16_f32 v83, v22, v23
    v_exp_f32 v26, v26
    v_exp_f32 v27, v27
    v_mfma_f32_32x32x16_bf16 v[48:63], v[100:103], v[80:83], v[48:63]
    v_exp_f32 v28, v28
    v_exp_f32 v29, v29
    v_exp_f32 v30, v30
    v_exp_f32 v31, v31
    v_cvt_pk_bf16_f32 v84, v24, v25
    v_cvt_pk_bf16_f32 v85, v26, v27
    v_cvt_pk_bf16_f32 v86, v28, v29
    v_cvt_pk_bf16_f32 v87, v30, v31
    v_mfma_f32_32x32x16_bf16 v[16:31], v[92:95], v[116:119], 0
    v_exp_f32 v32, v32
    v_exp_f32 v33, v33
    v_exp_f32 v34, v34
    v_exp_f32 v35, v35
    v_mfma_f32_32x32x16_bf16 v[48:63], v[104:107], v[84:87], v[48:63]
    v_exp_f32 v36, v36
    v_exp_f32 v37, v37
    v_exp_f32 v38, v38
    v_exp_f32_e64 v39, v39
    s_waitcnt lgkmcnt(0)
    v_mfma_f32_32x32x8bf16_1k v[16:31], v[98:99], v[126:127], v[16:31]
    v_exp_f32 v40, v40
    v_exp_f32 v41, v41
    v_cvt_pk_bf16_f32 v80, v32, v33
    v_cvt_pk_bf16_f32 v81, v34, v35
    v_cvt_pk_bf16_f32 v82, v36, v37
    v_cvt_pk_bf16_f32 v83, v38, v39
    v_exp_f32 v42, v42
    v_exp_f32 v43, v43
    v_mfma_f32_32x32x16_bf16 v[64:79], v[100:103], v[80:83], v[64:79]
    v_exp_f32 v44, v44
    v_exp_f32 v45, v45
    v_exp_f32 v46, v46
    v_exp_f32 v47, v47
    v_cvt_pk_bf16_f32 v84, v40, v41
    v_cvt_pk_bf16_f32 v85, v42, v43
    v_cvt_pk_bf16_f32 v86, v44, v45
    v_cvt_pk_bf16_f32 v87, v46, v47
    v_mfma_f32_32x32x16_bf16 v[32:47], v[92:95], v[120:123], 0
    ds_read_b128 v[92:95], v8 offset:39424
    ds_read_b128 v[100:103], v10 offset:38912
    v_exp_f32 v16, v16
    v_exp_f32 v17, v17
    v_exp_f32 v18, v18
    v_exp_f32 v19, v19
    v_mfma_f32_32x32x16_bf16 v[64:79], v[104:107], v[84:87], v[64:79]
    ds_read_b128 v[104:107], v11 offset:38912
    v_exp_f32 v20, v20
    v_exp_f32 v21, v21
    v_exp_f32 v22, v22
    v_exp_f32 v23, v23
    v_mfma_f32_32x32x8bf16_1k v[32:47], v[98:99], v[14:15], v[32:47]
    ds_read_b128 v[96:99], v9 offset:38912
    v_exp_f32 v24, v24
    v_exp_f32 v25, v25
    v_cvt_pk_bf16_f32 v80, v16, v17
    v_cvt_pk_bf16_f32 v81, v18, v19
    v_cvt_pk_bf16_f32 v82, v20, v21
    v_cvt_pk_bf16_f32 v83, v22, v23
    v_exp_f32 v26, v26
    v_exp_f32 v27, v27
    v_mfma_f32_32x32x16_bf16 v[48:63], v[108:111], v[80:83], v[48:63]
    v_exp_f32 v28, v28
    v_exp_f32 v29, v29
    v_exp_f32 v30, v30
    v_exp_f32 v31, v31
    v_cvt_pk_bf16_f32 v84, v24, v25
    v_cvt_pk_bf16_f32 v85, v26, v27
    v_cvt_pk_bf16_f32 v86, v28, v29
    v_cvt_pk_bf16_f32 v87, v30, v31
    v_mfma_f32_32x32x16_bf16 v[16:31], v[88:91], v[116:119], 0
    v_exp_f32 v32, v32
    v_exp_f32 v33, v33
    v_exp_f32 v34, v34
    v_exp_f32 v35, v35
    v_mfma_f32_32x32x16_bf16 v[48:63], v[112:115], v[84:87], v[48:63]
    v_exp_f32 v36, v36
    v_exp_f32 v37, v37
    v_exp_f32 v38, v38
    v_exp_f32 v39, v39
    s_waitcnt lgkmcnt(0)
    s_barrier
    s_setprio 3
    s_nop 0
    v_mfma_f32_32x32x8bf16_1k v[16:31], v[96:97], v[124:125], v[16:31]
    v_exp_f32 v40, v40
    v_exp_f32 v41, v41
    v_cvt_pk_bf16_f32 v80, v32, v33
    v_cvt_pk_bf16_f32 v81, v34, v35
    v_cvt_pk_bf16_f32 v82, v36, v37
    v_cvt_pk_bf16_f32 v83, v38, v39
    v_exp_f32 v42, v42
    v_exp_f32 v43, v43
    v_mfma_f32_32x32x16_bf16 v[64:79], v[108:111], v[80:83], v[64:79]
    v_exp_f32 v44, v44
    v_exp_f32 v45, v45
    v_exp_f32 v46, v46
    v_exp_f32 v47, v47
    v_cvt_pk_bf16_f32 v84, v40, v41
    v_cvt_pk_bf16_f32 v85, v42, v43
    v_cvt_pk_bf16_f32 v86, v44, v45
    v_cvt_pk_bf16_f32 v87, v46, v47
    v_mfma_f32_32x32x16_bf16 v[32:47], v[88:91], v[120:123], 0
    ds_read_b128 v[88:91], v8 offset:39936
    ds_read_b128 v[108:111], v10 offset:40192
    v_exp_f32 v16, v16
    v_exp_f32 v17, v17
    v_exp_f32 v18, v18
    v_exp_f32 v19, v19
    v_mfma_f32_32x32x16_bf16 v[64:79], v[112:115], v[84:87], v[64:79]
    ds_read_b128 v[112:115], v11 offset:40192
    v_exp_f32 v20, v20
    v_exp_f32 v21, v21
    v_exp_f32 v22, v22
    v_exp_f32 v23, v23
    v_mfma_f32_32x32x8bf16_1k v[32:47], v[96:97], v[12:13], v[32:47]
    v_exp_f32 v24, v24
    v_exp_f32 v25, v25
    v_cvt_pk_bf16_f32 v80, v16, v17
    v_cvt_pk_bf16_f32 v81, v18, v19
    v_cvt_pk_bf16_f32 v82, v20, v21
    v_cvt_pk_bf16_f32 v83, v22, v23
    v_exp_f32 v26, v26
    v_exp_f32 v27, v27
    v_mfma_f32_32x32x16_bf16 v[48:63], v[100:103], v[80:83], v[48:63]
    v_exp_f32 v28, v28
    v_exp_f32 v29, v29
    v_exp_f32 v30, v30
    v_exp_f32 v31, v31
    v_cvt_pk_bf16_f32 v84, v24, v25
    v_cvt_pk_bf16_f32 v85, v26, v27
    v_cvt_pk_bf16_f32 v86, v28, v29
    v_cvt_pk_bf16_f32 v87, v30, v31
    v_mfma_f32_32x32x16_bf16 v[16:31], v[92:95], v[116:119], 0
    v_exp_f32 v32, v32
    v_exp_f32 v33, v33
    v_exp_f32 v34, v34
    v_exp_f32 v35, v35
    v_mfma_f32_32x32x16_bf16 v[48:63], v[104:107], v[84:87], v[48:63]
    v_exp_f32 v36, v36
    v_exp_f32 v37, v37
    v_exp_f32 v38, v38
    v_exp_f32_e64 v39, v39
    s_waitcnt lgkmcnt(0)
    v_mfma_f32_32x32x8bf16_1k v[16:31], v[96:97], v[126:127], v[16:31]
    v_exp_f32 v40, v40
    v_exp_f32 v41, v41
    v_cvt_pk_bf16_f32 v80, v32, v33
    v_cvt_pk_bf16_f32 v81, v34, v35
    v_cvt_pk_bf16_f32 v82, v36, v37
    v_cvt_pk_bf16_f32 v83, v38, v39
    v_exp_f32 v42, v42
    v_exp_f32 v43, v43
    v_mfma_f32_32x32x16_bf16 v[64:79], v[100:103], v[80:83], v[64:79]
    v_exp_f32 v44, v44
    v_exp_f32 v45, v45
    v_exp_f32 v46, v46
    v_exp_f32 v47, v47
    v_cvt_pk_bf16_f32 v84, v40, v41
    v_cvt_pk_bf16_f32 v85, v42, v43
    v_cvt_pk_bf16_f32 v86, v44, v45
    v_cvt_pk_bf16_f32 v87, v46, v47
    v_mfma_f32_32x32x16_bf16 v[32:47], v[92:95], v[120:123], 0
    ds_read_b128 v[92:95], v8 offset:40448
    ds_read_b128 v[100:103], v10 offset:41472
    v_exp_f32 v16, v16
    v_exp_f32 v17, v17
    v_exp_f32 v18, v18
    v_exp_f32 v19, v19
    v_mfma_f32_32x32x16_bf16 v[64:79], v[104:107], v[84:87], v[64:79]
    ds_read_b128 v[104:107], v11 offset:41472
    v_exp_f32 v20, v20
    v_exp_f32 v21, v21
    v_exp_f32 v22, v22
    v_exp_f32 v23, v23
    v_mfma_f32_32x32x8bf16_1k v[32:47], v[96:97], v[14:15], v[32:47]
    v_exp_f32 v24, v24
    v_exp_f32 v25, v25
    v_cvt_pk_bf16_f32 v80, v16, v17
    v_cvt_pk_bf16_f32 v81, v18, v19
    v_cvt_pk_bf16_f32 v82, v20, v21
    v_cvt_pk_bf16_f32 v83, v22, v23
    v_exp_f32 v26, v26
    v_exp_f32 v27, v27
    v_mfma_f32_32x32x16_bf16 v[48:63], v[108:111], v[80:83], v[48:63]
    v_exp_f32 v28, v28
    v_exp_f32 v29, v29
    v_exp_f32 v30, v30
    v_exp_f32 v31, v31
    v_cvt_pk_bf16_f32 v84, v24, v25
    v_cvt_pk_bf16_f32 v85, v26, v27
    v_cvt_pk_bf16_f32 v86, v28, v29
    v_cvt_pk_bf16_f32 v87, v30, v31
    v_mfma_f32_32x32x16_bf16 v[16:31], v[88:91], v[116:119], 0
    v_exp_f32 v32, v32
    v_exp_f32 v33, v33
    v_exp_f32 v34, v34
    v_exp_f32 v35, v35
    v_mfma_f32_32x32x16_bf16 v[48:63], v[112:115], v[84:87], v[48:63]
    v_exp_f32 v36, v36
    v_exp_f32 v37, v37
    v_exp_f32 v38, v38
    v_exp_f32_e64 v39, v39
    s_waitcnt lgkmcnt(0)
    v_mfma_f32_32x32x8bf16_1k v[16:31], v[98:99], v[124:125], v[16:31]
    v_exp_f32 v40, v40
    v_exp_f32 v41, v41
    v_cvt_pk_bf16_f32 v80, v32, v33
    v_cvt_pk_bf16_f32 v81, v34, v35
    v_cvt_pk_bf16_f32 v82, v36, v37
    v_cvt_pk_bf16_f32 v83, v38, v39
    v_exp_f32 v42, v42
    v_exp_f32 v43, v43
    v_mfma_f32_32x32x16_bf16 v[64:79], v[108:111], v[80:83], v[64:79]
    v_exp_f32 v44, v44
    v_exp_f32 v45, v45
    v_exp_f32 v46, v46
    v_exp_f32 v47, v47
    v_cvt_pk_bf16_f32 v84, v40, v41
    v_cvt_pk_bf16_f32 v85, v42, v43
    v_cvt_pk_bf16_f32 v86, v44, v45
    v_cvt_pk_bf16_f32 v87, v46, v47
    v_mfma_f32_32x32x16_bf16 v[32:47], v[88:91], v[120:123], 0
    ds_read_b128 v[88:91], v8 offset:40960
    ds_read_b128 v[108:111], v10 offset:42752
    v_exp_f32 v16, v16
    v_exp_f32 v17, v17
    v_exp_f32 v18, v18
    v_exp_f32 v19, v19
    v_mfma_f32_32x32x16_bf16 v[64:79], v[112:115], v[84:87], v[64:79]
    ds_read_b128 v[112:115], v11 offset:42752
    v_exp_f32 v20, v20
    v_exp_f32 v21, v21
    v_exp_f32 v22, v22
    v_exp_f32 v23, v23
    v_mfma_f32_32x32x8bf16_1k v[32:47], v[98:99], v[12:13], v[32:47]
    v_exp_f32 v24, v24
    v_exp_f32 v25, v25
    v_cvt_pk_bf16_f32 v80, v16, v17
    v_cvt_pk_bf16_f32 v81, v18, v19
    v_cvt_pk_bf16_f32 v82, v20, v21
    v_cvt_pk_bf16_f32 v83, v22, v23
    v_exp_f32 v26, v26
    v_exp_f32 v27, v27
    v_mfma_f32_32x32x16_bf16 v[48:63], v[100:103], v[80:83], v[48:63]
    v_exp_f32 v28, v28
    v_exp_f32 v29, v29
    v_exp_f32 v30, v30
    v_exp_f32 v31, v31
    v_cvt_pk_bf16_f32 v84, v24, v25
    v_cvt_pk_bf16_f32 v85, v26, v27
    v_cvt_pk_bf16_f32 v86, v28, v29
    v_cvt_pk_bf16_f32 v87, v30, v31
    v_mfma_f32_32x32x16_bf16 v[16:31], v[92:95], v[116:119], 0
    v_exp_f32 v32, v32
    v_exp_f32 v33, v33
    v_exp_f32 v34, v34
    v_exp_f32 v35, v35
    v_mfma_f32_32x32x16_bf16 v[48:63], v[104:107], v[84:87], v[48:63]
    v_exp_f32 v36, v36
    v_exp_f32 v37, v37
    v_exp_f32 v38, v38
    v_exp_f32 v39, v39
    s_waitcnt lgkmcnt(0)
    s_setprio 2
    v_mfma_f32_32x32x8bf16_1k v[16:31], v[98:99], v[126:127], v[16:31]
    v_exp_f32 v40, v40
    v_exp_f32 v41, v41
    v_cvt_pk_bf16_f32 v80, v32, v33
    v_cvt_pk_bf16_f32 v81, v34, v35
    v_cvt_pk_bf16_f32 v82, v36, v37
    v_cvt_pk_bf16_f32 v83, v38, v39
    v_exp_f32 v42, v42
    v_exp_f32 v43, v43
    v_mfma_f32_32x32x16_bf16 v[64:79], v[100:103], v[80:83], v[64:79]
    v_exp_f32 v44, v44
    v_exp_f32 v45, v45
    v_exp_f32 v46, v46
    v_exp_f32 v47, v47
    v_cvt_pk_bf16_f32 v84, v40, v41
    v_cvt_pk_bf16_f32 v85, v42, v43
    v_cvt_pk_bf16_f32 v86, v44, v45
    v_cvt_pk_bf16_f32 v87, v46, v47
    v_mfma_f32_32x32x16_bf16 v[32:47], v[92:95], v[120:123], 0
    ds_read_b128 v[92:95], v8 offset:41472
    ds_read_b128 v[100:103], v10 offset:44032
    v_exp_f32 v16, v16
    v_exp_f32 v17, v17
    v_exp_f32 v18, v18
    v_exp_f32 v19, v19
    v_mfma_f32_32x32x16_bf16 v[64:79], v[104:107], v[84:87], v[64:79]
    ds_read_b128 v[104:107], v11 offset:44032
    v_exp_f32 v20, v20
    v_exp_f32 v21, v21
    v_exp_f32 v22, v22
    v_exp_f32 v23, v23
    v_mfma_f32_32x32x8bf16_1k v[32:47], v[98:99], v[14:15], v[32:47]
    ds_read_b128 v[96:99], v9 offset:39424
    v_exp_f32 v24, v24
    v_exp_f32 v25, v25
    v_cvt_pk_bf16_f32 v80, v16, v17
    v_cvt_pk_bf16_f32 v81, v18, v19
    v_cvt_pk_bf16_f32 v82, v20, v21
    v_cvt_pk_bf16_f32 v83, v22, v23
    v_exp_f32 v26, v26
    v_exp_f32 v27, v27
    v_mfma_f32_32x32x16_bf16 v[48:63], v[108:111], v[80:83], v[48:63]
    v_exp_f32 v28, v28
    v_exp_f32 v29, v29
    v_exp_f32 v30, v30
    v_exp_f32 v31, v31
    v_cvt_pk_bf16_f32 v84, v24, v25
    v_cvt_pk_bf16_f32 v85, v26, v27
    v_cvt_pk_bf16_f32 v86, v28, v29
    v_cvt_pk_bf16_f32 v87, v30, v31
    v_mfma_f32_32x32x16_bf16 v[16:31], v[88:91], v[116:119], 0
    v_exp_f32 v32, v32
    v_exp_f32 v33, v33
    v_exp_f32 v34, v34
    v_exp_f32 v35, v35
    v_mfma_f32_32x32x16_bf16 v[48:63], v[112:115], v[84:87], v[48:63]
    v_exp_f32 v36, v36
    v_exp_f32 v37, v37
    v_exp_f32 v38, v38
    v_exp_f32_e64 v39, v39
    s_waitcnt lgkmcnt(0)
    v_mfma_f32_32x32x8bf16_1k v[16:31], v[96:97], v[124:125], v[16:31]
    v_exp_f32 v40, v40
    v_exp_f32 v41, v41
    v_cvt_pk_bf16_f32 v80, v32, v33
    v_cvt_pk_bf16_f32 v81, v34, v35
    v_cvt_pk_bf16_f32 v82, v36, v37
    v_cvt_pk_bf16_f32 v83, v38, v39
    v_exp_f32 v42, v42
    v_exp_f32 v43, v43
    v_mfma_f32_32x32x16_bf16 v[64:79], v[108:111], v[80:83], v[64:79]
    v_exp_f32 v44, v44
    v_exp_f32 v45, v45
    v_exp_f32 v46, v46
    v_exp_f32 v47, v47
    v_cvt_pk_bf16_f32 v84, v40, v41
    v_cvt_pk_bf16_f32 v85, v42, v43
    v_cvt_pk_bf16_f32 v86, v44, v45
    v_cvt_pk_bf16_f32 v87, v46, v47
    v_mfma_f32_32x32x16_bf16 v[32:47], v[88:91], v[120:123], 0
    ds_read_b128 v[88:91], v8 offset:41984
    ds_read_b128 v[108:111], v10 offset:45312
    v_exp_f32 v16, v16
    v_exp_f32 v17, v17
    v_exp_f32 v18, v18
    v_exp_f32 v19, v19
    v_mfma_f32_32x32x16_bf16 v[64:79], v[112:115], v[84:87], v[64:79]
    ds_read_b128 v[112:115], v11 offset:45312
    v_exp_f32 v20, v20
    v_exp_f32 v21, v21
    v_exp_f32 v22, v22
    v_exp_f32 v23, v23
    v_mfma_f32_32x32x8bf16_1k v[32:47], v[96:97], v[12:13], v[32:47]
    v_exp_f32 v24, v24
    v_exp_f32 v25, v25
    v_cvt_pk_bf16_f32 v80, v16, v17
    v_cvt_pk_bf16_f32 v81, v18, v19
    v_cvt_pk_bf16_f32 v82, v20, v21
    v_cvt_pk_bf16_f32 v83, v22, v23
    v_exp_f32 v26, v26
    v_exp_f32 v27, v27
    v_mfma_f32_32x32x16_bf16 v[48:63], v[100:103], v[80:83], v[48:63]
    v_exp_f32 v28, v28
    v_exp_f32 v29, v29
    v_exp_f32 v30, v30
    v_exp_f32 v31, v31
    v_cvt_pk_bf16_f32 v84, v24, v25
    v_cvt_pk_bf16_f32 v85, v26, v27
    v_cvt_pk_bf16_f32 v86, v28, v29
    v_cvt_pk_bf16_f32 v87, v30, v31
    v_mfma_f32_32x32x16_bf16 v[16:31], v[92:95], v[116:119], 0
    v_exp_f32 v32, v32
    v_exp_f32 v33, v33
    v_exp_f32 v34, v34
    v_exp_f32 v35, v35
    v_mfma_f32_32x32x16_bf16 v[48:63], v[104:107], v[84:87], v[48:63]
    v_exp_f32 v36, v36
    v_exp_f32 v37, v37
    v_exp_f32 v38, v38
    v_exp_f32_e64 v39, v39
    s_waitcnt lgkmcnt(0)
    v_mfma_f32_32x32x8bf16_1k v[16:31], v[96:97], v[126:127], v[16:31]
    v_exp_f32 v40, v40
    v_exp_f32 v41, v41
    v_cvt_pk_bf16_f32 v80, v32, v33
    v_cvt_pk_bf16_f32 v81, v34, v35
    v_cvt_pk_bf16_f32 v82, v36, v37
    v_cvt_pk_bf16_f32 v83, v38, v39
    v_exp_f32 v42, v42
    v_exp_f32 v43, v43
    v_mfma_f32_32x32x16_bf16 v[64:79], v[100:103], v[80:83], v[64:79]
    v_exp_f32 v44, v44
    v_exp_f32 v45, v45
    v_exp_f32 v46, v46
    v_exp_f32 v47, v47
    v_cvt_pk_bf16_f32 v84, v40, v41
    v_cvt_pk_bf16_f32 v85, v42, v43
    v_cvt_pk_bf16_f32 v86, v44, v45
    v_cvt_pk_bf16_f32 v87, v46, v47
    v_mfma_f32_32x32x16_bf16 v[32:47], v[92:95], v[120:123], 0
    ds_read_b128 v[92:95], v8 offset:42496
    ds_read_b128 v[100:103], v10 offset:46592
    v_exp_f32 v16, v16
    v_exp_f32 v17, v17
    v_exp_f32 v18, v18
    v_exp_f32 v19, v19
    v_mfma_f32_32x32x16_bf16 v[64:79], v[104:107], v[84:87], v[64:79]
    ds_read_b128 v[104:107], v11 offset:46592
    v_exp_f32 v20, v20
    v_exp_f32 v21, v21
    v_exp_f32 v22, v22
    v_exp_f32 v23, v23
    v_mfma_f32_32x32x8bf16_1k v[32:47], v[96:97], v[14:15], v[32:47]
    v_exp_f32 v24, v24
    v_exp_f32 v25, v25
    v_cvt_pk_bf16_f32 v80, v16, v17
    v_cvt_pk_bf16_f32 v81, v18, v19
    v_cvt_pk_bf16_f32 v82, v20, v21
    v_cvt_pk_bf16_f32 v83, v22, v23
    v_exp_f32 v26, v26
    v_exp_f32 v27, v27
    v_mfma_f32_32x32x16_bf16 v[48:63], v[108:111], v[80:83], v[48:63]
    v_exp_f32 v28, v28
    v_exp_f32 v29, v29
    v_exp_f32 v30, v30
    v_exp_f32 v31, v31
    v_cvt_pk_bf16_f32 v84, v24, v25
    v_cvt_pk_bf16_f32 v85, v26, v27
    v_cvt_pk_bf16_f32 v86, v28, v29
    v_cvt_pk_bf16_f32 v87, v30, v31
    v_mfma_f32_32x32x16_bf16 v[16:31], v[88:91], v[116:119], 0
    v_exp_f32 v32, v32
    v_exp_f32 v33, v33
    v_exp_f32 v34, v34
    v_exp_f32 v35, v35
    v_mfma_f32_32x32x16_bf16 v[48:63], v[112:115], v[84:87], v[48:63]
    v_exp_f32 v36, v36
    v_exp_f32 v37, v37
    v_exp_f32 v38, v38
    v_exp_f32 v39, v39
    s_waitcnt lgkmcnt(0)
    s_setprio 1
    v_mfma_f32_32x32x8bf16_1k v[16:31], v[98:99], v[124:125], v[16:31]
    v_exp_f32 v40, v40
    v_exp_f32 v41, v41
    v_cvt_pk_bf16_f32 v80, v32, v33
    v_cvt_pk_bf16_f32 v81, v34, v35
    v_cvt_pk_bf16_f32 v82, v36, v37
    v_cvt_pk_bf16_f32 v83, v38, v39
    v_exp_f32 v42, v42
    v_exp_f32 v43, v43
    v_mfma_f32_32x32x16_bf16 v[64:79], v[108:111], v[80:83], v[64:79]
    v_exp_f32 v44, v44
    v_exp_f32 v45, v45
    v_exp_f32 v46, v46
    v_exp_f32 v47, v47
    v_cvt_pk_bf16_f32 v84, v40, v41
    v_cvt_pk_bf16_f32 v85, v42, v43
    v_cvt_pk_bf16_f32 v86, v44, v45
    v_cvt_pk_bf16_f32 v87, v46, v47
    v_mfma_f32_32x32x16_bf16 v[32:47], v[88:91], v[120:123], 0
    ds_read_b128 v[108:111], v10 offset:47872
    v_exp_f32 v16, v16
    v_exp_f32 v17, v17
    v_exp_f32 v18, v18
    v_exp_f32 v19, v19
    v_mfma_f32_32x32x16_bf16 v[64:79], v[112:115], v[84:87], v[64:79]
    ds_read_b128 v[112:115], v11 offset:47872
    v_exp_f32 v20, v20
    v_exp_f32 v21, v21
    v_exp_f32 v22, v22
    v_exp_f32 v23, v23
    v_mfma_f32_32x32x8bf16_1k v[32:47], v[98:99], v[12:13], v[32:47]
    v_exp_f32 v24, v24
    v_exp_f32 v25, v25
    v_cvt_pk_bf16_f32 v80, v16, v17
    v_cvt_pk_bf16_f32 v81, v18, v19
    v_cvt_pk_bf16_f32 v82, v20, v21
    v_cvt_pk_bf16_f32 v83, v22, v23
    v_exp_f32 v26, v26
    v_exp_f32 v27, v27
    v_mfma_f32_32x32x16_bf16 v[48:63], v[100:103], v[80:83], v[48:63]
    v_exp_f32 v28, v28
    v_exp_f32 v29, v29
    v_exp_f32 v30, v30
    v_exp_f32 v31, v31
    v_cvt_pk_bf16_f32 v84, v24, v25
    v_cvt_pk_bf16_f32 v85, v26, v27
    v_cvt_pk_bf16_f32 v86, v28, v29
    v_cvt_pk_bf16_f32 v87, v30, v31
    v_mfma_f32_32x32x16_bf16 v[16:31], v[92:95], v[116:119], 0
    v_exp_f32 v32, v32
    v_exp_f32 v33, v33
    v_exp_f32 v34, v34
    v_exp_f32 v35, v35
    v_mfma_f32_32x32x16_bf16 v[48:63], v[104:107], v[84:87], v[48:63]
    v_exp_f32 v36, v36
    v_exp_f32 v37, v37
    v_exp_f32 v38, v38
    v_exp_f32_e64 v39, v39
    s_waitcnt lgkmcnt(0)
    v_mfma_f32_32x32x8bf16_1k v[16:31], v[98:99], v[126:127], v[16:31]
    v_exp_f32 v40, v40
    v_exp_f32 v41, v41
    v_cvt_pk_bf16_f32 v80, v32, v33
    v_cvt_pk_bf16_f32 v81, v34, v35
    v_cvt_pk_bf16_f32 v82, v36, v37
    v_cvt_pk_bf16_f32 v83, v38, v39
    v_exp_f32 v42, v42
    v_exp_f32 v43, v43
    v_mfma_f32_32x32x16_bf16 v[64:79], v[100:103], v[80:83], v[64:79]
    v_exp_f32 v44, v44
    v_exp_f32 v45, v45
    v_exp_f32 v46, v46
    v_exp_f32 v47, v47
    v_cvt_pk_bf16_f32 v84, v40, v41
    v_cvt_pk_bf16_f32 v85, v42, v43
    v_cvt_pk_bf16_f32 v86, v44, v45
    v_cvt_pk_bf16_f32 v87, v46, v47
    v_mfma_f32_32x32x16_bf16 v[32:47], v[92:95], v[120:123], 0
    v_exp_f32 v16, v16
    v_exp_f32 v17, v17
    v_exp_f32 v18, v18
    v_exp_f32 v19, v19
    v_mfma_f32_32x32x16_bf16 v[64:79], v[104:107], v[84:87], v[64:79]
    v_exp_f32 v20, v20
    v_exp_f32 v21, v21
    v_exp_f32 v22, v22
    v_exp_f32 v23, v23
    v_mfma_f32_32x32x8bf16_1k v[32:47], v[98:99], v[14:15], v[32:47]
    v_exp_f32 v24, v24
    v_exp_f32 v25, v25
    v_cvt_pk_bf16_f32 v80, v16, v17
    v_cvt_pk_bf16_f32 v81, v18, v19
    v_cvt_pk_bf16_f32 v82, v20, v21
    v_cvt_pk_bf16_f32 v83, v22, v23
    v_exp_f32 v26, v26
    v_exp_f32 v27, v27
    v_mfma_f32_32x32x16_bf16 v[48:63], v[108:111], v[80:83], v[48:63]
    v_exp_f32 v28, v28
    v_exp_f32 v29, v29
    v_exp_f32 v30, v30
    v_exp_f32 v31, v31
    v_cvt_pk_bf16_f32 v84, v24, v25
    v_cvt_pk_bf16_f32 v85, v26, v27
    v_cvt_pk_bf16_f32 v86, v28, v29
    v_cvt_pk_bf16_f32 v87, v30, v31
    v_exp_f32 v32, v32
    v_exp_f32 v33, v33
    v_exp_f32 v34, v34
    v_exp_f32 v35, v35
    v_mfma_f32_32x32x16_bf16 v[48:63], v[112:115], v[84:87], v[48:63]
    v_exp_f32 v36, v36
    v_exp_f32 v37, v37
    v_exp_f32 v38, v38
    v_exp_f32 v39, v39
    v_exp_f32 v40, v40
    v_exp_f32 v41, v41
    v_cvt_pk_bf16_f32 v80, v32, v33
    v_cvt_pk_bf16_f32 v81, v34, v35
    v_cvt_pk_bf16_f32 v82, v36, v37
    v_cvt_pk_bf16_f32 v83, v38, v39
    v_exp_f32 v42, v42
    v_exp_f32 v43, v43
    v_mfma_f32_32x32x16_bf16 v[64:79], v[108:111], v[80:83], v[64:79]
    v_exp_f32 v44, v44
    v_exp_f32 v45, v45
    v_exp_f32 v46, v46
    v_exp_f32 v47, v47
    v_cvt_pk_bf16_f32 v84, v40, v41
    v_cvt_pk_bf16_f32 v85, v42, v43
    v_cvt_pk_bf16_f32 v86, v44, v45
    v_cvt_pk_bf16_f32 v87, v46, v47
    s_nop 1
    v_mfma_f32_32x32x16_bf16 v[64:79], v[112:115], v[84:87], v[64:79]
    v_and_b32 v1, 31, v0
    v_lshrrev_b32 v2, 5, v0
    s_lshl_b32 s6, s5, 12
    v_add_u32 v6, s6, v3
    v_xor_b32 v7, 0x4000, v6
    s_lshl_b32 s6, s4, 8
    s_lshl_b32 s7, s76, 6
    s_add_u32 s6, s6, s7
    s_lshl_b32 s7, s77, 5
    s_add_u32 s6, s6, s7
    v_add_u32 v4, s6, v1
    v_lshlrev_b32 v4, 4, v4
    v_lshl_add_u32 v5, v2, 15, v4
    s_mul_i32 s12, s3, 98304
    s_add_u32 s12, s12, 14712832
    s_add_u32 s13, s12, 65536
    s_cmp_eq_u32 s77, 0
    s_cbranch_scc1 A_x0
    ds_write_b128 v6, v[48:51] offset:0
    ds_write_b128 v6, v[52:55] offset:1024
    ds_write_b128 v6, v[56:59] offset:2048
    ds_write_b128 v6, v[60:63] offset:3072
    v_mov_b32 v48, v64
    v_mov_b32 v49, v65
    v_mov_b32 v50, v66
    v_mov_b32 v51, v67
    v_mov_b32 v52, v68
    v_mov_b32 v53, v69
    v_mov_b32 v54, v70
    v_mov_b32 v55, v71
    v_mov_b32 v56, v72
    v_mov_b32 v57, v73
    v_mov_b32 v58, v74
    v_mov_b32 v59, v75
    v_mov_b32 v60, v76
    v_mov_b32 v116, v120
    v_mov_b32 v124, v12
    v_mov_b32 v117, v121
    v_mov_b32 v125, v13
    v_mov_b32 v118, v122
    v_mov_b32 v126, v14
    v_mov_b32 v119, v123
    v_mov_b32 v127, v15
    s_branch A_x1
A_x0:
    ds_write_b128 v6, v[64:67] offset:0
    ds_write_b128 v6, v[68:71] offset:1024
    ds_write_b128 v6, v[72:75] offset:2048
    ds_write_b128 v6, v[76:79] offset:3072
A_x1:
    s_mov_b32 s14, 562036736
    s_mov_b32 s15, 1568669696
    s_movk_i32 s46, 0x207
    s_waitcnt lgkmcnt(0)
    s_barrier
    ds_read_b128 v[32:35], v7 offset:0
    ds_read_b128 v[36:39], v7 offset:1024
    ds_read_b128 v[40:43], v7 offset:2048
    ds_read_b128 v[44:47], v7 offset:3072
    s_waitcnt lgkmcnt(0)
    v_add_f32 v48, v48, v32
    v_add_f32 v49, v49, v33
    v_add_f32 v50, v50, v34
    v_add_f32 v51, v51, v35
    v_add_f32 v52, v52, v36
    v_add_f32 v53, v53, v37
    v_add_f32 v54, v54, v38
    v_add_f32 v55, v55, v39
    v_add_f32 v56, v56, v40
    v_add_f32 v57, v57, v41
    v_add_f32 v58, v58, v42
    v_add_f32 v59, v59, v43
    v_add_f32 v60, v60, v44
    v_cndmask_b32 v6, v58, v60, s[8:9]
    v_add_f32 v7, |v48|, |v49|
    v_add_f32 v7, v7, |v50|
    v_add_f32 v7, v7, |v51|
    v_add_f32 v7, v7, |v52|
    v_add_f32 v7, v7, |v53|
    v_add_f32 v7, v7, |v54|
    v_add_f32 v7, v7, |v55|
    v_add_f32 v7, v7, |v56|
    v_add_f32 v7, v7, |v57|
    v_cmp_nle_f32 vcc, s14, v6
    v_cmp_lt_f32 s[68:69], s15, v6
    v_cmp_class_f32 s[70:71], v7, s46
    s_or_b64 vcc, vcc, s[68:69]
    s_or_b64 vcc, vcc, s[70:71]
    s_cbranch_vccnz K2_slow
K2_fin:
    v_rcp_f32 v6, v6
    v_mov_b32 v21, 0
    v_mov_b32 v22, 0
    v_mov_b32 v23, 0
    v_mul_f32 v48, v6, v48
    v_mul_f32 v49, v6, v49
    v_mul_f32 v50, v6, v50
    v_mul_f32 v51, v6, v51
    v_mul_f32 v52, v6, v52
    v_mul_f32 v53, v6, v53
    v_mul_f32 v54, v6, v54
    v_mul_f32 v55, v6, v55
    v_mul_f32 v56, v6, v56
    v_mul_f32 v57, v6, v57
    v_cvt_pk_bf16_f32 v16, v48, v49
    v_cvt_pk_bf16_f32 v17, v50, v51
    v_cvt_pk_bf16_f32 v18, v52, v53
    v_cvt_pk_bf16_f32 v19, v54, v55
    v_cvt_pk_bf16_f32 v20, v56, v57
    buffer_store_dwordx4 v[16:19], v5, s[60:63], s12 offen sc1
    s_mov_b64 exec, 0xffffffff
    buffer_store_dwordx4 v[20:23], v4, s[60:63], s13 offen sc1
    s_mov_b64 exec, -1
    s_lshl_b32 s74, s4, 9
    s_add_u32 s74, s74, 18017280
    s_lshr_b32 s6, s3, 2
    s_sub_u32 s79, s3, s6
    s_sub_u32 s79, s79, 1
    s_and_b32 s6, s3, 3
    s_cselect_b32 s79, s79, 24
    s_mul_i32 s14, s79, 43
    s_lshr_b32 s14, s14, 8
    s_mul_i32 s15, s14, 6
    s_sub_u32 s15, s79, s15
    s_lshl_b32 s6, s4, 2
    s_add_u32 s14, s14, s6
    s_cmp_lt_u32 s5, 4
    s_cbranch_scc1 K2_pc
    s_sub_u32 s6, s5, 4
    s_mov_b32 s52, s20
    s_mov_b32 s53, s21
    s_mov_b32 s54, 663552
    s_mov_b32 s55, 0x00020000
    s_nop 0
    v_lshlrev_b32 v1, 4, v0
    s_lshl_b32 s7, s6, 6
    v_add_u32 v12, s7, v0
    v_add_u32 v12, 0, v12
    v_min_u32 v12, 431, v12
    v_mul_u32_u24 v13, 5462, v12
    v_lshrrev_b32 v13, 16, v13
    v_mul_u32_u24 v13, 960, v13
    v_lshl_add_u32 v2, v12, 4, v13
    v_add_u32 v12, s7, v0
    v_add_u32 v12, 256, v12
    v_min_u32 v12, 431, v12
    v_mul_u32_u24 v13, 5462, v12
    v_lshrrev_b32 v13, 16, v13
    v_mul_u32_u24 v13, 960, v13
    v_lshl_add_u32 v3, v12, 4, v13
    s_lshl_b32 s68, s14, 10
    s_lshl_b32 s7, s6, 15
    s_add_u32 s68, s68, s7
    s_add_u32 s68, s68, 14712832
    s_mul_i32 s69, s15, 192
    s_lshl_b32 s76, s6, 10
    s_waitcnt vmcnt(0)
    s_barrier
    s_cmp_ge_u32 s79, 24
    s_cbranch_scc1 K2_done
    s_cmp_eq_u32 s6, 2
    s_cbranch_scc1 A_l1
    s_cmp_eq_u32 s6, 3
    s_cbranch_scc1 A_l2
    s_add_u32 m0, s76, 6144
    s_add_u32 s72, s69, 0
    buffer_load_dwordx4 v2, s[52:55], s72 offen lds
    s_add_u32 m0, s76, 10240
    s_add_u32 s72, s69, 0
    buffer_load_dwordx4 v3, s[52:55], s72 offen lds
    s_add_u32 m0, s76, 19456
    s_add_u32 s72, s69, 41472
    buffer_load_dwordx4 v2, s[52:55], s72 offen lds
    s_add_u32 m0, s76, 23552
    s_add_u32 s72, s69, 41472
    buffer_load_dwordx4 v3, s[52:55], s72 offen lds
    s_add_u32 m0, s76, 32768
    s_add_u32 s72, s69, 82944
    buffer_load_dwordx4 v2, s[52:55], s72 offen lds
    s_add_u32 m0, s76, 36864
    s_add_u32 s72, s69, 82944
    buffer_load_dwordx4 v3, s[52:55], s72 offen lds
    s_add_u32 m0, s76, 46080
    s_add_u32 s72, s69, 124416
    buffer_load_dwordx4 v2, s[52:55], s72 offen lds
    s_add_u32 m0, s76, 50176
    s_add_u32 s72, s69, 124416
    buffer_load_dwordx4 v3, s[52:55], s72 offen lds
    s_barrier
    s_add_u32 m0, s76, 0
    s_add_u32 s72, s68, 0
    buffer_load_dwordx4 v1, s[60:63], s72 offen sc1 lds
    s_add_u32 m0, s76, 4096
    s_add_u32 s72, s68, 131072
    buffer_load_dwordx4 v1, s[60:63], s72 offen sc1 lds
    s_add_u32 m0, s76, 13312
    s_add_u32 s72, s68, 196608
    buffer_load_dwordx4 v1, s[60:63], s72 offen sc1 lds
    s_add_u32 m0, s76, 17408
    s_add_u32 s72, s68, 327680
    buffer_load_dwordx4 v1, s[60:63], s72 offen sc1 lds
    s_add_u32 m0, s76, 26624
    s_add_u32 s72, s68, 393216
    buffer_load_dwordx4 v1, s[60:63], s72 offen sc1 lds
    s_add_u32 m0, s76, 30720
    s_add_u32 s72, s68, 524288
    buffer_load_dwordx4 v1, s[60:63], s72 offen sc1 lds
    s_add_u32 m0, s76, 39936
    s_add_u32 s72, s68, 589824
    buffer_load_dwordx4 v1, s[60:63], s72 offen sc1 lds
    s_add_u32 m0, s76, 44032
    s_add_u32 s72, s68, 720896
    buffer_load_dwordx4 v1, s[60:63], s72 offen sc1 lds
    s_waitcnt vmcnt(6)
    s_barrier
    s_add_u32 m0, s76, 59392
    s_add_u32 s72, s69, 165888
    buffer_load_dwordx4 v2, s[52:55], s72 offen lds
    s_add_u32 m0, s76, 63488
    s_add_u32 s72, s69, 165888
    buffer_load_dwordx4 v3, s[52:55], s72 offen lds
    s_add_u32 m0, s76, 53248
    s_add_u32 s72, s68, 786432
    buffer_load_dwordx4 v1, s[60:63], s72 offen sc1 lds
    s_add_u32 m0, s76, 57344
    s_add_u32 s72, s68, 917504
    buffer_load_dwordx4 v1, s[60:63], s72 offen sc1 lds
    s_waitcnt vmcnt(8)
    s_barrier
    s_add_u32 m0, s76, 72704
    s_add_u32 s72, s69, 207360
    buffer_load_dwordx4 v2, s[52:55], s72 offen lds
    s_add_u32 m0, s76, 76800
    s_add_u32 s72, s69, 207360
    buffer_load_dwordx4 v3, s[52:55], s72 offen lds
    s_add_u32 m0, s76, 66560
    s_add_u32 s72, s68, 983040
    buffer_load_dwordx4 v1, s[60:63], s72 offen sc1 lds
    s_add_u32 m0, s76, 70656
    s_add_u32 s72, s68, 1114112
    buffer_load_dwordx4 v1, s[60:63], s72 offen sc1 lds
    s_waitcnt vmcnt(10)
    s_barrier
    s_add_u32 m0, s76, 6144
    s_add_u32 s72, s69, 248832
    buffer_load_dwordx4 v2, s[52:55], s72 offen lds
    s_add_u32 m0, s76, 10240
    s_add_u32 s72, s69, 248832
    buffer_load_dwordx4 v3, s[52:55], s72 offen lds
    s_add_u32 m0, s76, 0
    s_add_u32 s72, s68, 1179648
    buffer_load_dwordx4 v1, s[60:63], s72 offen sc1 lds
    s_add_u32 m0, s76, 4096
    s_add_u32 s72, s68, 1310720
    buffer_load_dwordx4 v1, s[60:63], s72 offen sc1 lds
    s_waitcnt vmcnt(12)
    s_barrier
    s_add_u32 m0, s76, 19456
    s_add_u32 s72, s69, 290304
    buffer_load_dwordx4 v2, s[52:55], s72 offen lds
    s_add_u32 m0, s76, 23552
    s_add_u32 s72, s69, 290304
    buffer_load_dwordx4 v3, s[52:55], s72 offen lds
    s_add_u32 m0, s76, 13312
    s_add_u32 s72, s68, 1376256
    buffer_load_dwordx4 v1, s[60:63], s72 offen sc1 lds
    s_add_u32 m0, s76, 17408
    s_add_u32 s72, s68, 1507328
    buffer_load_dwordx4 v1, s[60:63], s72 offen sc1 lds
    s_waitcnt vmcnt(12)
    s_barrier
    s_add_u32 m0, s76, 32768
    s_add_u32 s72, s69, 331776
    buffer_load_dwordx4 v2, s[52:55], s72 offen lds
    s_add_u32 m0, s76, 36864
    s_add_u32 s72, s69, 331776
    buffer_load_dwordx4 v3, s[52:55], s72 offen lds
    s_add_u32 m0, s76, 26624
    s_add_u32 s72, s68, 1572864
    buffer_load_dwordx4 v1, s[60:63], s72 offen sc1 lds
    s_add_u32 m0, s76, 30720
    s_add_u32 s72, s68, 1703936
    buffer_load_dwordx4 v1, s[60:63], s72 offen sc1 lds
    s_waitcnt vmcnt(12)
    s_barrier
    s_add_u32 m0, s76, 46080
    s_add_u32 s72, s69, 373248
    buffer_load_dwordx4 v2, s[52:55], s72 offen lds
    s_add_u32 m0, s76, 50176
    s_add_u32 s72, s69, 373248
    buffer_load_dwordx4 v3, s[52:55], s72 offen lds
    s_add_u32 m0, s76, 39936
    s_add_u32 s72, s68, 1769472
    buffer_load_dwordx4 v1, s[60:63], s72 offen sc1 lds
    s_add_u32 m0, s76, 44032
    s_add_u32 s72, s68, 1900544
    buffer_load_dwordx4 v1, s[60:63], s72 offen sc1 lds
    s_waitcnt vmcnt(12)
    s_barrier
    s_add_u32 m0, s76, 59392
    s_add_u32 s72, s69, 414720
    buffer_load_dwordx4 v2, s[52:55], s72 offen lds
    s_add_u32 m0, s76, 63488
    s_add_u32 s72, s69, 414720
    buffer_load_dwordx4 v3, s[52:55], s72 offen lds
    s_add_u32 m0, s76, 53248
    s_add_u32 s72, s68, 1966080
    buffer_load_dwordx4 v1, s[60:63], s72 offen sc1 lds
    s_add_u32 m0, s76, 57344
    s_add_u32 s72, s68, 2097152
    buffer_load_dwordx4 v1, s[60:63], s72 offen sc1 lds
    s_waitcnt vmcnt(12)
    s_barrier
    s_add_u32 m0, s76, 72704
    s_add_u32 s72, s69, 456192
    buffer_load_dwordx4 v2, s[52:55], s72 offen lds
    s_add_u32 m0, s76, 76800
    s_add_u32 s72, s69, 456192
    buffer_load_dwordx4 v3, s[52:55], s72 offen lds
    s_add_u32 m0, s76, 66560
    s_add_u32 s72, s68, 2162688
    buffer_load_dwordx4 v1, s[60:63], s72 offen sc1 lds
    s_add_u32 m0, s76, 70656
    s_add_u32 s72, s68, 2293760
    buffer_load_dwordx4 v1, s[60:63], s72 offen sc1 lds
    s_waitcnt vmcnt(12)
    s_barrier
    s_add_u32 m0, s76, 6144
    s_add_u32 s72, s69, 497664
    buffer_load_dwordx4 v2, s[52:55], s72 offen lds
    s_add_u32 m0, s76, 10240
    s_add_u32 s72, s69, 497664
    buffer_load_dwordx4 v3, s[52:55], s72 offen lds
    s_add_u32 m0, s76, 0
    s_add_u32 s72, s68, 2359296
    buffer_load_dwordx4 v1, s[60:63], s72 offen sc1 lds
    s_add_u32 m0, s76, 4096
    s_add_u32 s72, s68, 2490368
    buffer_load_dwordx4 v1, s[60:63], s72 offen sc1 lds
    s_waitcnt vmcnt(12)
    s_barrier
    s_add_u32 m0, s76, 19456
    s_add_u32 s72, s69, 539136
    buffer_load_dwordx4 v2, s[52:55], s72 offen lds
    s_add_u32 m0, s76, 23552
    s_add_u32 s72, s69, 539136
    buffer_load_dwordx4 v3, s[52:55], s72 offen lds
    s_add_u32 m0, s76, 13312
    s_add_u32 s72, s68, 2555904
    buffer_load_dwordx4 v1, s[60:63], s72 offen sc1 lds
    s_add_u32 m0, s76, 17408
    s_add_u32 s72, s68, 2686976
    buffer_load_dwordx4 v1, s[60:63], s72 offen sc1 lds
    s_waitcnt vmcnt(12)
    s_barrier
    s_add_u32 m0, s76, 32768
    s_add_u32 s72, s69, 580608
    buffer_load_dwordx4 v2, s[52:55], s72 offen lds
    s_add_u32 m0, s76, 36864
    s_add_u32 s72, s69, 580608
    buffer_load_dwordx4 v3, s[52:55], s72 offen lds
    s_add_u32 m0, s76, 26624
    s_add_u32 s72, s68, 2752512
    buffer_load_dwordx4 v1, s[60:63], s72 offen sc1 lds
    s_add_u32 m0, s76, 30720
    s_add_u32 s72, s68, 2883584
    buffer_load_dwordx4 v1, s[60:63], s72 offen sc1 lds
    s_waitcnt vmcnt(12)
    s_barrier
    s_add_u32 m0, s76, 46080
    s_add_u32 s72, s69, 622080
    buffer_load_dwordx4 v2, s[52:55], s72 offen lds
    s_add_u32 m0, s76, 50176
    s_add_u32 s72, s69, 622080
    buffer_load_dwordx4 v3, s[52:55], s72 offen lds
    s_add_u32 m0, s76, 39936
    s_add_u32 s72, s68, 2949120
    buffer_load_dwordx4 v1, s[60:63], s72 offen sc1 lds
    s_add_u32 m0, s76, 44032
    s_add_u32 s72, s68, 3080192
    buffer_load_dwordx4 v1, s[60:63], s72 offen sc1 lds
    s_waitcnt vmcnt(12)
    s_barrier
    s_waitcnt vmcnt(8)
    s_barrier
    s_waitcnt vmcnt(4)
    s_barrier
    s_waitcnt vmcnt(0)
    s_barrier
    s_endpgm
A_l1:
    s_add_u32 m0, s76, 6144
    s_add_u32 s72, s69, 0
    buffer_load_dwordx4 v2, s[52:55], s72 offen lds
    s_add_u32 m0, s76, 10240
    s_add_u32 s72, s69, 0
    buffer_load_dwordx4 v3, s[52:55], s72 offen lds
    s_add_u32 m0, s76, 19456
    s_add_u32 s72, s69, 41472
    buffer_load_dwordx4 v2, s[52:55], s72 offen lds
    s_add_u32 m0, s76, 23552
    s_add_u32 s72, s69, 41472
    buffer_load_dwordx4 v3, s[52:55], s72 offen lds
    s_add_u32 m0, s76, 32768
    s_add_u32 s72, s69, 82944
    buffer_load_dwordx4 v2, s[52:55], s72 offen lds
    s_add_u32 m0, s76, 36864
    s_add_u32 s72, s69, 82944
    buffer_load_dwordx4 v3, s[52:55], s72 offen lds
    s_add_u32 m0, s76, 46080
    s_add_u32 s72, s69, 124416
    buffer_load_dwordx4 v2, s[52:55], s72 offen lds
    s_add_u32 m0, s76, 50176
    s_add_u32 s72, s69, 124416
    buffer_load_dwordx4 v3, s[52:55], s72 offen lds
    s_barrier
    s_add_u32 m0, s76, 0
    s_add_u32 s72, s68, 0
    buffer_load_dwordx4 v1, s[60:63], s72 offen sc1 lds
    s_add_u32 m0, s76, 13312
    s_add_u32 s72, s68, 196608
    buffer_load_dwordx4 v1, s[60:63], s72 offen sc1 lds
    s_add_u32 m0, s76, 26624
    s_add_u32 s72, s68, 393216
    buffer_load_dwordx4 v1, s[60:63], s72 offen sc1 lds
    s_add_u32 m0, s76, 39936
    s_add_u32 s72, s68, 589824
    buffer_load_dwordx4 v1, s[60:63], s72 offen sc1 lds
    s_waitcnt vmcnt(3)
    s_barrier
    s_add_u32 m0, s76, 59392
    s_add_u32 s72, s69, 165888
    buffer_load_dwordx4 v2, s[52:55], s72 offen lds
    s_add_u32 m0, s76, 63488
    s_add_u32 s72, s69, 165888
    buffer_load_dwordx4 v3, s[52:55], s72 offen lds
    s_add_u32 m0, s76, 53248
    s_add_u32 s72, s68, 786432
    buffer_load_dwordx4 v1, s[60:63], s72 offen sc1 lds
    s_waitcnt vmcnt(5)
    s_barrier
    s_add_u32 m0, s76, 72704
    s_add_u32 s72, s69, 207360
    buffer_load_dwordx4 v2, s[52:55], s72 offen lds
    s_add_u32 m0, s76, 76800
    s_add_u32 s72, s69, 207360
    buffer_load_dwordx4 v3, s[52:55], s72 offen lds
    s_add_u32 m0, s76, 66560
    s_add_u32 s72, s68, 983040
    buffer_load_dwordx4 v1, s[60:63], s72 offen sc1 lds
    s_waitcnt vmcnt(7)
    s_barrier
    s_add_u32 m0, s76, 6144
    s_add_u32 s72, s69, 248832
    buffer_load_dwordx4 v2, s[52:55], s72 offen lds
    s_add_u32 m0, s76, 10240
    s_add_u32 s72, s69, 248832
    buffer_load_dwordx4 v3, s[52:55], s72 offen lds
    s_add_u32 m0, s76, 0
    s_add_u32 s72, s68, 1179648
    buffer_load_dwordx4 v1, s[60:63], s72 offen sc1 lds
    s_waitcnt vmcnt(9)
    s_barrier
    s_add_u32 m0, s76, 19456
    s_add_u32 s72, s69, 290304
    buffer_load_dwordx4 v2, s[52:55], s72 offen lds
    s_add_u32 m0, s76, 23552
    s_add_u32 s72, s69, 290304
    buffer_load_dwordx4 v3, s[52:55], s72 offen lds
    s_add_u32 m0, s76, 13312
    s_add_u32 s72, s68, 1376256
    buffer_load_dwordx4 v1, s[60:63], s72 offen sc1 lds
    s_waitcnt vmcnt(9)
    s_barrier
    s_add_u32 m0, s76, 32768
    s_add_u32 s72, s69, 331776
    buffer_load_dwordx4 v2, s[52:55], s72 offen lds
    s_add_u32 m0, s76, 36864
    s_add_u32 s72, s69, 331776
    buffer_load_dwordx4 v3, s[52:55], s72 offen lds
    s_add_u32 m0, s76, 26624
    s_add_u32 s72, s68, 1572864
    buffer_load_dwordx4 v1, s[60:63], s72 offen sc1 lds
    s_waitcnt vmcnt(9)
    s_barrier
    s_add_u32 m0, s76, 46080
    s_add_u32 s72, s69, 373248
    buffer_load_dwordx4 v2, s[52:55], s72 offen lds
    s_add_u32 m0, s76, 50176
    s_add_u32 s72, s69, 373248
    buffer_load_dwordx4 v3, s[52:55], s72 offen lds
    s_add_u32 m0, s76, 39936
    s_add_u32 s72, s68, 1769472
    buffer_load_dwordx4 v1, s[60:63], s72 offen sc1 lds
    s_waitcnt vmcnt(9)
    s_barrier
    s_add_u32 m0, s76, 59392
    s_add_u32 s72, s69, 414720
    buffer_load_dwordx4 v2, s[52:55], s72 offen lds
    s_add_u32 m0, s76, 63488
    s_add_u32 s72, s69, 414720
    buffer_load_dwordx4 v3, s[52:55], s72 offen lds
    s_add_u32 m0, s76, 53248
    s_add_u32 s72, s68, 1966080
    buffer_load_dwordx4 v1, s[60:63], s72 offen sc1 lds
    s_waitcnt vmcnt(9)
    s_barrier
    s_add_u32 m0, s76, 72704
    s_add_u32 s72, s69, 456192
    buffer_load_dwordx4 v2, s[52:55], s72 offen lds
    s_add_u32 m0, s76, 76800
    s_add_u32 s72, s69, 456192
    buffer_load_dwordx4 v3, s[52:55], s72 offen lds
    s_add_u32 m0, s76, 66560
    s_add_u32 s72, s68, 2162688
    buffer_load_dwordx4 v1, s[60:63], s72 offen sc1 lds
    s_waitcnt vmcnt(9)
    s_barrier
    s_add_u32 m0, s76, 6144
    s_add_u32 s72, s69, 497664
    buffer_load_dwordx4 v2, s[52:55], s72 offen lds
    s_add_u32 m0, s76, 10240
    s_add_u32 s72, s69, 497664
    buffer_load_dwordx4 v3, s[52:55], s72 offen lds
    s_add_u32 m0, s76, 0
    s_add_u32 s72, s68, 2359296
    buffer_load_dwordx4 v1, s[60:63], s72 offen sc1 lds
    s_waitcnt vmcnt(9)
    s_barrier
    s_add_u32 m0, s76, 19456
    s_add_u32 s72, s69, 539136
    buffer_load_dwordx4 v2, s[52:55], s72 offen lds
    s_add_u32 m0, s76, 23552
    s_add_u32 s72, s69, 539136
    buffer_load_dwordx4 v3, s[52:55], s72 offen lds
    s_add_u32 m0, s76, 13312
    s_add_u32 s72, s68, 2555904
    buffer_load_dwordx4 v1, s[60:63], s72 offen sc1 lds
    s_waitcnt vmcnt(9)
    s_barrier
    s_add_u32 m0, s76, 32768
    s_add_u32 s72, s69, 580608
    buffer_load_dwordx4 v2, s[52:55], s72 offen lds
    s_add_u32 m0, s76, 36864
    s_add_u32 s72, s69, 580608
    buffer_load_dwordx4 v3, s[52:55], s72 offen lds
    s_add_u32 m0, s76, 26624
    s_add_u32 s72, s68, 2752512
    buffer_load_dwordx4 v1, s[60:63], s72 offen sc1 lds
    s_waitcnt vmcnt(9)
    s_barrier
    s_add_u32 m0, s76, 46080
    s_add_u32 s72, s69, 622080
    buffer_load_dwordx4 v2, s[52:55], s72 offen lds
    s_add_u32 m0, s76, 50176
    s_add_u32 s72, s69, 622080
    buffer_load_dwordx4 v3, s[52:55], s72 offen lds
    s_add_u32 m0, s76, 39936
    s_add_u32 s72, s68, 2949120
    buffer_load_dwordx4 v1, s[60:63], s72 offen sc1 lds
    s_waitcnt vmcnt(9)
    s_barrier
    s_waitcnt vmcnt(6)
    s_barrier
    s_waitcnt vmcnt(3)
    s_barrier
    s_waitcnt vmcnt(0)
    s_barrier
    s_endpgm
A_l2:
    s_add_u32 m0, s76, 6144
    s_add_u32 s72, s69, 0
    buffer_load_dwordx4 v2, s[52:55], s72 offen lds
    s_add_u32 m0, s76, 19456
    s_add_u32 s72, s69, 41472
    buffer_load_dwordx4 v2, s[52:55], s72 offen lds
    s_add_u32 m0, s76, 32768
    s_add_u32 s72, s69, 82944
    buffer_load_dwordx4 v2, s[52:55], s72 offen lds
    s_add_u32 m0, s76, 46080
    s_add_u32 s72, s69, 124416
    buffer_load_dwordx4 v2, s[52:55], s72 offen lds
    s_barrier
    s_add_u32 m0, s76, 0
    s_add_u32 s72, s68, 0
    buffer_load_dwordx4 v1, s[60:63], s72 offen sc1 lds
    s_add_u32 m0, s76, 13312
    s_add_u32 s72, s68, 196608
    buffer_load_dwordx4 v1, s[60:63], s72 offen sc1 lds
    s_add_u32 m0, s76, 26624
    s_add_u32 s72, s68, 393216
    buffer_load_dwordx4 v1, s[60:63], s72 offen sc1 lds
    s_add_u32 m0, s76, 39936
    s_add_u32 s72, s68, 589824
    buffer_load_dwordx4 v1, s[60:63], s72 offen sc1 lds
    s_waitcnt vmcnt(3)
    s_barrier
    s_add_u32 m0, s76, 59392
    s_add_u32 s72, s69, 165888
    buffer_load_dwordx4 v2, s[52:55], s72 offen lds
    s_add_u32 m0, s76, 53248
    s_add_u32 s72, s68, 786432
    buffer_load_dwordx4 v1, s[60:63], s72 offen sc1 lds
    s_waitcnt vmcnt(4)
    s_barrier
    s_add_u32 m0, s76, 72704
    s_add_u32 s72, s69, 207360
    buffer_load_dwordx4 v2, s[52:55], s72 offen lds
    s_add_u32 m0, s76, 66560
    s_add_u32 s72, s68, 983040
    buffer_load_dwordx4 v1, s[60:63], s72 offen sc1 lds
    s_waitcnt vmcnt(5)
    s_barrier
    s_add_u32 m0, s76, 6144
    s_add_u32 s72, s69, 248832
    buffer_load_dwordx4 v2, s[52:55], s72 offen lds
    s_add_u32 m0, s76, 0
    s_add_u32 s72, s68, 1179648
    buffer_load_dwordx4 v1, s[60:63], s72 offen sc1 lds
    s_waitcnt vmcnt(6)
    s_barrier
    s_add_u32 m0, s76, 19456
    s_add_u32 s72, s69, 290304
    buffer_load_dwordx4 v2, s[52:55], s72 offen lds
    s_add_u32 m0, s76, 13312
    s_add_u32 s72, s68, 1376256
    buffer_load_dwordx4 v1, s[60:63], s72 offen sc1 lds
    s_waitcnt vmcnt(6)
    s_barrier
    s_add_u32 m0, s76, 32768
    s_add_u32 s72, s69, 331776
    buffer_load_dwordx4 v2, s[52:55], s72 offen lds
    s_add_u32 m0, s76, 26624
    s_add_u32 s72, s68, 1572864
    buffer_load_dwordx4 v1, s[60:63], s72 offen sc1 lds
    s_waitcnt vmcnt(6)
    s_barrier
    s_add_u32 m0, s76, 46080
    s_add_u32 s72, s69, 373248
    buffer_load_dwordx4 v2, s[52:55], s72 offen lds
    s_add_u32 m0, s76, 39936
    s_add_u32 s72, s68, 1769472
    buffer_load_dwordx4 v1, s[60:63], s72 offen sc1 lds
    s_waitcnt vmcnt(6)
    s_barrier
    s_add_u32 m0, s76, 59392
    s_add_u32 s72, s69, 414720
    buffer_load_dwordx4 v2, s[52:55], s72 offen lds
    s_add_u32 m0, s76, 53248
    s_add_u32 s72, s68, 1966080
    buffer_load_dwordx4 v1, s[60:63], s72 offen sc1 lds
    s_waitcnt vmcnt(6)
    s_barrier
    s_add_u32 m0, s76, 72704
    s_add_u32 s72, s69, 456192
    buffer_load_dwordx4 v2, s[52:55], s72 offen lds
    s_add_u32 m0, s76, 66560
    s_add_u32 s72, s68, 2162688
    buffer_load_dwordx4 v1, s[60:63], s72 offen sc1 lds
    s_waitcnt vmcnt(6)
    s_barrier
    s_add_u32 m0, s76, 6144
    s_add_u32 s72, s69, 497664
    buffer_load_dwordx4 v2, s[52:55], s72 offen lds
    s_add_u32 m0, s76, 0
    s_add_u32 s72, s68, 2359296
    buffer_load_dwordx4 v1, s[60:63], s72 offen sc1 lds
    s_waitcnt vmcnt(6)
    s_barrier
    s_add_u32 m0, s76, 19456
    s_add_u32 s72, s69, 539136
    buffer_load_dwordx4 v2, s[52:55], s72 offen lds
    s_add_u32 m0, s76, 13312
    s_add_u32 s72, s68, 2555904
    buffer_load_dwordx4 v1, s[60:63], s72 offen sc1 lds
    s_waitcnt vmcnt(6)
    s_barrier
    s_add_u32 m0, s76, 32768
    s_add_u32 s72, s69, 580608
    buffer_load_dwordx4 v2, s[52:55], s72 offen lds
    s_add_u32 m0, s76, 26624
    s_add_u32 s72, s68, 2752512
    buffer_load_dwordx4 v1, s[60:63], s72 offen sc1 lds
    s_waitcnt vmcnt(6)
    s_barrier
    s_add_u32 m0, s76, 46080
    s_add_u32 s72, s69, 622080
    buffer_load_dwordx4 v2, s[52:55], s72 offen lds
    s_add_u32 m0, s76, 39936
    s_add_u32 s72, s68, 2949120
    buffer_load_dwordx4 v1, s[60:63], s72 offen sc1 lds
    s_waitcnt vmcnt(6)
    s_barrier
    s_waitcnt vmcnt(4)
    s_barrier
    s_waitcnt vmcnt(2)
    s_barrier
    s_waitcnt vmcnt(0)
    s_barrier
    s_endpgm
K2_pc:
    s_mov_b32 s64, s40
    s_mov_b32 s65, s41
    s_mov_b32 s66, 9437184
    s_mov_b32 s67, 0x00020000
    v_lshlrev_b32 v20, 4, v1
    v_lshl_add_u32 v20, v2, 10, v20
    v_bfe_u32 v12, v0, 2, 2
    v_and_b32 v13, 3, v0
    v_lshlrev_b32 v13, 3, v13
    v_and_b32 v14, 16, v0
    v_lshl_add_u32 v13, v14, 1, v13
    s_lshl_b32 s7, s5, 6
    s_add_u32 s7, s7, 6144
    v_add_u32 v13, s7, v13
    s_movk_i32 s7, 192
    v_mad_u32_u24 v14, v2, 8, v12
    v_add_u32 v14, 0, v14
    v_min_u32 v14, 35, v14
    v_mad_u32_u24 v24, v14, s7, v13
    v_mad_u32_u24 v14, v2, 2, v12
    v_add_u32 v14, 16, v14
    v_min_u32 v14, 35, v14
    v_mad_u32_u24 v25, v14, s7, v13
    v_mad_u32_u24 v14, v2, 8, v12
    v_add_u32 v14, 26, v14
    v_min_u32 v14, 35, v14
    v_mad_u32_u24 v26, v14, s7, v13
    v_mad_u32_u24 v14, v2, 8, v12
    v_add_u32 v14, 30, v14
    v_min_u32 v14, 35, v14
    v_mad_u32_u24 v27, v14, s7, v13
    s_mul_i32 s7, s5, 8192
    s_add_u32 s7, s7, 0
    v_and_b32 v3, 7, v1
    v_xor_b32 v3, v3, v2
    v_lshlrev_b32 v3, 4, v3
    v_lshl_add_u32 v3, v1, 7, v3
    v_add_u32 v6, s7, v3
    v_xor_b32 v7, 32, v6
    v_xor_b32 v8, 64, v6
    v_xor_b32 v9, 96, v6
    v_lshrrev_b32 v3, 3, v0
    v_and_b32 v5, 7, v0
    v_xor_b32 v4, v3, v5
    v_lshlrev_b32 v4, 4, v4
    v_lshl_add_u32 v4, v3, 7, v4
    v_add_u32 v4, s7, v4
    v_mul_u32_u24 v10, 4608, v3
    v_lshl_add_u32 v10, v5, 4, v10
    v_add_u32 v11, 36864, v10
    v_add_u32 v12, 73728, v10
    v_add_u32 v13, 110592, v10
    s_mul_i32 s6, s14, 294912
    s_mul_i32 s7, s15, 384
    s_add_u32 s6, s6, s7
    s_lshl_b32 s7, s5, 7
    s_add_u32 s12, s6, s7
    s_add_u32 s13, s12, 147456
    s_waitcnt vmcnt(0)
    s_barrier
    s_cmp_lg_u32 s5, 3
    s_cbranch_scc1 K2_pw
    s_lshl_b32 s6, s3, 4
    v_mov_b32 v14, s6
    v_mov_b32 v15, 1
    s_mov_b64 exec, 1
    buffer_store_dword v15, v14, s[60:63], s74 offen sc1
    s_mov_b64 exec, -1
    s_cmp_ge_u32 s79, 24
    s_cbranch_scc1 K2_done
    v_lshlrev_b32 v14, 4, v0
    s_mov_b32 exec_lo, 4294967295
    s_mov_b32 exec_hi, 0
    s_mov_b32 s72, 0
K2_pp:
    buffer_load_dword v15, v14, s[60:63], s74 offen sc1
    s_waitcnt vmcnt(0)
    v_cmp_gt_u32 vcc, 1, v15
    s_add_u32 s72, s72, 1
    s_cbranch_vccz K2_pp_ok
    s_sleep 1
    s_cmp_lt_u32 s72, 0x100000
    s_cbranch_scc1 K2_pp
K2_pp_ok:
    s_mov_b64 exec, -1
    s_barrier
    s_endpgm
K2_pw:
    s_cmp_ge_u32 s79, 24
    s_cbranch_scc1 K2_end
    s_barrier
    s_barrier
    ds_read_b64_tr_b16 v[28:29], v24
    ds_read_b64_tr_b16 v[30:31], v24 offset:768
    ds_read_b128 v[32:35], v20 offset:0
    ds_read_b128 v[36:39], v20 offset:512
    v_add_u32 v24, 13312, v24
    ds_read_b64_tr_b16 v[40:41], v25
    ds_read_b64_tr_b16 v[42:43], v25 offset:768
    ds_read_b128 v[44:47], v20 offset:2048
    ds_read_b128 v[48:51], v20 offset:2560
    v_add_u32 v25, 13312, v25
    s_waitcnt lgkmcnt(5)
    v_mfma_f32_32x32x16_bf16 v[64:79], v[28:31], v[32:35], 0
    s_barrier
    ds_read_b64_tr_b16 v[52:53], v26
    ds_read_b64_tr_b16 v[54:55], v27
    ds_read_b128 v[56:59], v20 offset:4096
    s_waitcnt lgkmcnt(7)
    v_mfma_f32_32x32x16_bf16 v[80:95], v[28:31], v[36:39], 0
    ds_read_b128 v[60:63], v20 offset:4608
    v_add_u32 v26, 13312, v26
    v_add_u32 v20, 13312, v20
    v_add_u32 v27, 13312, v27
    s_waitcnt lgkmcnt(5)
    v_mfma_f32_32x32x16_bf16 v[64:79], v[40:43], v[44:47], v[64:79]
    ds_read_b64_tr_b16 v[28:29], v24
    ds_read_b64_tr_b16 v[30:31], v24 offset:768
    ds_read_b128 v[32:35], v20 offset:0
    s_waitcnt lgkmcnt(7)
    v_mfma_f32_32x32x16_bf16 v[80:95], v[40:43], v[48:51], v[80:95]
    ds_read_b128 v[36:39], v20 offset:512
    v_add_u32 v24, 13312, v24
    s_waitcnt lgkmcnt(5)
    v_mfma_f32_32x32x16_bf16 v[64:79], v[52:55], v[56:59], v[64:79]
    ds_read_b64_tr_b16 v[40:41], v25
    ds_read_b64_tr_b16 v[42:43], v25 offset:768
    ds_read_b128 v[44:47], v20 offset:2048
    s_waitcnt lgkmcnt(7)
    v_mfma_f32_32x32x16_bf16 v[80:95], v[52:55], v[60:63], v[80:95]
    ds_read_b128 v[48:51], v20 offset:2560
    v_add_u32 v25, 13312, v25
    s_waitcnt lgkmcnt(5)
    v_mfma_f32_32x32x16_bf16 v[64:79], v[28:31], v[32:35], v[64:79]
    s_barrier
    ds_read_b64_tr_b16 v[52:53], v26
    ds_read_b64_tr_b16 v[54:55], v27
    ds_read_b128 v[56:59], v20 offset:4096
    s_waitcnt lgkmcnt(7)
    v_mfma_f32_32x32x16_bf16 v[80:95], v[28:31], v[36:39], v[80:95]
    ds_read_b128 v[60:63], v20 offset:4608
    v_add_u32 v26, 13312, v26
    v_add_u32 v20, 13312, v20
    v_add_u32 v27, 13312, v27
    s_waitcnt lgkmcnt(5)
    v_mfma_f32_32x32x16_bf16 v[64:79], v[40:43], v[44:47], v[64:79]
    ds_read_b64_tr_b16 v[28:29], v24
    ds_read_b64_tr_b16 v[30:31], v24 offset:768
    ds_read_b128 v[32:35], v20 offset:0
    s_waitcnt lgkmcnt(7)
    v_mfma_f32_32x32x16_bf16 v[80:95], v[40:43], v[48:51], v[80:95]
    ds_read_b128 v[36:39], v20 offset:512
    v_add_u32 v24, 13312, v24
    s_waitcnt lgkmcnt(5)
    v_mfma_f32_32x32x16_bf16 v[64:79], v[52:55], v[56:59], v[64:79]
    ds_read_b64_tr_b16 v[40:41], v25
    ds_read_b64_tr_b16 v[42:43], v25 offset:768
    ds_read_b128 v[44:47], v20 offset:2048
    s_waitcnt lgkmcnt(7)
    v_mfma_f32_32x32x16_bf16 v[80:95], v[52:55], v[60:63], v[80:95]
    ds_read_b128 v[48:51], v20 offset:2560
    v_add_u32 v25, 13312, v25
    s_waitcnt lgkmcnt(5)
    v_mfma_f32_32x32x16_bf16 v[64:79], v[28:31], v[32:35], v[64:79]
    s_barrier
    ds_read_b64_tr_b16 v[52:53], v26
    ds_read_b64_tr_b16 v[54:55], v27
    ds_read_b128 v[56:59], v20 offset:4096
    s_waitcnt lgkmcnt(7)
    v_mfma_f32_32x32x16_bf16 v[80:95], v[28:31], v[36:39], v[80:95]
    ds_read_b128 v[60:63], v20 offset:4608
    v_add_u32 v26, 13312, v26
    v_add_u32 v20, 13312, v20
    v_add_u32 v27, 13312, v27
    s_waitcnt lgkmcnt(5)
    v_mfma_f32_32x32x16_bf16 v[64:79], v[40:43], v[44:47], v[64:79]
    ds_read_b64_tr_b16 v[28:29], v24
    ds_read_b64_tr_b16 v[30:31], v24 offset:768
    ds_read_b128 v[32:35], v20 offset:0
    s_waitcnt lgkmcnt(7)
    v_mfma_f32_32x32x16_bf16 v[80:95], v[40:43], v[48:51], v[80:95]
    ds_read_b128 v[36:39], v20 offset:512
    v_add_u32 v24, 13312, v24
    s_waitcnt lgkmcnt(5)
    v_mfma_f32_32x32x16_bf16 v[64:79], v[52:55], v[56:59], v[64:79]
    ds_read_b64_tr_b16 v[40:41], v25
    ds_read_b64_tr_b16 v[42:43], v25 offset:768
    ds_read_b128 v[44:47], v20 offset:2048
    s_waitcnt lgkmcnt(7)
    v_mfma_f32_32x32x16_bf16 v[80:95], v[52:55], v[60:63], v[80:95]
    ds_read_b128 v[48:51], v20 offset:2560
    v_add_u32 v25, 13312, v25
    s_waitcnt lgkmcnt(5)
    v_mfma_f32_32x32x16_bf16 v[64:79], v[28:31], v[32:35], v[64:79]
    s_barrier
    ds_read_b64_tr_b16 v[52:53], v26
    ds_read_b64_tr_b16 v[54:55], v27
    ds_read_b128 v[56:59], v20 offset:4096
    s_waitcnt lgkmcnt(7)
    v_mfma_f32_32x32x16_bf16 v[80:95], v[28:31], v[36:39], v[80:95]
    ds_read_b128 v[60:63], v20 offset:4608
    v_add_u32 v26, 13312, v26
    v_add_u32 v20, 13312, v20
    v_add_u32 v27, 13312, v27
    s_waitcnt lgkmcnt(5)
    v_mfma_f32_32x32x16_bf16 v[64:79], v[40:43], v[44:47], v[64:79]
    ds_read_b64_tr_b16 v[28:29], v24
    ds_read_b64_tr_b16 v[30:31], v24 offset:768
    ds_read_b128 v[32:35], v20 offset:0
    s_waitcnt lgkmcnt(7)
    v_mfma_f32_32x32x16_bf16 v[80:95], v[40:43], v[48:51], v[80:95]
    ds_read_b128 v[36:39], v20 offset:512
    v_add_u32 v24, 13312, v24
    s_waitcnt lgkmcnt(5)
    v_mfma_f32_32x32x16_bf16 v[64:79], v[52:55], v[56:59], v[64:79]
    ds_read_b64_tr_b16 v[40:41], v25
    ds_read_b64_tr_b16 v[42:43], v25 offset:768
    ds_read_b128 v[44:47], v20 offset:2048
    s_waitcnt lgkmcnt(7)
    v_mfma_f32_32x32x16_bf16 v[80:95], v[52:55], v[60:63], v[80:95]
    ds_read_b128 v[48:51], v20 offset:2560
    v_add_u32 v25, 13312, v25
    s_waitcnt lgkmcnt(5)
    v_mfma_f32_32x32x16_bf16 v[64:79], v[28:31], v[32:35], v[64:79]
    s_barrier
    ds_read_b64_tr_b16 v[52:53], v26
    ds_read_b64_tr_b16 v[54:55], v27
    ds_read_b128 v[56:59], v20 offset:4096
    s_waitcnt lgkmcnt(7)
    v_mfma_f32_32x32x16_bf16 v[80:95], v[28:31], v[36:39], v[80:95]
    ds_read_b128 v[60:63], v20 offset:4608
    v_add_u32 v26, 13312, v26
    v_add_u32 v20, 13312, v20
    v_add_u32 v27, 13312, v27
    s_waitcnt lgkmcnt(5)
    v_mfma_f32_32x32x16_bf16 v[64:79], v[40:43], v[44:47], v[64:79]
    ds_read_b64_tr_b16 v[28:29], v24
    ds_read_b64_tr_b16 v[30:31], v24 offset:768
    ds_read_b128 v[32:35], v20 offset:0
    s_waitcnt lgkmcnt(7)
    v_mfma_f32_32x32x16_bf16 v[80:95], v[40:43], v[48:51], v[80:95]
    ds_read_b128 v[36:39], v20 offset:512
    v_add_u32 v24, 4294900736, v24
    s_waitcnt lgkmcnt(5)
    v_mfma_f32_32x32x16_bf16 v[64:79], v[52:55], v[56:59], v[64:79]
    ds_read_b64_tr_b16 v[40:41], v25
    ds_read_b64_tr_b16 v[42:43], v25 offset:768
    ds_read_b128 v[44:47], v20 offset:2048
    s_waitcnt lgkmcnt(7)
    v_mfma_f32_32x32x16_bf16 v[80:95], v[52:55], v[60:63], v[80:95]
    ds_read_b128 v[48:51], v20 offset:2560
    v_add_u32 v25, 4294900736, v25
    s_waitcnt lgkmcnt(5)
    v_mfma_f32_32x32x16_bf16 v[64:79], v[28:31], v[32:35], v[64:79]
    s_barrier
    ds_read_b64_tr_b16 v[52:53], v26
    ds_read_b64_tr_b16 v[54:55], v27
    ds_read_b128 v[56:59], v20 offset:4096
    s_waitcnt lgkmcnt(7)
    v_mfma_f32_32x32x16_bf16 v[80:95], v[28:31], v[36:39], v[80:95]
    ds_read_b128 v[60:63], v20 offset:4608
    v_add_u32 v26, 4294900736, v26
    v_add_u32 v20, 4294900736, v20
    v_add_u32 v27, 4294900736, v27
    s_waitcnt lgkmcnt(5)
    v_mfma_f32_32x32x16_bf16 v[64:79], v[40:43], v[44:47], v[64:79]
    ds_read_b64_tr_b16 v[28:29], v24
    ds_read_b64_tr_b16 v[30:31], v24 offset:768
    ds_read_b128 v[32:35], v20 offset:0
    s_waitcnt lgkmcnt(7)
    v_mfma_f32_32x32x16_bf16 v[80:95], v[40:43], v[48:51], v[80:95]
    ds_read_b128 v[36:39], v20 offset:512
    v_add_u32 v24, 13312, v24
    s_waitcnt lgkmcnt(5)
    v_mfma_f32_32x32x16_bf16 v[64:79], v[52:55], v[56:59], v[64:79]
    ds_read_b64_tr_b16 v[40:41], v25
    ds_read_b64_tr_b16 v[42:43], v25 offset:768
    ds_read_b128 v[44:47], v20 offset:2048
    s_waitcnt lgkmcnt(7)
    v_mfma_f32_32x32x16_bf16 v[80:95], v[52:55], v[60:63], v[80:95]
    ds_read_b128 v[48:51], v20 offset:2560
    v_add_u32 v25, 13312, v25
    s_waitcnt lgkmcnt(5)
    v_mfma_f32_32x32x16_bf16 v[64:79], v[28:31], v[32:35], v[64:79]
    s_barrier
    ds_read_b64_tr_b16 v[52:53], v26
    ds_read_b64_tr_b16 v[54:55], v27
    ds_read_b128 v[56:59], v20 offset:4096
    s_waitcnt lgkmcnt(7)
    v_mfma_f32_32x32x16_bf16 v[80:95], v[28:31], v[36:39], v[80:95]
    ds_read_b128 v[60:63], v20 offset:4608
    v_add_u32 v26, 13312, v26
    v_add_u32 v20, 13312, v20
    v_add_u32 v27, 13312, v27
    s_waitcnt lgkmcnt(5)
    v_mfma_f32_32x32x16_bf16 v[64:79], v[40:43], v[44:47], v[64:79]
    ds_read_b64_tr_b16 v[28:29], v24
    ds_read_b64_tr_b16 v[30:31], v24 offset:768
    ds_read_b128 v[32:35], v20 offset:0
    s_waitcnt lgkmcnt(7)
    v_mfma_f32_32x32x16_bf16 v[80:95], v[40:43], v[48:51], v[80:95]
    ds_read_b128 v[36:39], v20 offset:512
    v_add_u32 v24, 13312, v24
    s_waitcnt lgkmcnt(5)
    v_mfma_f32_32x32x16_bf16 v[64:79], v[52:55], v[56:59], v[64:79]
    ds_read_b64_tr_b16 v[40:41], v25
    ds_read_b64_tr_b16 v[42:43], v25 offset:768
    ds_read_b128 v[44:47], v20 offset:2048
    s_waitcnt lgkmcnt(7)
    v_mfma_f32_32x32x16_bf16 v[80:95], v[52:55], v[60:63], v[80:95]
    ds_read_b128 v[48:51], v20 offset:2560
    v_add_u32 v25, 13312, v25
    s_waitcnt lgkmcnt(5)
    v_mfma_f32_32x32x16_bf16 v[64:79], v[28:31], v[32:35], v[64:79]
    s_barrier
    ds_read_b64_tr_b16 v[52:53], v26
    ds_read_b64_tr_b16 v[54:55], v27
    ds_read_b128 v[56:59], v20 offset:4096
    s_waitcnt lgkmcnt(7)
    v_mfma_f32_32x32x16_bf16 v[80:95], v[28:31], v[36:39], v[80:95]
    ds_read_b128 v[60:63], v20 offset:4608
    v_add_u32 v26, 13312, v26
    v_add_u32 v20, 13312, v20
    v_add_u32 v27, 13312, v27
    s_waitcnt lgkmcnt(5)
    v_mfma_f32_32x32x16_bf16 v[64:79], v[40:43], v[44:47], v[64:79]
    ds_read_b64_tr_b16 v[28:29], v24
    ds_read_b64_tr_b16 v[30:31], v24 offset:768
    ds_read_b128 v[32:35], v20 offset:0
    s_waitcnt lgkmcnt(7)
    v_mfma_f32_32x32x16_bf16 v[80:95], v[40:43], v[48:51], v[80:95]
    ds_read_b128 v[36:39], v20 offset:512
    v_add_u32 v24, 13312, v24
    s_waitcnt lgkmcnt(5)
    v_mfma_f32_32x32x16_bf16 v[64:79], v[52:55], v[56:59], v[64:79]
    ds_read_b64_tr_b16 v[40:41], v25
    ds_read_b64_tr_b16 v[42:43], v25 offset:768
    ds_read_b128 v[44:47], v20 offset:2048
    s_waitcnt lgkmcnt(7)
    v_mfma_f32_32x32x16_bf16 v[80:95], v[52:55], v[60:63], v[80:95]
    ds_read_b128 v[48:51], v20 offset:2560
    v_add_u32 v25, 13312, v25
    s_waitcnt lgkmcnt(5)
    v_mfma_f32_32x32x16_bf16 v[64:79], v[28:31], v[32:35], v[64:79]
    s_barrier
    ds_read_b64_tr_b16 v[52:53], v26
    ds_read_b64_tr_b16 v[54:55], v27
    ds_read_b128 v[56:59], v20 offset:4096
    s_waitcnt lgkmcnt(7)
    v_mfma_f32_32x32x16_bf16 v[80:95], v[28:31], v[36:39], v[80:95]
    ds_read_b128 v[60:63], v20 offset:4608
    v_add_u32 v26, 13312, v26
    v_add_u32 v20, 13312, v20
    v_add_u32 v27, 13312, v27
    s_waitcnt lgkmcnt(5)
    v_mfma_f32_32x32x16_bf16 v[64:79], v[40:43], v[44:47], v[64:79]
    ds_read_b64_tr_b16 v[28:29], v24
    ds_read_b64_tr_b16 v[30:31], v24 offset:768
    ds_read_b128 v[32:35], v20 offset:0
    s_waitcnt lgkmcnt(7)
    v_mfma_f32_32x32x16_bf16 v[80:95], v[40:43], v[48:51], v[80:95]
    ds_read_b128 v[36:39], v20 offset:512
    v_add_u32 v24, 13312, v24
    s_waitcnt lgkmcnt(5)
    v_mfma_f32_32x32x16_bf16 v[64:79], v[52:55], v[56:59], v[64:79]
    ds_read_b64_tr_b16 v[40:41], v25
    ds_read_b64_tr_b16 v[42:43], v25 offset:768
    ds_read_b128 v[44:47], v20 offset:2048
    s_waitcnt lgkmcnt(7)
    v_mfma_f32_32x32x16_bf16 v[80:95], v[52:55], v[60:63], v[80:95]
    ds_read_b128 v[48:51], v20 offset:2560
    v_add_u32 v25, 13312, v25
    s_waitcnt lgkmcnt(5)
    v_mfma_f32_32x32x16_bf16 v[64:79], v[28:31], v[32:35], v[64:79]
    s_barrier
    ds_read_b64_tr_b16 v[52:53], v26
    ds_read_b64_tr_b16 v[54:55], v27
    ds_read_b128 v[56:59], v20 offset:4096
    s_waitcnt lgkmcnt(7)
    v_mfma_f32_32x32x16_bf16 v[80:95], v[28:31], v[36:39], v[80:95]
    ds_read_b128 v[60:63], v20 offset:4608
    v_add_u32 v26, 13312, v26
    v_add_u32 v20, 13312, v20
    v_add_u32 v27, 13312, v27
    s_waitcnt lgkmcnt(5)
    v_mfma_f32_32x32x16_bf16 v[64:79], v[40:43], v[44:47], v[64:79]
    ds_read_b64_tr_b16 v[28:29], v24
    ds_read_b64_tr_b16 v[30:31], v24 offset:768
    ds_read_b128 v[32:35], v20 offset:0
    s_waitcnt lgkmcnt(7)
    v_mfma_f32_32x32x16_bf16 v[80:95], v[40:43], v[48:51], v[80:95]
    ds_read_b128 v[36:39], v20 offset:512
    v_add_u32 v24, 13312, v24
    s_waitcnt lgkmcnt(5)
    v_mfma_f32_32x32x16_bf16 v[64:79], v[52:55], v[56:59], v[64:79]
    ds_read_b64_tr_b16 v[40:41], v25
    ds_read_b64_tr_b16 v[42:43], v25 offset:768
    ds_read_b128 v[44:47], v20 offset:2048
    s_waitcnt lgkmcnt(7)
    v_mfma_f32_32x32x16_bf16 v[80:95], v[52:55], v[60:63], v[80:95]
    ds_read_b128 v[48:51], v20 offset:2560
    v_add_u32 v25, 13312, v25
    s_waitcnt lgkmcnt(5)
    v_mfma_f32_32x32x16_bf16 v[64:79], v[28:31], v[32:35], v[64:79]
    s_barrier
    ds_read_b64_tr_b16 v[52:53], v26
    ds_read_b64_tr_b16 v[54:55], v27
    ds_read_b128 v[56:59], v20 offset:4096
    s_waitcnt lgkmcnt(7)
    v_mfma_f32_32x32x16_bf16 v[80:95], v[28:31], v[36:39], v[80:95]
    ds_read_b128 v[60:63], v20 offset:4608
    v_add_u32 v26, 13312, v26
    v_add_u32 v20, 13312, v20
    v_add_u32 v27, 13312, v27
    s_waitcnt lgkmcnt(5)
    v_mfma_f32_32x32x16_bf16 v[64:79], v[40:43], v[44:47], v[64:79]
    ds_read_b64_tr_b16 v[28:29], v24
    ds_read_b64_tr_b16 v[30:31], v24 offset:768
    ds_read_b128 v[32:35], v20 offset:0
    s_waitcnt lgkmcnt(7)
    v_mfma_f32_32x32x16_bf16 v[80:95], v[40:43], v[48:51], v[80:95]
    ds_read_b128 v[36:39], v20 offset:512
    v_add_u32 v24, 4294900736, v24
    s_waitcnt lgkmcnt(5)
    v_mfma_f32_32x32x16_bf16 v[64:79], v[52:55], v[56:59], v[64:79]
    ds_read_b64_tr_b16 v[40:41], v25
    ds_read_b64_tr_b16 v[42:43], v25 offset:768
    ds_read_b128 v[44:47], v20 offset:2048
    s_waitcnt lgkmcnt(7)
    v_mfma_f32_32x32x16_bf16 v[80:95], v[52:55], v[60:63], v[80:95]
    ds_read_b128 v[48:51], v20 offset:2560
    v_add_u32 v25, 4294900736, v25
    s_waitcnt lgkmcnt(5)
    v_mfma_f32_32x32x16_bf16 v[64:79], v[28:31], v[32:35], v[64:79]
    s_barrier
    ds_read_b64_tr_b16 v[52:53], v26
    ds_read_b64_tr_b16 v[54:55], v27
    ds_read_b128 v[56:59], v20 offset:4096
    s_waitcnt lgkmcnt(7)
    v_mfma_f32_32x32x16_bf16 v[80:95], v[28:31], v[36:39], v[80:95]
    ds_read_b128 v[60:63], v20 offset:4608
    v_add_u32 v26, 4294900736, v26
    v_add_u32 v20, 4294900736, v20
    v_add_u32 v27, 4294900736, v27
    s_waitcnt lgkmcnt(5)
    v_mfma_f32_32x32x16_bf16 v[64:79], v[40:43], v[44:47], v[64:79]
    ds_read_b64_tr_b16 v[28:29], v24
    ds_read_b64_tr_b16 v[30:31], v24 offset:768
    ds_read_b128 v[32:35], v20 offset:0
    s_waitcnt lgkmcnt(7)
    v_mfma_f32_32x32x16_bf16 v[80:95], v[40:43], v[48:51], v[80:95]
    ds_read_b128 v[36:39], v20 offset:512
    v_add_u32 v24, 13312, v24
    s_waitcnt lgkmcnt(5)
    v_mfma_f32_32x32x16_bf16 v[64:79], v[52:55], v[56:59], v[64:79]
    ds_read_b64_tr_b16 v[40:41], v25
    ds_read_b64_tr_b16 v[42:43], v25 offset:768
    ds_read_b128 v[44:47], v20 offset:2048
    s_waitcnt lgkmcnt(7)
    v_mfma_f32_32x32x16_bf16 v[80:95], v[52:55], v[60:63], v[80:95]
    ds_read_b128 v[48:51], v20 offset:2560
    v_add_u32 v25, 13312, v25
    s_waitcnt lgkmcnt(5)
    v_mfma_f32_32x32x16_bf16 v[64:79], v[28:31], v[32:35], v[64:79]
    s_barrier
    ds_read_b64_tr_b16 v[52:53], v26
    ds_read_b64_tr_b16 v[54:55], v27
    ds_read_b128 v[56:59], v20 offset:4096
    s_waitcnt lgkmcnt(7)
    v_mfma_f32_32x32x16_bf16 v[80:95], v[28:31], v[36:39], v[80:95]
    ds_read_b128 v[60:63], v20 offset:4608
    v_add_u32 v26, 13312, v26
    v_add_u32 v20, 13312, v20
    v_add_u32 v27, 13312, v27
    s_waitcnt lgkmcnt(5)
    v_mfma_f32_32x32x16_bf16 v[64:79], v[40:43], v[44:47], v[64:79]
    ds_read_b64_tr_b16 v[28:29], v24
    ds_read_b64_tr_b16 v[30:31], v24 offset:768
    ds_read_b128 v[32:35], v20 offset:0
    s_waitcnt lgkmcnt(7)
    v_mfma_f32_32x32x16_bf16 v[80:95], v[40:43], v[48:51], v[80:95]
    ds_read_b128 v[36:39], v20 offset:512
    v_add_u32 v24, 13312, v24
    s_waitcnt lgkmcnt(5)
    v_mfma_f32_32x32x16_bf16 v[64:79], v[52:55], v[56:59], v[64:79]
    ds_read_b64_tr_b16 v[40:41], v25
    ds_read_b64_tr_b16 v[42:43], v25 offset:768
    ds_read_b128 v[44:47], v20 offset:2048
    s_waitcnt lgkmcnt(7)
    v_mfma_f32_32x32x16_bf16 v[80:95], v[52:55], v[60:63], v[80:95]
    ds_read_b128 v[48:51], v20 offset:2560
    v_add_u32 v25, 13312, v25
    s_waitcnt lgkmcnt(5)
    v_mfma_f32_32x32x16_bf16 v[64:79], v[28:31], v[32:35], v[64:79]
    s_barrier
    ds_read_b64_tr_b16 v[52:53], v26
    ds_read_b64_tr_b16 v[54:55], v27
    ds_read_b128 v[56:59], v20 offset:4096
    s_waitcnt lgkmcnt(7)
    v_mfma_f32_32x32x16_bf16 v[80:95], v[28:31], v[36:39], v[80:95]
    ds_read_b128 v[60:63], v20 offset:4608
    v_add_u32 v26, 13312, v26
    v_add_u32 v20, 13312, v20
    v_add_u32 v27, 13312, v27
    s_waitcnt lgkmcnt(5)
    v_mfma_f32_32x32x16_bf16 v[64:79], v[40:43], v[44:47], v[64:79]
    ds_read_b64_tr_b16 v[28:29], v24
    ds_read_b64_tr_b16 v[30:31], v24 offset:768
    ds_read_b128 v[32:35], v20 offset:0
    s_waitcnt lgkmcnt(7)
    v_mfma_f32_32x32x16_bf16 v[80:95], v[40:43], v[48:51], v[80:95]
    ds_read_b128 v[36:39], v20 offset:512
    v_add_u32 v24, 13312, v24
    s_waitcnt lgkmcnt(5)
    v_mfma_f32_32x32x16_bf16 v[64:79], v[52:55], v[56:59], v[64:79]
    ds_read_b64_tr_b16 v[40:41], v25
    ds_read_b64_tr_b16 v[42:43], v25 offset:768
    ds_read_b128 v[44:47], v20 offset:2048
    s_waitcnt lgkmcnt(7)
    v_mfma_f32_32x32x16_bf16 v[80:95], v[52:55], v[60:63], v[80:95]
    ds_read_b128 v[48:51], v20 offset:2560
    v_add_u32 v25, 13312, v25
    s_waitcnt lgkmcnt(5)
    v_mfma_f32_32x32x16_bf16 v[64:79], v[28:31], v[32:35], v[64:79]
    s_barrier
    ds_read_b64_tr_b16 v[52:53], v26
    ds_read_b64_tr_b16 v[54:55], v27
    ds_read_b128 v[56:59], v20 offset:4096
    s_waitcnt lgkmcnt(7)
    v_mfma_f32_32x32x16_bf16 v[80:95], v[28:31], v[36:39], v[80:95]
    ds_read_b128 v[60:63], v20 offset:4608
    v_add_u32 v26, 13312, v26
    v_add_u32 v20, 13312, v20
    v_add_u32 v27, 13312, v27
    s_waitcnt lgkmcnt(5)
    v_mfma_f32_32x32x16_bf16 v[64:79], v[40:43], v[44:47], v[64:79]
    ds_read_b64_tr_b16 v[28:29], v24
    ds_read_b64_tr_b16 v[30:31], v24 offset:768
    ds_read_b128 v[32:35], v20 offset:0
    s_waitcnt lgkmcnt(7)
    v_mfma_f32_32x32x16_bf16 v[80:95], v[40:43], v[48:51], v[80:95]
    ds_read_b128 v[36:39], v20 offset:512
    s_waitcnt lgkmcnt(5)
    v_mfma_f32_32x32x16_bf16 v[64:79], v[52:55], v[56:59], v[64:79]
    ds_read_b64_tr_b16 v[40:41], v25
    ds_read_b64_tr_b16 v[42:43], v25 offset:768
    ds_read_b128 v[44:47], v20 offset:2048
    s_waitcnt lgkmcnt(7)
    v_mfma_f32_32x32x16_bf16 v[80:95], v[52:55], v[60:63], v[80:95]
    ds_read_b128 v[48:51], v20 offset:2560
    s_waitcnt lgkmcnt(5)
    v_mfma_f32_32x32x16_bf16 v[64:79], v[28:31], v[32:35], v[64:79]
    ds_read_b64_tr_b16 v[52:53], v26
    ds_read_b64_tr_b16 v[54:55], v27
    ds_read_b128 v[56:59], v20 offset:4096
    s_waitcnt lgkmcnt(7)
    v_mfma_f32_32x32x16_bf16 v[80:95], v[28:31], v[36:39], v[80:95]
    ds_read_b128 v[60:63], v20 offset:4608
    s_waitcnt lgkmcnt(5)
    v_mfma_f32_32x32x16_bf16 v[64:79], v[40:43], v[44:47], v[64:79]
    s_waitcnt lgkmcnt(4)
    v_mfma_f32_32x32x16_bf16 v[80:95], v[40:43], v[48:51], v[80:95]
    s_waitcnt lgkmcnt(1)
    v_mfma_f32_32x32x16_bf16 v[64:79], v[52:55], v[56:59], v[64:79]
    s_waitcnt lgkmcnt(0)
    v_mfma_f32_32x32x16_bf16 v[80:95], v[52:55], v[60:63], v[80:95]
    s_nop 10
    ds_write_b128 v6, v[64:67] offset:0
    ds_write_b128 v7, v[68:71] offset:0
    ds_write_b128 v8, v[72:75] offset:0
    ds_write_b128 v9, v[76:79] offset:0
    ds_read_b128 v[64:67], v4 offset:0
    ds_read_b128 v[68:71], v4 offset:1024
    ds_read_b128 v[72:75], v4 offset:2048
    ds_read_b128 v[76:79], v4 offset:3072
    ds_write_b128 v6, v[80:83] offset:4096
    ds_write_b128 v7, v[84:87] offset:4096
    ds_write_b128 v8, v[88:91] offset:4096
    ds_write_b128 v9, v[92:95] offset:4096
    s_waitcnt lgkmcnt(4)
    ds_read_b128 v[80:83], v4 offset:4096
    ds_read_b128 v[84:87], v4 offset:5120
    ds_read_b128 v[88:91], v4 offset:6144
    ds_read_b128 v[92:95], v4 offset:7168
    buffer_store_dwordx4 v[64:67], v10, s[64:67], s12 offen offset:0 sc1
    buffer_store_dwordx4 v[68:71], v11, s[64:67], s12 offen offset:0 sc1
    buffer_store_dwordx4 v[72:75], v12, s[64:67], s12 offen offset:0 sc1
    buffer_store_dwordx4 v[76:79], v13, s[64:67], s12 offen offset:0 sc1
    s_waitcnt lgkmcnt(0)
    buffer_store_dwordx4 v[80:83], v10, s[64:67], s13 offen offset:0 sc1
    buffer_store_dwordx4 v[84:87], v11, s[64:67], s13 offen offset:0 sc1
    buffer_store_dwordx4 v[88:91], v12, s[64:67], s13 offen offset:0 sc1
    buffer_store_dwordx4 v[92:95], v13, s[64:67], s13 offen offset:0 sc1
K2_end:
K2_done:
    s_endpgm
K2_slow:
    s_mul_i32 s6, s77, 19456
    v_subrev_u32 v8, s6, v8
    v_subrev_u32 v9, s6, v9
    v_subrev_u32 v10, s6, v10
    v_subrev_u32 v11, s6, v11
    s_mov_b32 s6, 0
    v_mov_b32 v7, 0xff800000
K2_sl0:
    s_lshr_b32 s7, s6, 2
    s_mul_i32 s7, s7, 19456
    s_add_u32 s7, s7, s75
    s_and_b32 s68, s6, 3
    s_mul_i32 s70, s68, 2560
    s_add_u32 s70, s70, s7
    s_lshr_b32 s69, s68, 1
    s_lshl_b32 s69, s69, 9
    s_add_u32 s69, s69, s7
    s_bitcmp1_b32 s6, 0
    s_cselect_b32 s71, 8, 0
    s_add_u32 s69, s69, s71
    s_lshl_b32 s68, s68, 10
    s_add_u32 s68, s68, s7
    buffer_load_dwordx4 v[88:91], v8, s[60:63], s68 offen sc1
    buffer_load_dwordx4 v[92:95], v8, s[60:63], s68 offen offset:512 sc1
    buffer_load_dwordx2 v[96:97], v9, s[60:63], s69 offen sc1
    s_waitcnt vmcnt(0)
    v_mfma_f32_32x32x16_bf16 v[16:31], v[88:91], v[116:119], 0
    v_mfma_f32_32x32x16_bf16 v[32:47], v[92:95], v[116:119], 0
    v_mfma_f32_32x32x8bf16_1k v[16:31], v[96:97], v[124:125], v[16:31]
    v_mfma_f32_32x32x8bf16_1k v[32:47], v[96:97], v[126:127], v[32:47]
    s_nop 15
    v_max3_f32 v7, v7, v16, v17
    v_max3_f32 v7, v7, v18, v19
    v_max3_f32 v7, v7, v20, v21
    v_max3_f32 v7, v7, v22, v23
    v_max3_f32 v7, v7, v24, v25
    v_max3_f32 v7, v7, v26, v27
    v_max3_f32 v7, v7, v28, v29
    v_max3_f32 v7, v7, v30, v31
    v_max3_f32 v7, v7, v32, v33
    v_max3_f32 v7, v7, v34, v35
    v_max3_f32 v7, v7, v36, v37
    v_max3_f32 v7, v7, v38, v39
    v_max3_f32 v7, v7, v40, v41
    v_max3_f32 v7, v7, v42, v43
    v_max3_f32 v7, v7, v44, v45
    v_max3_f32 v7, v7, v46, v47
    s_add_u32 s6, s6, 1
    s_cmp_lt_u32 s6, 32
    s_cbranch_scc1 K2_sl0
    v_mov_b32 v6, v7
    s_nop 1
    v_permlane32_swap_b32 v7, v6
    s_nop 1
    v_max_f32 v7, v7, v6
    s_mov_b32 s6, 0
    v_mov_b32 v48, 0
    v_mov_b32 v49, 0
    v_mov_b32 v50, 0
    v_mov_b32 v51, 0
    v_mov_b32 v52, 0
    v_mov_b32 v53, 0
    v_mov_b32 v54, 0
    v_mov_b32 v55, 0
    v_mov_b32 v56, 0
    v_mov_b32 v57, 0
    v_mov_b32 v58, 0
    v_mov_b32 v59, 0
    v_mov_b32 v60, 0
    v_mov_b32 v61, 0
    v_mov_b32 v62, 0
    v_mov_b32 v63, 0
K2_sl1:
    s_lshr_b32 s7, s6, 2
    s_mul_i32 s7, s7, 19456
    s_add_u32 s7, s7, s75
    s_and_b32 s68, s6, 3
    s_mul_i32 s70, s68, 2560
    s_add_u32 s70, s70, s7
    s_lshr_b32 s69, s68, 1
    s_lshl_b32 s69, s69, 9
    s_add_u32 s69, s69, s7
    s_bitcmp1_b32 s6, 0
    s_cselect_b32 s71, 8, 0
    s_add_u32 s69, s69, s71
    s_lshl_b32 s68, s68, 10
    s_add_u32 s68, s68, s7
    buffer_load_dwordx4 v[88:91], v8, s[60:63], s68 offen sc1
    buffer_load_dwordx4 v[92:95], v8, s[60:63], s68 offen offset:512 sc1
    buffer_load_dwordx2 v[96:97], v9, s[60:63], s69 offen sc1
    buffer_load_dwordx4 v[100:103], v10, s[60:63], s70 offen offset:0 sc1
    buffer_load_dwordx4 v[104:107], v11, s[60:63], s70 offen offset:0 sc1
    buffer_load_dwordx4 v[108:111], v10, s[60:63], s70 offen offset:1280 sc1
    buffer_load_dwordx4 v[112:115], v11, s[60:63], s70 offen offset:1280 sc1
    s_waitcnt vmcnt(0)
    v_mfma_f32_32x32x16_bf16 v[16:31], v[88:91], v[116:119], 0
    v_mfma_f32_32x32x16_bf16 v[32:47], v[92:95], v[116:119], 0
    v_mfma_f32_32x32x8bf16_1k v[16:31], v[96:97], v[124:125], v[16:31]
    v_mfma_f32_32x32x8bf16_1k v[32:47], v[96:97], v[126:127], v[32:47]
    s_nop 15
    v_sub_f32 v16, v16, v7
    v_sub_f32 v17, v17, v7
    v_sub_f32 v18, v18, v7
    v_sub_f32 v19, v19, v7
    v_sub_f32 v20, v20, v7
    v_sub_f32 v21, v21, v7
    v_sub_f32 v22, v22, v7
    v_sub_f32 v23, v23, v7
    v_sub_f32 v24, v24, v7
    v_sub_f32 v25, v25, v7
    v_sub_f32 v26, v26, v7
    v_sub_f32 v27, v27, v7
    v_sub_f32 v28, v28, v7
    v_sub_f32 v29, v29, v7
    v_sub_f32 v30, v30, v7
    v_sub_f32 v31, v31, v7
    v_exp_f32 v16, v16
    v_exp_f32 v17, v17
    v_exp_f32 v18, v18
    v_exp_f32 v19, v19
    v_exp_f32 v20, v20
    v_exp_f32 v21, v21
    v_exp_f32 v22, v22
    v_exp_f32 v23, v23
    v_exp_f32 v24, v24
    v_exp_f32 v25, v25
    v_exp_f32 v26, v26
    v_exp_f32 v27, v27
    v_exp_f32 v28, v28
    v_exp_f32 v29, v29
    v_exp_f32 v30, v30
    v_exp_f32 v31, v31
    s_nop 0
    v_cvt_pk_bf16_f32 v80, v16, v17
    v_cvt_pk_bf16_f32 v81, v18, v19
    v_cvt_pk_bf16_f32 v82, v20, v21
    v_cvt_pk_bf16_f32 v83, v22, v23
    v_cvt_pk_bf16_f32 v84, v24, v25
    v_cvt_pk_bf16_f32 v85, v26, v27
    v_cvt_pk_bf16_f32 v86, v28, v29
    v_cvt_pk_bf16_f32 v87, v30, v31
    s_nop 1
    v_mfma_f32_32x32x16_bf16 v[48:63], v[100:103], v[80:83], v[48:63]
    v_mfma_f32_32x32x16_bf16 v[48:63], v[104:107], v[84:87], v[48:63]
    v_sub_f32 v32, v32, v7
    v_sub_f32 v33, v33, v7
    v_sub_f32 v34, v34, v7
    v_sub_f32 v35, v35, v7
    v_sub_f32 v36, v36, v7
    v_sub_f32 v37, v37, v7
    v_sub_f32 v38, v38, v7
    v_sub_f32 v39, v39, v7
    v_sub_f32 v40, v40, v7
    v_sub_f32 v41, v41, v7
    v_sub_f32 v42, v42, v7
    v_sub_f32 v43, v43, v7
    v_sub_f32 v44, v44, v7
    v_sub_f32 v45, v45, v7
    v_sub_f32 v46, v46, v7
    v_sub_f32 v47, v47, v7
    v_exp_f32 v32, v32
    v_exp_f32 v33, v33
    v_exp_f32 v34, v34
    v_exp_f32 v35, v35
    v_exp_f32 v36, v36
    v_exp_f32 v37, v37
    v_exp_f32 v38, v38
    v_exp_f32 v39, v39
    v_exp_f32 v40, v40
    v_exp_f32 v41, v41
    v_exp_f32 v42, v42
    v_exp_f32 v43, v43
    v_exp_f32 v44, v44
    v_exp_f32 v45, v45
    v_exp_f32 v46, v46
    v_exp_f32 v47, v47
    s_nop 0
    v_cvt_pk_bf16_f32 v80, v32, v33
    v_cvt_pk_bf16_f32 v81, v34, v35
    v_cvt_pk_bf16_f32 v82, v36, v37
    v_cvt_pk_bf16_f32 v83, v38, v39
    v_cvt_pk_bf16_f32 v84, v40, v41
    v_cvt_pk_bf16_f32 v85, v42, v43
    v_cvt_pk_bf16_f32 v86, v44, v45
    v_cvt_pk_bf16_f32 v87, v46, v47
    s_nop 1
    v_mfma_f32_32x32x16_bf16 v[48:63], v[108:111], v[80:83], v[48:63]
    v_mfma_f32_32x32x16_bf16 v[48:63], v[112:115], v[84:87], v[48:63]
    s_add_u32 s6, s6, 1
    s_cmp_lt_u32 s6, 32
    s_cbranch_scc1 K2_sl1
    s_nop 15
    v_cndmask_b32 v6, v58, v60, s[8:9]
    s_branch K2_fin
K2_ssm:
    s_sub_u32 s7, s47, 20
    s_and_b32 s4, s6, 1
    s_mul_i32 s4, s4, 3
    s_lshr_b32 s3, s7, 2
    s_add_u32 s4, s4, s3
    s_and_b32 s7, s7, 3
    s_lshr_b32 s3, s6, 1
    s_lshl_b32 s3, s3, 2
    s_add_u32 s3, s3, s7
    s_setprio 3
    s_nop 0
    s_mov_b32 s48, s22
    s_mov_b32 s49, s23
    s_mov_b32 s50, 2359296
    s_mov_b32 s51, 0x00020000
    s_mov_b32 s52, s28
    s_mov_b32 s53, s29
    s_mov_b32 s54, 663552
    s_mov_b32 s55, 0x00020000
    s_mov_b32 s56, s30
    s_mov_b32 s57, s31
    s_mov_b32 s58, 663552
    s_mov_b32 s59, 0x00020000
    s_mov_b32 s6, s5
    v_lshrrev_b32 v8, 3, v0
    v_lshrrev_b32 v9, 4, v0
    s_and_b32 s7, s6, 1
    s_lshl_b32 s7, s7, 2
    v_add_u32 v9, s7, v9
    v_and_b32 v10, 7, v0
    v_xor_b32 v9, v9, v10
    s_lshl_b32 s7, s6, 3
    v_add_u32 v8, s7, v8
    v_mul_u32_u24 v8, 1152, v8
    v_lshl_add_u32 v6, v9, 4, v8
    s_mul_i32 s68, s3, 147456
    s_add_u32 s72, s68, 73728
    s_mul_i32 s69, s4, 110592
    s_lshl_b32 s76, s5, 10
    s_and_b32 s77, s5, 3
    s_lshl_b32 s77, s77, 10
    s_lshr_b32 s71, s5, 2
    s_lshl_b32 s70, s71, 5
    s_sub_u32 s70, 64, s70
    s_mul_i32 s70, s70, 1152
    s_add_u32 s70, s70, s69
    s_sub_u32 s6, s47, 20
    s_lshr_b32 s7, s6, 2
    s_mul_i32 s7, s7, 3
    s_and_b32 s6, s6, 3
    s_lshl_b32 s6, s6, 1
    s_add_u32 s6, s6, s7
    s_sub_u32 s7, s6, 9
    s_cmp_ge_u32 s6, 9
    s_cselect_b32 s6, s7, s6
    s_mul_i32 s78, s6, 128
    s_mov_b32 s60, s44
    s_mov_b32 s61, s45
    s_mov_b32 s62, 18021376
    s_mov_b32 s63, 0x00020000
    v_and_b32 v1, 31, v0
    v_lshrrev_b32 v2, 5, v0
    s_mov_b32 s8, 0
    s_mov_b32 s9, -1
    s_mov_b32 s10, 0xffff0000
    s_mov_b32 s11, 0xffff0000
    s_and_b32 s14, s5, 3
    s_mul_i32 s46, s4, 96
    s_lshl_b32 s6, s71, 6
    s_add_u32 s46, s46, s6
    v_add_u32 v3, s46, v1
    v_lshlrev_b32 v3, 1, v3
    s_and_b32 s6, s14, 1
    s_lshl_b32 s6, s6, 6
    s_sub_u32 s6, s6, 128
    s_cmp_eq_u32 s71, 0
    s_cselect_b32 s6, 64, s6
    v_add_u32 v4, s6, v3
    global_load_ushort v32, v3, s[24:25]
    global_load_ushort v33, v3, s[26:27]
    global_load_ushort v34, v3, s[36:37]
    global_load_ushort v48, v4, s[24:25]
    global_load_ushort v49, v4, s[26:27]
    global_load_ushort v50, v4, s[36:37]
    v_bfe_u32 v5, v1, 1, 1
    v_lshrrev_b32 v4, 3, v1
    v_lshl_add_u32 v5, v4, 1, v5
    v_and_b32 v4, 1, v1
    v_lshl_add_u32 v5, v4, 3, v5
    v_and_b32 v4, 4, v1
    v_lshl_add_u32 v5, v4, 2, v5
    s_lshl_b32 s7, s14, 12
    v_bfe_u32 v4, v5, 1, 3
    v_xor_b32 v4, v4, v2
    v_lshlrev_b32 v4, 4, v4
    v_lshl_add_u32 v4, v5, 7, v4
    v_add_u32 v60, s7, v4
    v_xor_b32 v61, 32, v60
    v_xor_b32 v62, 64, v60
    v_xor_b32 v63, 96, v60
    s_mul_i32 s7, s71, 12288
    s_add_u32 s7, s7, 32768
    v_bfe_u32 v4, v1, 1, 3
    v_xor_b32 v4, v4, v2
    v_lshlrev_b32 v4, 4, v4
    v_lshl_add_u32 v4, v1, 7, v4
    v_add_u32 v28, s7, v4
    v_xor_b32 v29, 32, v28
    v_xor_b32 v30, 64, v28
    v_xor_b32 v31, 96, v28
    s_cmp_lg_u32 s71, 0
    s_cbranch_scc1 S_i1
    s_add_u32 m0, s76, 0
    s_add_u32 s7, s68, s78
    buffer_load_dwordx4 v6, s[48:51], s7 offen lds
    s_add_u32 m0, s76, 8192
    s_add_u32 s7, s72, s78
    buffer_load_dwordx4 v6, s[48:51], s7 offen lds
    s_add_u32 m0, s76, 32768
    s_add_u32 s7, s69, s78
    buffer_load_dwordx4 v6, s[52:55], s7 offen lds
    s_add_u32 m0, s77, 40960
    s_add_u32 s7, s70, s78
    buffer_load_dwordx4 v6, s[52:55], s7 offen lds
    s_add_u32 m0, s76, 45056
    s_add_u32 s7, s69, s78
    buffer_load_dwordx4 v6, s[56:59], s7 offen lds
    s_add_u32 s78, s78, 128
    s_cmp_eq_u32 s78, 1152
    s_cselect_b32 s78, 0, s78
    s_branch S_i2
S_i1:
    s_add_u32 m0, s76, 0
    s_add_u32 s7, s68, s78
    buffer_load_dwordx4 v6, s[48:51], s7 offen lds
    s_add_u32 m0, s76, 8192
    s_add_u32 s7, s72, s78
    buffer_load_dwordx4 v6, s[48:51], s7 offen lds
    s_add_u32 m0, s76, 32768
    s_add_u32 s7, s69, s78
    buffer_load_dwordx4 v6, s[52:55], s7 offen lds
    s_add_u32 m0, s76, 45056
    s_add_u32 s7, s69, s78
    buffer_load_dwordx4 v6, s[56:59], s7 offen lds
    s_add_u32 m0, s77, 53248
    s_add_u32 s7, s70, s78
    buffer_load_dwordx4 v6, s[56:59], s7 offen lds
    s_add_u32 s78, s78, 128
    s_cmp_eq_u32 s78, 1152
    s_cselect_b32 s78, 0, s78
S_i2:
    s_mov_b32 s12, 1069066811
    s_waitcnt vmcnt(5)
    v_lshlrev_b32 v32, 16, v32
    v_lshlrev_b32 v33, 16, v33
    v_lshlrev_b32 v34, 16, v34
    v_mul_f32 v34, s12, v34
    v_exp_f32 v34, v34
    s_nop 0
    v_cvt_pk_bf16_f32 v34, v34, v34
    v_lshlrev_b32 v34, 16, v34
    v_mul_f32 v35, v34, v32
    v_mul_f32 v34, v34, v33
    v_mul_f32 v35, s12, v35
    v_mul_f32 v34, 0.15915494309189532, v34
    v_exp_f32 v35, v35
    v_fract_f32 v34, v34
    v_cos_f32 v8, v34
    v_sin_f32 v9, v34
    v_mul_f32 v36, v32, v32
    v_mul_f32 v8, v8, v35
    v_mul_f32 v9, v9, v35
    v_fma_f32 v36, v33, v33, v36
    v_rcp_f32 v36, v36
    v_add_f32 v37, -1.0, v8
    v_mul_f32 v10, v37, v32
    v_mul_f32 v11, v9, v32
    v_add_f32 v36, v36, v36
    v_fma_f32 v10, v9, v33, v10
    v_fma_f32 v11, -v37, v33, v11
    v_mul_f32 v10, v10, v36
    v_mul_f32 v11, v11, v36
    v_mul_f32 v32, v8, v8
    v_mul_f32 v33, v8, v9
    v_fma_f32 v32, -v9, v9, v32
    v_fma_f32 v33, v9, v8, v33
    v_mul_f32 v34, v32, v32
    v_mul_f32 v35, v32, v33
    v_fma_f32 v34, -v33, v33, v34
    v_fma_f32 v35, v33, v32, v35
    v_mul_f32 v12, v34, v34
    v_mul_f32 v13, v34, v35
    v_fma_f32 v12, -v35, v35, v12
    v_fma_f32 v13, v35, v34, v13
    v_mul_f32 v14, v12, v12
    v_mul_f32 v15, v12, v13
    v_fma_f32 v14, -v13, v13, v14
    v_fma_f32 v15, v13, v12, v15
    v_mul_f32 v16, v14, v14
    v_mul_f32 v17, v14, v15
    v_fma_f32 v16, -v15, v15, v16
    v_fma_f32 v17, v15, v14, v17
    v_lshlrev_b32 v48, 16, v48
    v_lshlrev_b32 v49, 16, v49
    v_lshlrev_b32 v50, 16, v50
    v_mul_f32 v50, s12, v50
    v_exp_f32 v50, v50
    s_nop 0
    v_cvt_pk_bf16_f32 v50, v50, v50
    v_lshlrev_b32 v50, 16, v50
    v_mul_f32 v51, v50, v48
    v_mul_f32 v50, v50, v49
    v_mul_f32 v51, s12, v51
    v_mul_f32 v50, 0.15915494309189532, v50
    v_exp_f32 v51, v51
    v_fract_f32 v50, v50
    v_cos_f32 v18, v50
    v_sin_f32 v19, v50
    v_mul_f32 v52, v48, v48
    v_mul_f32 v18, v18, v51
    v_mul_f32 v19, v19, v51
    v_fma_f32 v52, v49, v49, v52
    v_rcp_f32 v52, v52
    v_add_f32 v53, -1.0, v18
    v_mul_f32 v20, v53, v48
    v_mul_f32 v21, v19, v48
    v_add_f32 v52, v52, v52
    v_fma_f32 v20, v19, v49, v20
    v_fma_f32 v21, -v53, v49, v21
    v_mul_f32 v20, v20, v52
    v_mul_f32 v21, v21, v52
    v_mul_f32 v48, v18, v18
    v_mul_f32 v49, v18, v19
    v_fma_f32 v48, -v19, v19, v48
    v_fma_f32 v49, v19, v18, v49
    v_mul_f32 v50, v48, v48
    v_mul_f32 v51, v48, v49
    v_fma_f32 v50, -v49, v49, v50
    v_fma_f32 v51, v49, v48, v51
    v_mul_f32 v22, v50, v50
    v_mul_f32 v23, v50, v51
    v_fma_f32 v22, -v51, v51, v22
    v_fma_f32 v23, v51, v50, v23
    v_mul_f32 v24, v22, v22
    v_mul_f32 v25, v22, v23
    v_fma_f32 v24, -v23, v23, v24
    v_fma_f32 v25, v23, v22, v25
    v_mul_f32 v26, v24, v24
    v_mul_f32 v27, v24, v25
    v_fma_f32 v26, -v25, v25, v26
    v_fma_f32 v27, v25, v24, v27
    s_cmp_lg_u32 s71, 0
    s_cbranch_scc1 S_g1
    s_waitcnt vmcnt(1)
    s_barrier
    ds_read_b128 v[32:35], v60
    ds_read_b128 v[36:39], v61
    ds_read_b128 v[40:43], v62
    ds_read_b128 v[44:47], v63
    ds_read_b128 v[48:51], v28 offset:0
    ds_read_b128 v[52:55], v28 offset:4096
    ds_read_b128 v[56:59], v28 offset:8192
    s_waitcnt lgkmcnt(2)
    v_mfma_f32_32x32x16_bf16 v[64:79], v[32:35], v[48:51], 0
    ds_read_b128 v[80:83], v29 offset:0
    s_add_u32 m0, s76, 16384
    s_add_u32 s7, s68, s78
    buffer_load_dwordx4 v6, s[48:51], s7 offen lds
    s_waitcnt lgkmcnt(2)
    v_mfma_f32_32x32x16_bf16 v[96:111], v[32:35], v[52:55], 0
    ds_read_b128 v[84:87], v29 offset:4096
    s_add_u32 m0, s76, 24576
    s_add_u32 s7, s72, s78
    buffer_load_dwordx4 v6, s[48:51], s7 offen lds
    s_waitcnt lgkmcnt(2)
    v_mfma_f32_32x32x16_bf16 v[112:127], v[32:35], v[56:59], 0
    ds_read_b128 v[88:91], v29 offset:8192
    s_add_u32 m0, s76, 57344
    s_add_u32 s7, s69, s78
    buffer_load_dwordx4 v6, s[52:55], s7 offen lds
    v_add_u32 v60, 16384, v60
    v_add_u32 v28, 24576, v28
    s_waitcnt lgkmcnt(2)
    v_mfma_f32_32x32x16_bf16 v[64:79], v[36:39], v[80:83], v[64:79]
    ds_read_b128 v[48:51], v30 offset:0
    s_add_u32 m0, s77, 65536
    s_add_u32 s7, s70, s78
    buffer_load_dwordx4 v6, s[52:55], s7 offen lds
    s_waitcnt lgkmcnt(2)
    v_mfma_f32_32x32x16_bf16 v[96:111], v[36:39], v[84:87], v[96:111]
    ds_read_b128 v[52:55], v30 offset:4096
    s_waitcnt lgkmcnt(2)
    v_mfma_f32_32x32x16_bf16 v[112:127], v[36:39], v[88:91], v[112:127]
    ds_read_b128 v[56:59], v30 offset:8192
    v_add_u32 v61, 16384, v61
    v_add_u32 v29, 24576, v29
    s_waitcnt vmcnt(4)
    s_barrier
    s_waitcnt lgkmcnt(2)
    v_mfma_f32_32x32x16_bf16 v[64:79], v[40:43], v[48:51], v[64:79]
    ds_read_b128 v[80:83], v31 offset:0
    s_add_u32 m0, s76, 69632
    s_add_u32 s7, s69, s78
    buffer_load_dwordx4 v6, s[56:59], s7 offen lds
    s_add_u32 s78, s78, 128
    s_cmp_eq_u32 s78, 1152
    s_cselect_b32 s78, 0, s78
    s_waitcnt lgkmcnt(2)
    v_mfma_f32_32x32x16_bf16 v[96:111], v[40:43], v[52:55], v[96:111]
    ds_read_b128 v[84:87], v31 offset:4096
    s_waitcnt lgkmcnt(2)
    v_mfma_f32_32x32x16_bf16 v[112:127], v[40:43], v[56:59], v[112:127]
    ds_read_b128 v[88:91], v31 offset:8192
    v_add_u32 v62, 16384, v62
    v_add_u32 v30, 24576, v30
    s_waitcnt lgkmcnt(2)
    v_mfma_f32_32x32x16_bf16 v[64:79], v[44:47], v[80:83], v[64:79]
    v_add_u32 v63, 16384, v63
    s_waitcnt lgkmcnt(1)
    v_mfma_f32_32x32x16_bf16 v[96:111], v[44:47], v[84:87], v[96:111]
    v_add_u32 v31, 24576, v31
    s_waitcnt lgkmcnt(0)
    v_mfma_f32_32x32x16_bf16 v[112:127], v[44:47], v[88:91], v[112:127]
    s_waitcnt vmcnt(1)
    s_barrier
    ds_read_b128 v[32:35], v60
    ds_read_b128 v[36:39], v61
    ds_read_b128 v[40:43], v62
    ds_read_b128 v[44:47], v63
    ds_read_b128 v[48:51], v28 offset:0
    ds_read_b128 v[52:55], v28 offset:4096
    ds_read_b128 v[56:59], v28 offset:8192
    s_waitcnt lgkmcnt(2)
    v_mfma_f32_32x32x16_bf16 v[64:79], v[32:35], v[48:51], v[64:79]
    ds_read_b128 v[80:83], v29 offset:0
    s_add_u32 m0, s76, 0
    s_add_u32 s7, s68, s78
    buffer_load_dwordx4 v6, s[48:51], s7 offen lds
    s_waitcnt lgkmcnt(2)
    v_mfma_f32_32x32x16_bf16 v[96:111], v[32:35], v[52:55], v[96:111]
    ds_read_b128 v[84:87], v29 offset:4096
    s_add_u32 m0, s76, 8192
    s_add_u32 s7, s72, s78
    buffer_load_dwordx4 v6, s[48:51], s7 offen lds
    s_waitcnt lgkmcnt(2)
    v_mfma_f32_32x32x16_bf16 v[112:127], v[32:35], v[56:59], v[112:127]
    ds_read_b128 v[88:91], v29 offset:8192
    s_add_u32 m0, s76, 32768
    s_add_u32 s7, s69, s78
    buffer_load_dwordx4 v6, s[52:55], s7 offen lds
    v_add_u32 v60, 4294950912, v60
    v_add_u32 v28, 4294942720, v28
    s_waitcnt lgkmcnt(2)
    v_mfma_f32_32x32x16_bf16 v[64:79], v[36:39], v[80:83], v[64:79]
    ds_read_b128 v[48:51], v30 offset:0
    s_add_u32 m0, s77, 40960
    s_add_u32 s7, s70, s78
    buffer_load_dwordx4 v6, s[52:55], s7 offen lds
    s_waitcnt lgkmcnt(2)
    v_mfma_f32_32x32x16_bf16 v[96:111], v[36:39], v[84:87], v[96:111]
    ds_read_b128 v[52:55], v30 offset:4096
    s_waitcnt lgkmcnt(2)
    v_mfma_f32_32x32x16_bf16 v[112:127], v[36:39], v[88:91], v[112:127]
    ds_read_b128 v[56:59], v30 offset:8192
    v_add_u32 v61, 4294950912, v61
    v_add_u32 v29, 4294942720, v29
    s_waitcnt vmcnt(4)
    s_barrier
    s_waitcnt lgkmcnt(2)
    v_mfma_f32_32x32x16_bf16 v[64:79], v[40:43], v[48:51], v[64:79]
    ds_read_b128 v[80:83], v31 offset:0
    s_add_u32 m0, s76, 45056
    s_add_u32 s7, s69, s78
    buffer_load_dwordx4 v6, s[56:59], s7 offen lds
    s_add_u32 s78, s78, 128
    s_cmp_eq_u32 s78, 1152
    s_cselect_b32 s78, 0, s78
    s_waitcnt lgkmcnt(2)
    v_mfma_f32_32x32x16_bf16 v[96:111], v[40:43], v[52:55], v[96:111]
    ds_read_b128 v[84:87], v31 offset:4096
    s_waitcnt lgkmcnt(2)
    v_mfma_f32_32x32x16_bf16 v[112:127], v[40:43], v[56:59], v[112:127]
    ds_read_b128 v[88:91], v31 offset:8192
    v_add_u32 v62, 4294950912, v62
    v_add_u32 v30, 4294942720, v30
    s_waitcnt lgkmcnt(2)
    v_mfma_f32_32x32x16_bf16 v[64:79], v[44:47], v[80:83], v[64:79]
    v_add_u32 v63, 4294950912, v63
    s_waitcnt lgkmcnt(1)
    v_mfma_f32_32x32x16_bf16 v[96:111], v[44:47], v[84:87], v[96:111]
    v_add_u32 v31, 4294942720, v31
    s_waitcnt lgkmcnt(0)
    v_mfma_f32_32x32x16_bf16 v[112:127], v[44:47], v[88:91], v[112:127]
    s_waitcnt vmcnt(1)
    s_barrier
    ds_read_b128 v[32:35], v60
    ds_read_b128 v[36:39], v61
    ds_read_b128 v[40:43], v62
    ds_read_b128 v[44:47], v63
    ds_read_b128 v[48:51], v28 offset:0
    ds_read_b128 v[52:55], v28 offset:4096
    ds_read_b128 v[56:59], v28 offset:8192
    s_waitcnt lgkmcnt(2)
    v_mfma_f32_32x32x16_bf16 v[64:79], v[32:35], v[48:51], v[64:79]
    ds_read_b128 v[80:83], v29 offset:0
    s_add_u32 m0, s76, 16384
    s_add_u32 s7, s68, s78
    buffer_load_dwordx4 v6, s[48:51], s7 offen lds
    s_waitcnt lgkmcnt(2)
    v_mfma_f32_32x32x16_bf16 v[96:111], v[32:35], v[52:55], v[96:111]
    ds_read_b128 v[84:87], v29 offset:4096
    s_add_u32 m0, s76, 24576
    s_add_u32 s7, s72, s78
    buffer_load_dwordx4 v6, s[48:51], s7 offen lds
    s_waitcnt lgkmcnt(2)
    v_mfma_f32_32x32x16_bf16 v[112:127], v[32:35], v[56:59], v[112:127]
    ds_read_b128 v[88:91], v29 offset:8192
    s_add_u32 m0, s76, 57344
    s_add_u32 s7, s69, s78
    buffer_load_dwordx4 v6, s[52:55], s7 offen lds
    v_add_u32 v60, 16384, v60
    v_add_u32 v28, 24576, v28
    s_waitcnt lgkmcnt(2)
    v_mfma_f32_32x32x16_bf16 v[64:79], v[36:39], v[80:83], v[64:79]
    ds_read_b128 v[48:51], v30 offset:0
    s_add_u32 m0, s77, 65536
    s_add_u32 s7, s70, s78
    buffer_load_dwordx4 v6, s[52:55], s7 offen lds
    s_waitcnt lgkmcnt(2)
    v_mfma_f32_32x32x16_bf16 v[96:111], v[36:39], v[84:87], v[96:111]
    ds_read_b128 v[52:55], v30 offset:4096
    s_waitcnt lgkmcnt(2)
    v_mfma_f32_32x32x16_bf16 v[112:127], v[36:39], v[88:91], v[112:127]
    ds_read_b128 v[56:59], v30 offset:8192
    v_add_u32 v61, 16384, v61
    v_add_u32 v29, 24576, v29
    s_waitcnt vmcnt(4)
    s_barrier
    s_waitcnt lgkmcnt(2)
    v_mfma_f32_32x32x16_bf16 v[64:79], v[40:43], v[48:51], v[64:79]
    ds_read_b128 v[80:83], v31 offset:0
    s_add_u32 m0, s76, 69632
    s_add_u32 s7, s69, s78
    buffer_load_dwordx4 v6, s[56:59], s7 offen lds
    s_add_u32 s78, s78, 128
    s_cmp_eq_u32 s78, 1152
    s_cselect_b32 s78, 0, s78
    s_waitcnt lgkmcnt(2)
    v_mfma_f32_32x32x16_bf16 v[96:111], v[40:43], v[52:55], v[96:111]
    ds_read_b128 v[84:87], v31 offset:4096
    s_waitcnt lgkmcnt(2)
    v_mfma_f32_32x32x16_bf16 v[112:127], v[40:43], v[56:59], v[112:127]
    ds_read_b128 v[88:91], v31 offset:8192
    v_add_u32 v62, 16384, v62
    v_add_u32 v30, 24576, v30
    s_waitcnt lgkmcnt(2)
    v_mfma_f32_32x32x16_bf16 v[64:79], v[44:47], v[80:83], v[64:79]
    v_add_u32 v63, 16384, v63
    s_waitcnt lgkmcnt(1)
    v_mfma_f32_32x32x16_bf16 v[96:111], v[44:47], v[84:87], v[96:111]
    v_add_u32 v31, 24576, v31
    s_waitcnt lgkmcnt(0)
    v_mfma_f32_32x32x16_bf16 v[112:127], v[44:47], v[88:91], v[112:127]
    s_waitcnt vmcnt(1)
    s_barrier
    ds_read_b128 v[32:35], v60
    ds_read_b128 v[36:39], v61
    ds_read_b128 v[40:43], v62
    ds_read_b128 v[44:47], v63
    ds_read_b128 v[48:51], v28 offset:0
    ds_read_b128 v[52:55], v28 offset:4096
    ds_read_b128 v[56:59], v28 offset:8192
    s_waitcnt lgkmcnt(2)
    v_mfma_f32_32x32x16_bf16 v[64:79], v[32:35], v[48:51], v[64:79]
    ds_read_b128 v[80:83], v29 offset:0
    s_add_u32 m0, s76, 0
    s_add_u32 s7, s68, s78
    buffer_load_dwordx4 v6, s[48:51], s7 offen lds
    s_waitcnt lgkmcnt(2)
    v_mfma_f32_32x32x16_bf16 v[96:111], v[32:35], v[52:55], v[96:111]
    ds_read_b128 v[84:87], v29 offset:4096
    s_add_u32 m0, s76, 8192
    s_add_u32 s7, s72, s78
    buffer_load_dwordx4 v6, s[48:51], s7 offen lds
    s_waitcnt lgkmcnt(2)
    v_mfma_f32_32x32x16_bf16 v[112:127], v[32:35], v[56:59], v[112:127]
    ds_read_b128 v[88:91], v29 offset:8192
    s_add_u32 m0, s76, 32768
    s_add_u32 s7, s69, s78
    buffer_load_dwordx4 v6, s[52:55], s7 offen lds
    v_add_u32 v60, 4294950912, v60
    v_add_u32 v28, 4294942720, v28
    s_waitcnt lgkmcnt(2)
    v_mfma_f32_32x32x16_bf16 v[64:79], v[36:39], v[80:83], v[64:79]
    ds_read_b128 v[48:51], v30 offset:0
    s_add_u32 m0, s77, 40960
    s_add_u32 s7, s70, s78
    buffer_load_dwordx4 v6, s[52:55], s7 offen lds
    s_waitcnt lgkmcnt(2)
    v_mfma_f32_32x32x16_bf16 v[96:111], v[36:39], v[84:87], v[96:111]
    ds_read_b128 v[52:55], v30 offset:4096
    s_waitcnt lgkmcnt(2)
    v_mfma_f32_32x32x16_bf16 v[112:127], v[36:39], v[88:91], v[112:127]
    ds_read_b128 v[56:59], v30 offset:8192
    v_add_u32 v61, 4294950912, v61
    v_add_u32 v29, 4294942720, v29
    s_waitcnt vmcnt(4)
    s_barrier
    s_waitcnt lgkmcnt(2)
    v_mfma_f32_32x32x16_bf16 v[64:79], v[40:43], v[48:51], v[64:79]
    ds_read_b128 v[80:83], v31 offset:0
    s_add_u32 m0, s76, 45056
    s_add_u32 s7, s69, s78
    buffer_load_dwordx4 v6, s[56:59], s7 offen lds
    s_add_u32 s78, s78, 128
    s_cmp_eq_u32 s78, 1152
    s_cselect_b32 s78, 0, s78
    s_waitcnt lgkmcnt(2)
    v_mfma_f32_32x32x16_bf16 v[96:111], v[40:43], v[52:55], v[96:111]
    ds_read_b128 v[84:87], v31 offset:4096
    s_waitcnt lgkmcnt(2)
    v_mfma_f32_32x32x16_bf16 v[112:127], v[40:43], v[56:59], v[112:127]
    ds_read_b128 v[88:91], v31 offset:8192
    v_add_u32 v62, 4294950912, v62
    v_add_u32 v30, 4294942720, v30
    s_waitcnt lgkmcnt(2)
    v_mfma_f32_32x32x16_bf16 v[64:79], v[44:47], v[80:83], v[64:79]
    v_add_u32 v63, 4294950912, v63
    s_waitcnt lgkmcnt(1)
    v_mfma_f32_32x32x16_bf16 v[96:111], v[44:47], v[84:87], v[96:111]
    v_add_u32 v31, 4294942720, v31
    s_waitcnt lgkmcnt(0)
    v_mfma_f32_32x32x16_bf16 v[112:127], v[44:47], v[88:91], v[112:127]
    s_waitcnt vmcnt(1)
    s_barrier
    ds_read_b128 v[32:35], v60
    ds_read_b128 v[36:39], v61
    ds_read_b128 v[40:43], v62
    ds_read_b128 v[44:47], v63
    ds_read_b128 v[48:51], v28 offset:0
    ds_read_b128 v[52:55], v28 offset:4096
    ds_read_b128 v[56:59], v28 offset:8192
    s_waitcnt lgkmcnt(2)
    v_mfma_f32_32x32x16_bf16 v[64:79], v[32:35], v[48:51], v[64:79]
    ds_read_b128 v[80:83], v29 offset:0
    s_add_u32 m0, s76, 16384
    s_add_u32 s7, s68, s78
    buffer_load_dwordx4 v6, s[48:51], s7 offen lds
    s_waitcnt lgkmcnt(2)
    v_mfma_f32_32x32x16_bf16 v[96:111], v[32:35], v[52:55], v[96:111]
    ds_read_b128 v[84:87], v29 offset:4096
    s_add_u32 m0, s76, 24576
    s_add_u32 s7, s72, s78
    buffer_load_dwordx4 v6, s[48:51], s7 offen lds
    s_waitcnt lgkmcnt(2)
    v_mfma_f32_32x32x16_bf16 v[112:127], v[32:35], v[56:59], v[112:127]
    ds_read_b128 v[88:91], v29 offset:8192
    s_add_u32 m0, s76, 57344
    s_add_u32 s7, s69, s78
    buffer_load_dwordx4 v6, s[52:55], s7 offen lds
    v_add_u32 v60, 16384, v60
    v_add_u32 v28, 24576, v28
    s_waitcnt lgkmcnt(2)
    v_mfma_f32_32x32x16_bf16 v[64:79], v[36:39], v[80:83], v[64:79]
    ds_read_b128 v[48:51], v30 offset:0
    s_add_u32 m0, s77, 65536
    s_add_u32 s7, s70, s78
    buffer_load_dwordx4 v6, s[52:55], s7 offen lds
    s_waitcnt lgkmcnt(2)
    v_mfma_f32_32x32x16_bf16 v[96:111], v[36:39], v[84:87], v[96:111]
    ds_read_b128 v[52:55], v30 offset:4096
    s_waitcnt lgkmcnt(2)
    v_mfma_f32_32x32x16_bf16 v[112:127], v[36:39], v[88:91], v[112:127]
    ds_read_b128 v[56:59], v30 offset:8192
    v_add_u32 v61, 16384, v61
    v_add_u32 v29, 24576, v29
    s_waitcnt vmcnt(4)
    s_barrier
    s_waitcnt lgkmcnt(2)
    v_mfma_f32_32x32x16_bf16 v[64:79], v[40:43], v[48:51], v[64:79]
    ds_read_b128 v[80:83], v31 offset:0
    s_add_u32 m0, s76, 69632
    s_add_u32 s7, s69, s78
    buffer_load_dwordx4 v6, s[56:59], s7 offen lds
    s_add_u32 s78, s78, 128
    s_cmp_eq_u32 s78, 1152
    s_cselect_b32 s78, 0, s78
    s_waitcnt lgkmcnt(2)
    v_mfma_f32_32x32x16_bf16 v[96:111], v[40:43], v[52:55], v[96:111]
    ds_read_b128 v[84:87], v31 offset:4096
    s_waitcnt lgkmcnt(2)
    v_mfma_f32_32x32x16_bf16 v[112:127], v[40:43], v[56:59], v[112:127]
    ds_read_b128 v[88:91], v31 offset:8192
    v_add_u32 v62, 16384, v62
    v_add_u32 v30, 24576, v30
    s_waitcnt lgkmcnt(2)
    v_mfma_f32_32x32x16_bf16 v[64:79], v[44:47], v[80:83], v[64:79]
    v_add_u32 v63, 16384, v63
    s_waitcnt lgkmcnt(1)
    v_mfma_f32_32x32x16_bf16 v[96:111], v[44:47], v[84:87], v[96:111]
    v_add_u32 v31, 24576, v31
    s_waitcnt lgkmcnt(0)
    v_mfma_f32_32x32x16_bf16 v[112:127], v[44:47], v[88:91], v[112:127]
    s_waitcnt vmcnt(1)
    s_barrier
    ds_read_b128 v[32:35], v60
    ds_read_b128 v[36:39], v61
    ds_read_b128 v[40:43], v62
    ds_read_b128 v[44:47], v63
    ds_read_b128 v[48:51], v28 offset:0
    ds_read_b128 v[52:55], v28 offset:4096
    ds_read_b128 v[56:59], v28 offset:8192
    s_waitcnt lgkmcnt(2)
    v_mfma_f32_32x32x16_bf16 v[64:79], v[32:35], v[48:51], v[64:79]
    ds_read_b128 v[80:83], v29 offset:0
    s_add_u32 m0, s76, 0
    s_add_u32 s7, s68, s78
    buffer_load_dwordx4 v6, s[48:51], s7 offen lds
    s_waitcnt lgkmcnt(2)
    v_mfma_f32_32x32x16_bf16 v[96:111], v[32:35], v[52:55], v[96:111]
    ds_read_b128 v[84:87], v29 offset:4096
    s_add_u32 m0, s76, 8192
    s_add_u32 s7, s72, s78
    buffer_load_dwordx4 v6, s[48:51], s7 offen lds
    s_waitcnt lgkmcnt(2)
    v_mfma_f32_32x32x16_bf16 v[112:127], v[32:35], v[56:59], v[112:127]
    ds_read_b128 v[88:91], v29 offset:8192
    s_add_u32 m0, s76, 32768
    s_add_u32 s7, s69, s78
    buffer_load_dwordx4 v6, s[52:55], s7 offen lds
    v_add_u32 v60, 4294950912, v60
    v_add_u32 v28, 4294942720, v28
    s_waitcnt lgkmcnt(2)
    v_mfma_f32_32x32x16_bf16 v[64:79], v[36:39], v[80:83], v[64:79]
    ds_read_b128 v[48:51], v30 offset:0
    s_add_u32 m0, s77, 40960
    s_add_u32 s7, s70, s78
    buffer_load_dwordx4 v6, s[52:55], s7 offen lds
    s_waitcnt lgkmcnt(2)
    v_mfma_f32_32x32x16_bf16 v[96:111], v[36:39], v[84:87], v[96:111]
    ds_read_b128 v[52:55], v30 offset:4096
    s_waitcnt lgkmcnt(2)
    v_mfma_f32_32x32x16_bf16 v[112:127], v[36:39], v[88:91], v[112:127]
    ds_read_b128 v[56:59], v30 offset:8192
    v_add_u32 v61, 4294950912, v61
    v_add_u32 v29, 4294942720, v29
    s_waitcnt vmcnt(4)
    s_barrier
    s_waitcnt lgkmcnt(2)
    v_mfma_f32_32x32x16_bf16 v[64:79], v[40:43], v[48:51], v[64:79]
    ds_read_b128 v[80:83], v31 offset:0
    s_add_u32 m0, s76, 45056
    s_add_u32 s7, s69, s78
    buffer_load_dwordx4 v6, s[56:59], s7 offen lds
    s_add_u32 s78, s78, 128
    s_cmp_eq_u32 s78, 1152
    s_cselect_b32 s78, 0, s78
    s_waitcnt lgkmcnt(2)
    v_mfma_f32_32x32x16_bf16 v[96:111], v[40:43], v[52:55], v[96:111]
    ds_read_b128 v[84:87], v31 offset:4096
    s_waitcnt lgkmcnt(2)
    v_mfma_f32_32x32x16_bf16 v[112:127], v[40:43], v[56:59], v[112:127]
    ds_read_b128 v[88:91], v31 offset:8192
    v_add_u32 v62, 4294950912, v62
    v_add_u32 v30, 4294942720, v30
    s_waitcnt lgkmcnt(2)
    v_mfma_f32_32x32x16_bf16 v[64:79], v[44:47], v[80:83], v[64:79]
    v_add_u32 v63, 4294950912, v63
    s_waitcnt lgkmcnt(1)
    v_mfma_f32_32x32x16_bf16 v[96:111], v[44:47], v[84:87], v[96:111]
    v_add_u32 v31, 4294942720, v31
    s_waitcnt lgkmcnt(0)
    v_mfma_f32_32x32x16_bf16 v[112:127], v[44:47], v[88:91], v[112:127]
    s_waitcnt vmcnt(1)
    s_barrier
    ds_read_b128 v[32:35], v60
    ds_read_b128 v[36:39], v61
    ds_read_b128 v[40:43], v62
    ds_read_b128 v[44:47], v63
    ds_read_b128 v[48:51], v28 offset:0
    ds_read_b128 v[52:55], v28 offset:4096
    ds_read_b128 v[56:59], v28 offset:8192
    s_waitcnt lgkmcnt(2)
    v_mfma_f32_32x32x16_bf16 v[64:79], v[32:35], v[48:51], v[64:79]
    ds_read_b128 v[80:83], v29 offset:0
    s_add_u32 m0, s76, 16384
    s_add_u32 s7, s68, s78
    buffer_load_dwordx4 v6, s[48:51], s7 offen lds
    s_waitcnt lgkmcnt(2)
    v_mfma_f32_32x32x16_bf16 v[96:111], v[32:35], v[52:55], v[96:111]
    ds_read_b128 v[84:87], v29 offset:4096
    s_add_u32 m0, s76, 24576
    s_add_u32 s7, s72, s78
    buffer_load_dwordx4 v6, s[48:51], s7 offen lds
    s_waitcnt lgkmcnt(2)
    v_mfma_f32_32x32x16_bf16 v[112:127], v[32:35], v[56:59], v[112:127]
    ds_read_b128 v[88:91], v29 offset:8192
    s_add_u32 m0, s76, 57344
    s_add_u32 s7, s69, s78
    buffer_load_dwordx4 v6, s[52:55], s7 offen lds
    v_add_u32 v60, 16384, v60
    v_add_u32 v28, 24576, v28
    s_waitcnt lgkmcnt(2)
    v_mfma_f32_32x32x16_bf16 v[64:79], v[36:39], v[80:83], v[64:79]
    ds_read_b128 v[48:51], v30 offset:0
    s_add_u32 m0, s77, 65536
    s_add_u32 s7, s70, s78
    buffer_load_dwordx4 v6, s[52:55], s7 offen lds
    s_waitcnt lgkmcnt(2)
    v_mfma_f32_32x32x16_bf16 v[96:111], v[36:39], v[84:87], v[96:111]
    ds_read_b128 v[52:55], v30 offset:4096
    s_waitcnt lgkmcnt(2)
    v_mfma_f32_32x32x16_bf16 v[112:127], v[36:39], v[88:91], v[112:127]
    ds_read_b128 v[56:59], v30 offset:8192
    v_add_u32 v61, 16384, v61
    v_add_u32 v29, 24576, v29
    s_waitcnt vmcnt(4)
    s_barrier
    s_waitcnt lgkmcnt(2)
    v_mfma_f32_32x32x16_bf16 v[64:79], v[40:43], v[48:51], v[64:79]
    ds_read_b128 v[80:83], v31 offset:0
    s_add_u32 m0, s76, 69632
    s_add_u32 s7, s69, s78
    buffer_load_dwordx4 v6, s[56:59], s7 offen lds
    s_add_u32 s78, s78, 128
    s_cmp_eq_u32 s78, 1152
    s_cselect_b32 s78, 0, s78
    s_waitcnt lgkmcnt(2)
    v_mfma_f32_32x32x16_bf16 v[96:111], v[40:43], v[52:55], v[96:111]
    ds_read_b128 v[84:87], v31 offset:4096
    s_waitcnt lgkmcnt(2)
    v_mfma_f32_32x32x16_bf16 v[112:127], v[40:43], v[56:59], v[112:127]
    ds_read_b128 v[88:91], v31 offset:8192
    v_add_u32 v62, 16384, v62
    v_add_u32 v30, 24576, v30
    s_waitcnt lgkmcnt(2)
    v_mfma_f32_32x32x16_bf16 v[64:79], v[44:47], v[80:83], v[64:79]
    v_add_u32 v63, 16384, v63
    s_waitcnt lgkmcnt(1)
    v_mfma_f32_32x32x16_bf16 v[96:111], v[44:47], v[84:87], v[96:111]
    v_add_u32 v31, 24576, v31
    s_waitcnt lgkmcnt(0)
    v_mfma_f32_32x32x16_bf16 v[112:127], v[44:47], v[88:91], v[112:127]
    s_waitcnt vmcnt(1)
    s_barrier
    ds_read_b128 v[32:35], v60
    ds_read_b128 v[36:39], v61
    ds_read_b128 v[40:43], v62
    ds_read_b128 v[44:47], v63
    ds_read_b128 v[48:51], v28 offset:0
    ds_read_b128 v[52:55], v28 offset:4096
    ds_read_b128 v[56:59], v28 offset:8192
    s_waitcnt lgkmcnt(2)
    v_mfma_f32_32x32x16_bf16 v[64:79], v[32:35], v[48:51], v[64:79]
    ds_read_b128 v[80:83], v29 offset:0
    s_add_u32 m0, s76, 0
    s_add_u32 s7, s68, s78
    buffer_load_dwordx4 v6, s[48:51], s7 offen lds
    s_waitcnt lgkmcnt(2)
    v_mfma_f32_32x32x16_bf16 v[96:111], v[32:35], v[52:55], v[96:111]
    ds_read_b128 v[84:87], v29 offset:4096
    s_add_u32 m0, s76, 8192
    s_add_u32 s7, s72, s78
    buffer_load_dwordx4 v6, s[48:51], s7 offen lds
    s_waitcnt lgkmcnt(2)
    v_mfma_f32_32x32x16_bf16 v[112:127], v[32:35], v[56:59], v[112:127]
    ds_read_b128 v[88:91], v29 offset:8192
    s_add_u32 m0, s76, 32768
    s_add_u32 s7, s69, s78
    buffer_load_dwordx4 v6, s[52:55], s7 offen lds
    v_add_u32 v60, 4294950912, v60
    v_add_u32 v28, 4294942720, v28
    s_waitcnt lgkmcnt(2)
    v_mfma_f32_32x32x16_bf16 v[64:79], v[36:39], v[80:83], v[64:79]
    ds_read_b128 v[48:51], v30 offset:0
    s_add_u32 m0, s77, 40960
    s_add_u32 s7, s70, s78
    buffer_load_dwordx4 v6, s[52:55], s7 offen lds
    s_waitcnt lgkmcnt(2)
    v_mfma_f32_32x32x16_bf16 v[96:111], v[36:39], v[84:87], v[96:111]
    ds_read_b128 v[52:55], v30 offset:4096
    s_waitcnt lgkmcnt(2)
    v_mfma_f32_32x32x16_bf16 v[112:127], v[36:39], v[88:91], v[112:127]
    ds_read_b128 v[56:59], v30 offset:8192
    v_add_u32 v61, 4294950912, v61
    v_add_u32 v29, 4294942720, v29
    s_waitcnt vmcnt(4)
    s_barrier
    s_waitcnt lgkmcnt(2)
    v_mfma_f32_32x32x16_bf16 v[64:79], v[40:43], v[48:51], v[64:79]
    ds_read_b128 v[80:83], v31 offset:0
    s_add_u32 m0, s76, 45056
    s_add_u32 s7, s69, s78
    buffer_load_dwordx4 v6, s[56:59], s7 offen lds
    s_add_u32 s78, s78, 128
    s_cmp_eq_u32 s78, 1152
    s_cselect_b32 s78, 0, s78
    s_waitcnt lgkmcnt(2)
    v_mfma_f32_32x32x16_bf16 v[96:111], v[40:43], v[52:55], v[96:111]
    ds_read_b128 v[84:87], v31 offset:4096
    s_waitcnt lgkmcnt(2)
    v_mfma_f32_32x32x16_bf16 v[112:127], v[40:43], v[56:59], v[112:127]
    ds_read_b128 v[88:91], v31 offset:8192
    v_add_u32 v62, 4294950912, v62
    v_add_u32 v30, 4294942720, v30
    s_waitcnt lgkmcnt(2)
    v_mfma_f32_32x32x16_bf16 v[64:79], v[44:47], v[80:83], v[64:79]
    v_add_u32 v63, 4294950912, v63
    s_waitcnt lgkmcnt(1)
    v_mfma_f32_32x32x16_bf16 v[96:111], v[44:47], v[84:87], v[96:111]
    v_add_u32 v31, 4294942720, v31
    s_waitcnt lgkmcnt(0)
    v_mfma_f32_32x32x16_bf16 v[112:127], v[44:47], v[88:91], v[112:127]
    s_waitcnt vmcnt(1)
    s_barrier
    ds_read_b128 v[32:35], v60
    ds_read_b128 v[36:39], v61
    ds_read_b128 v[40:43], v62
    ds_read_b128 v[44:47], v63
    ds_read_b128 v[48:51], v28 offset:0
    ds_read_b128 v[52:55], v28 offset:4096
    ds_read_b128 v[56:59], v28 offset:8192
    s_waitcnt lgkmcnt(2)
    v_mfma_f32_32x32x16_bf16 v[64:79], v[32:35], v[48:51], v[64:79]
    ds_read_b128 v[80:83], v29 offset:0
    s_waitcnt lgkmcnt(2)
    v_mfma_f32_32x32x16_bf16 v[96:111], v[32:35], v[52:55], v[96:111]
    ds_read_b128 v[84:87], v29 offset:4096
    s_waitcnt lgkmcnt(2)
    v_mfma_f32_32x32x16_bf16 v[112:127], v[32:35], v[56:59], v[112:127]
    ds_read_b128 v[88:91], v29 offset:8192
    s_waitcnt lgkmcnt(2)
    v_mfma_f32_32x32x16_bf16 v[64:79], v[36:39], v[80:83], v[64:79]
    ds_read_b128 v[48:51], v30 offset:0
    s_waitcnt lgkmcnt(2)
    v_mfma_f32_32x32x16_bf16 v[96:111], v[36:39], v[84:87], v[96:111]
    ds_read_b128 v[52:55], v30 offset:4096
    s_waitcnt lgkmcnt(2)
    v_mfma_f32_32x32x16_bf16 v[112:127], v[36:39], v[88:91], v[112:127]
    ds_read_b128 v[56:59], v30 offset:8192
    s_waitcnt vmcnt(0)
    s_barrier
    s_waitcnt lgkmcnt(2)
    v_mfma_f32_32x32x16_bf16 v[64:79], v[40:43], v[48:51], v[64:79]
    ds_read_b128 v[80:83], v31 offset:0
    s_waitcnt lgkmcnt(2)
    v_mfma_f32_32x32x16_bf16 v[96:111], v[40:43], v[52:55], v[96:111]
    ds_read_b128 v[84:87], v31 offset:4096
    s_waitcnt lgkmcnt(2)
    v_mfma_f32_32x32x16_bf16 v[112:127], v[40:43], v[56:59], v[112:127]
    ds_read_b128 v[88:91], v31 offset:8192
    s_waitcnt lgkmcnt(2)
    v_mfma_f32_32x32x16_bf16 v[64:79], v[44:47], v[80:83], v[64:79]
    s_waitcnt lgkmcnt(1)
    v_mfma_f32_32x32x16_bf16 v[96:111], v[44:47], v[84:87], v[96:111]
    s_waitcnt lgkmcnt(0)
    v_mfma_f32_32x32x16_bf16 v[112:127], v[44:47], v[88:91], v[112:127]
    s_setprio 3
    s_mul_i32 s6, s14, 12288
    v_lshl_add_u32 v7, v0, 4, s6
    s_nop 7
    s_barrier
    ds_write_b128 v7, v[112:115] offset:0
    ds_write_b128 v7, v[116:119] offset:1024
    ds_write_b128 v7, v[120:123] offset:2048
    ds_write_b128 v7, v[124:127] offset:3072
    s_waitcnt lgkmcnt(0)
    s_barrier
    ds_read_b128 v[80:83], v7 offset:4096
    ds_read_b128 v[84:87], v7 offset:5120
    ds_read_b128 v[88:91], v7 offset:6144
    ds_read_b128 v[92:95], v7 offset:7168
    ds_read_b128 v[112:115], v7 offset:8192
    ds_read_b128 v[116:119], v7 offset:9216
    ds_read_b128 v[120:123], v7 offset:10240
    ds_read_b128 v[124:127], v7 offset:11264
    s_branch S_g2
S_g1:
    s_waitcnt vmcnt(2)
    s_barrier
    s_add_u32 m0, s76, 16384
    s_add_u32 s7, s68, s78
    buffer_load_dwordx4 v6, s[48:51], s7 offen lds
    s_add_u32 m0, s76, 24576
    s_add_u32 s7, s72, s78
    buffer_load_dwordx4 v6, s[48:51], s7 offen lds
    s_add_u32 m0, s76, 57344
    s_add_u32 s7, s69, s78
    buffer_load_dwordx4 v6, s[52:55], s7 offen lds
    s_waitcnt vmcnt(3)
    s_barrier
    ds_read_b128 v[32:35], v60
    ds_read_b128 v[36:39], v61
    ds_read_b128 v[40:43], v62
    ds_read_b128 v[44:47], v63
    ds_read_b128 v[48:51], v28 offset:0
    ds_read_b128 v[52:55], v28 offset:4096
    ds_read_b128 v[56:59], v28 offset:8192
    s_waitcnt lgkmcnt(2)
    v_mfma_f32_32x32x16_bf16 v[96:111], v[32:35], v[48:51], 0
    ds_read_b128 v[64:67], v29 offset:0
    s_add_u32 m0, s76, 69632
    s_add_u32 s7, s69, s78
    buffer_load_dwordx4 v6, s[56:59], s7 offen lds
    s_waitcnt lgkmcnt(2)
    v_mfma_f32_32x32x16_bf16 v[112:127], v[32:35], v[52:55], 0
    ds_read_b128 v[68:71], v29 offset:4096
    s_add_u32 m0, s77, 77824
    s_add_u32 s7, s70, s78
    buffer_load_dwordx4 v6, s[56:59], s7 offen lds
    s_add_u32 s78, s78, 128
    s_cmp_eq_u32 s78, 1152
    s_cselect_b32 s78, 0, s78
    s_waitcnt lgkmcnt(2)
    v_mfma_f32_32x32x16_bf16 v[80:95], v[32:35], v[56:59], 0
    ds_read_b128 v[72:75], v29 offset:8192
    v_add_u32 v60, 16384, v60
    v_add_u32 v28, 24576, v28
    s_waitcnt lgkmcnt(2)
    v_mfma_f32_32x32x16_bf16 v[96:111], v[36:39], v[64:67], v[96:111]
    ds_read_b128 v[48:51], v30 offset:0
    s_waitcnt lgkmcnt(2)
    v_mfma_f32_32x32x16_bf16 v[112:127], v[36:39], v[68:71], v[112:127]
    ds_read_b128 v[52:55], v30 offset:4096
    s_waitcnt lgkmcnt(2)
    v_mfma_f32_32x32x16_bf16 v[80:95], v[36:39], v[72:75], v[80:95]
    ds_read_b128 v[56:59], v30 offset:8192
    v_add_u32 v61, 16384, v61
    v_add_u32 v29, 24576, v29
    s_waitcnt vmcnt(2)
    s_barrier
    s_waitcnt lgkmcnt(2)
    v_mfma_f32_32x32x16_bf16 v[96:111], v[40:43], v[48:51], v[96:111]
    ds_read_b128 v[64:67], v31 offset:0
    s_add_u32 m0, s76, 0
    s_add_u32 s7, s68, s78
    buffer_load_dwordx4 v6, s[48:51], s7 offen lds
    s_waitcnt lgkmcnt(2)
    v_mfma_f32_32x32x16_bf16 v[112:127], v[40:43], v[52:55], v[112:127]
    ds_read_b128 v[68:71], v31 offset:4096
    s_add_u32 m0, s76, 8192
    s_add_u32 s7, s72, s78
    buffer_load_dwordx4 v6, s[48:51], s7 offen lds
    s_waitcnt lgkmcnt(2)
    v_mfma_f32_32x32x16_bf16 v[80:95], v[40:43], v[56:59], v[80:95]
    ds_read_b128 v[72:75], v31 offset:8192
    s_add_u32 m0, s76, 32768
    s_add_u32 s7, s69, s78
    buffer_load_dwordx4 v6, s[52:55], s7 offen lds
    v_add_u32 v62, 16384, v62
    v_add_u32 v30, 24576, v30
    s_waitcnt lgkmcnt(2)
    v_mfma_f32_32x32x16_bf16 v[96:111], v[44:47], v[64:67], v[96:111]
    v_add_u32 v63, 16384, v63
    s_waitcnt lgkmcnt(1)
    v_mfma_f32_32x32x16_bf16 v[112:127], v[44:47], v[68:71], v[112:127]
    v_add_u32 v31, 24576, v31
    s_waitcnt lgkmcnt(0)
    v_mfma_f32_32x32x16_bf16 v[80:95], v[44:47], v[72:75], v[80:95]
    s_waitcnt vmcnt(3)
    s_barrier
    ds_read_b128 v[32:35], v60
    ds_read_b128 v[36:39], v61
    ds_read_b128 v[40:43], v62
    ds_read_b128 v[44:47], v63
    ds_read_b128 v[48:51], v28 offset:0
    ds_read_b128 v[52:55], v28 offset:4096
    ds_read_b128 v[56:59], v28 offset:8192
    s_waitcnt lgkmcnt(2)
    v_mfma_f32_32x32x16_bf16 v[96:111], v[32:35], v[48:51], v[96:111]
    ds_read_b128 v[64:67], v29 offset:0
    s_add_u32 m0, s76, 45056
    s_add_u32 s7, s69, s78
    buffer_load_dwordx4 v6, s[56:59], s7 offen lds
    s_waitcnt lgkmcnt(2)
    v_mfma_f32_32x32x16_bf16 v[112:127], v[32:35], v[52:55], v[112:127]
    ds_read_b128 v[68:71], v29 offset:4096
    s_add_u32 m0, s77, 53248
    s_add_u32 s7, s70, s78
    buffer_load_dwordx4 v6, s[56:59], s7 offen lds
    s_add_u32 s78, s78, 128
    s_cmp_eq_u32 s78, 1152
    s_cselect_b32 s78, 0, s78
    s_waitcnt lgkmcnt(2)
    v_mfma_f32_32x32x16_bf16 v[80:95], v[32:35], v[56:59], v[80:95]
    ds_read_b128 v[72:75], v29 offset:8192
    v_add_u32 v60, 4294950912, v60
    v_add_u32 v28, 4294942720, v28
    s_waitcnt lgkmcnt(2)
    v_mfma_f32_32x32x16_bf16 v[96:111], v[36:39], v[64:67], v[96:111]
    ds_read_b128 v[48:51], v30 offset:0
    s_waitcnt lgkmcnt(2)
    v_mfma_f32_32x32x16_bf16 v[112:127], v[36:39], v[68:71], v[112:127]
    ds_read_b128 v[52:55], v30 offset:4096
    s_waitcnt lgkmcnt(2)
    v_mfma_f32_32x32x16_bf16 v[80:95], v[36:39], v[72:75], v[80:95]
    ds_read_b128 v[56:59], v30 offset:8192
    v_add_u32 v61, 4294950912, v61
    v_add_u32 v29, 4294942720, v29
    s_waitcnt vmcnt(2)
    s_barrier
    s_waitcnt lgkmcnt(2)
    v_mfma_f32_32x32x16_bf16 v[96:111], v[40:43], v[48:51], v[96:111]
    ds_read_b128 v[64:67], v31 offset:0
    s_add_u32 m0, s76, 16384
    s_add_u32 s7, s68, s78
    buffer_load_dwordx4 v6, s[48:51], s7 offen lds
    s_waitcnt lgkmcnt(2)
    v_mfma_f32_32x32x16_bf16 v[112:127], v[40:43], v[52:55], v[112:127]
    ds_read_b128 v[68:71], v31 offset:4096
    s_add_u32 m0, s76, 24576
    s_add_u32 s7, s72, s78
    buffer_load_dwordx4 v6, s[48:51], s7 offen lds
    s_waitcnt lgkmcnt(2)
    v_mfma_f32_32x32x16_bf16 v[80:95], v[40:43], v[56:59], v[80:95]
    ds_read_b128 v[72:75], v31 offset:8192
    s_add_u32 m0, s76, 57344
    s_add_u32 s7, s69, s78
    buffer_load_dwordx4 v6, s[52:55], s7 offen lds
    v_add_u32 v62, 4294950912, v62
    v_add_u32 v30, 4294942720, v30
    s_waitcnt lgkmcnt(2)
    v_mfma_f32_32x32x16_bf16 v[96:111], v[44:47], v[64:67], v[96:111]
    v_add_u32 v63, 4294950912, v63
    s_waitcnt lgkmcnt(1)
    v_mfma_f32_32x32x16_bf16 v[112:127], v[44:47], v[68:71], v[112:127]
    v_add_u32 v31, 4294942720, v31
    s_waitcnt lgkmcnt(0)
    v_mfma_f32_32x32x16_bf16 v[80:95], v[44:47], v[72:75], v[80:95]
    s_waitcnt vmcnt(3)
    s_barrier
    ds_read_b128 v[32:35], v60
    ds_read_b128 v[36:39], v61
    ds_read_b128 v[40:43], v62
    ds_read_b128 v[44:47], v63
    ds_read_b128 v[48:51], v28 offset:0
    ds_read_b128 v[52:55], v28 offset:4096
    ds_read_b128 v[56:59], v28 offset:8192
    s_waitcnt lgkmcnt(2)
    v_mfma_f32_32x32x16_bf16 v[96:111], v[32:35], v[48:51], v[96:111]
    ds_read_b128 v[64:67], v29 offset:0
    s_add_u32 m0, s76, 69632
    s_add_u32 s7, s69, s78
    buffer_load_dwordx4 v6, s[56:59], s7 offen lds
    s_waitcnt lgkmcnt(2)
    v_mfma_f32_32x32x16_bf16 v[112:127], v[32:35], v[52:55], v[112:127]
    ds_read_b128 v[68:71], v29 offset:4096
    s_add_u32 m0, s77, 77824
    s_add_u32 s7, s70, s78
    buffer_load_dwordx4 v6, s[56:59], s7 offen lds
    s_add_u32 s78, s78, 128
    s_cmp_eq_u32 s78, 1152
    s_cselect_b32 s78, 0, s78
    s_waitcnt lgkmcnt(2)
    v_mfma_f32_32x32x16_bf16 v[80:95], v[32:35], v[56:59], v[80:95]
    ds_read_b128 v[72:75], v29 offset:8192
    v_add_u32 v60, 16384, v60
    v_add_u32 v28, 24576, v28
    s_waitcnt lgkmcnt(2)
    v_mfma_f32_32x32x16_bf16 v[96:111], v[36:39], v[64:67], v[96:111]
    ds_read_b128 v[48:51], v30 offset:0
    s_waitcnt lgkmcnt(2)
    v_mfma_f32_32x32x16_bf16 v[112:127], v[36:39], v[68:71], v[112:127]
    ds_read_b128 v[52:55], v30 offset:4096
    s_waitcnt lgkmcnt(2)
    v_mfma_f32_32x32x16_bf16 v[80:95], v[36:39], v[72:75], v[80:95]
    ds_read_b128 v[56:59], v30 offset:8192
    v_add_u32 v61, 16384, v61
    v_add_u32 v29, 24576, v29
    s_waitcnt vmcnt(2)
    s_barrier
    s_waitcnt lgkmcnt(2)
    v_mfma_f32_32x32x16_bf16 v[96:111], v[40:43], v[48:51], v[96:111]
    ds_read_b128 v[64:67], v31 offset:0
    s_add_u32 m0, s76, 0
    s_add_u32 s7, s68, s78
    buffer_load_dwordx4 v6, s[48:51], s7 offen lds
    s_waitcnt lgkmcnt(2)
    v_mfma_f32_32x32x16_bf16 v[112:127], v[40:43], v[52:55], v[112:127]
    ds_read_b128 v[68:71], v31 offset:4096
    s_add_u32 m0, s76, 8192
    s_add_u32 s7, s72, s78
    buffer_load_dwordx4 v6, s[48:51], s7 offen lds
    s_waitcnt lgkmcnt(2)
    v_mfma_f32_32x32x16_bf16 v[80:95], v[40:43], v[56:59], v[80:95]
    ds_read_b128 v[72:75], v31 offset:8192
    s_add_u32 m0, s76, 32768
    s_add_u32 s7, s69, s78
    buffer_load_dwordx4 v6, s[52:55], s7 offen lds
    v_add_u32 v62, 16384, v62
    v_add_u32 v30, 24576, v30
    s_waitcnt lgkmcnt(2)
    v_mfma_f32_32x32x16_bf16 v[96:111], v[44:47], v[64:67], v[96:111]
    v_add_u32 v63, 16384, v63
    s_waitcnt lgkmcnt(1)
    v_mfma_f32_32x32x16_bf16 v[112:127], v[44:47], v[68:71], v[112:127]
    v_add_u32 v31, 24576, v31
    s_waitcnt lgkmcnt(0)
    v_mfma_f32_32x32x16_bf16 v[80:95], v[44:47], v[72:75], v[80:95]
    s_waitcnt vmcnt(3)
    s_barrier
    ds_read_b128 v[32:35], v60
    ds_read_b128 v[36:39], v61
    ds_read_b128 v[40:43], v62
    ds_read_b128 v[44:47], v63
    ds_read_b128 v[48:51], v28 offset:0
    ds_read_b128 v[52:55], v28 offset:4096
    ds_read_b128 v[56:59], v28 offset:8192
    s_waitcnt lgkmcnt(2)
    v_mfma_f32_32x32x16_bf16 v[96:111], v[32:35], v[48:51], v[96:111]
    ds_read_b128 v[64:67], v29 offset:0
    s_add_u32 m0, s76, 45056
    s_add_u32 s7, s69, s78
    buffer_load_dwordx4 v6, s[56:59], s7 offen lds
    s_waitcnt lgkmcnt(2)
    v_mfma_f32_32x32x16_bf16 v[112:127], v[32:35], v[52:55], v[112:127]
    ds_read_b128 v[68:71], v29 offset:4096
    s_add_u32 m0, s77, 53248
    s_add_u32 s7, s70, s78
    buffer_load_dwordx4 v6, s[56:59], s7 offen lds
    s_add_u32 s78, s78, 128
    s_cmp_eq_u32 s78, 1152
    s_cselect_b32 s78, 0, s78
    s_waitcnt lgkmcnt(2)
    v_mfma_f32_32x32x16_bf16 v[80:95], v[32:35], v[56:59], v[80:95]
    ds_read_b128 v[72:75], v29 offset:8192
    v_add_u32 v60, 4294950912, v60
    v_add_u32 v28, 4294942720, v28
    s_waitcnt lgkmcnt(2)
    v_mfma_f32_32x32x16_bf16 v[96:111], v[36:39], v[64:67], v[96:111]
    ds_read_b128 v[48:51], v30 offset:0
    s_waitcnt lgkmcnt(2)
    v_mfma_f32_32x32x16_bf16 v[112:127], v[36:39], v[68:71], v[112:127]
    ds_read_b128 v[52:55], v30 offset:4096
    s_waitcnt lgkmcnt(2)
    v_mfma_f32_32x32x16_bf16 v[80:95], v[36:39], v[72:75], v[80:95]
    ds_read_b128 v[56:59], v30 offset:8192
    v_add_u32 v61, 4294950912, v61
    v_add_u32 v29, 4294942720, v29
    s_waitcnt vmcnt(2)
    s_barrier
    s_waitcnt lgkmcnt(2)
    v_mfma_f32_32x32x16_bf16 v[96:111], v[40:43], v[48:51], v[96:111]
    ds_read_b128 v[64:67], v31 offset:0
    s_add_u32 m0, s76, 16384
    s_add_u32 s7, s68, s78
    buffer_load_dwordx4 v6, s[48:51], s7 offen lds
    s_waitcnt lgkmcnt(2)
    v_mfma_f32_32x32x16_bf16 v[112:127], v[40:43], v[52:55], v[112:127]
    ds_read_b128 v[68:71], v31 offset:4096
    s_add_u32 m0, s76, 24576
    s_add_u32 s7, s72, s78
    buffer_load_dwordx4 v6, s[48:51], s7 offen lds
    s_waitcnt lgkmcnt(2)
    v_mfma_f32_32x32x16_bf16 v[80:95], v[40:43], v[56:59], v[80:95]
    ds_read_b128 v[72:75], v31 offset:8192
    s_add_u32 m0, s76, 57344
    s_add_u32 s7, s69, s78
    buffer_load_dwordx4 v6, s[52:55], s7 offen lds
    v_add_u32 v62, 4294950912, v62
    v_add_u32 v30, 4294942720, v30
    s_waitcnt lgkmcnt(2)
    v_mfma_f32_32x32x16_bf16 v[96:111], v[44:47], v[64:67], v[96:111]
    v_add_u32 v63, 4294950912, v63
    s_waitcnt lgkmcnt(1)
    v_mfma_f32_32x32x16_bf16 v[112:127], v[44:47], v[68:71], v[112:127]
    v_add_u32 v31, 4294942720, v31
    s_waitcnt lgkmcnt(0)
    v_mfma_f32_32x32x16_bf16 v[80:95], v[44:47], v[72:75], v[80:95]
    s_waitcnt vmcnt(3)
    s_barrier
    ds_read_b128 v[32:35], v60
    ds_read_b128 v[36:39], v61
    ds_read_b128 v[40:43], v62
    ds_read_b128 v[44:47], v63
    ds_read_b128 v[48:51], v28 offset:0
    ds_read_b128 v[52:55], v28 offset:4096
    ds_read_b128 v[56:59], v28 offset:8192
    s_waitcnt lgkmcnt(2)
    v_mfma_f32_32x32x16_bf16 v[96:111], v[32:35], v[48:51], v[96:111]
    ds_read_b128 v[64:67], v29 offset:0
    s_add_u32 m0, s76, 69632
    s_add_u32 s7, s69, s78
    buffer_load_dwordx4 v6, s[56:59], s7 offen lds
    s_waitcnt lgkmcnt(2)
    v_mfma_f32_32x32x16_bf16 v[112:127], v[32:35], v[52:55], v[112:127]
    ds_read_b128 v[68:71], v29 offset:4096
    s_add_u32 m0, s77, 77824
    s_add_u32 s7, s70, s78
    buffer_load_dwordx4 v6, s[56:59], s7 offen lds
    s_add_u32 s78, s78, 128
    s_cmp_eq_u32 s78, 1152
    s_cselect_b32 s78, 0, s78
    s_waitcnt lgkmcnt(2)
    v_mfma_f32_32x32x16_bf16 v[80:95], v[32:35], v[56:59], v[80:95]
    ds_read_b128 v[72:75], v29 offset:8192
    v_add_u32 v60, 16384, v60
    v_add_u32 v28, 24576, v28
    s_waitcnt lgkmcnt(2)
    v_mfma_f32_32x32x16_bf16 v[96:111], v[36:39], v[64:67], v[96:111]
    ds_read_b128 v[48:51], v30 offset:0
    s_waitcnt lgkmcnt(2)
    v_mfma_f32_32x32x16_bf16 v[112:127], v[36:39], v[68:71], v[112:127]
    ds_read_b128 v[52:55], v30 offset:4096
    s_waitcnt lgkmcnt(2)
    v_mfma_f32_32x32x16_bf16 v[80:95], v[36:39], v[72:75], v[80:95]
    ds_read_b128 v[56:59], v30 offset:8192
    v_add_u32 v61, 16384, v61
    v_add_u32 v29, 24576, v29
    s_waitcnt vmcnt(2)
    s_barrier
    s_waitcnt lgkmcnt(2)
    v_mfma_f32_32x32x16_bf16 v[96:111], v[40:43], v[48:51], v[96:111]
    ds_read_b128 v[64:67], v31 offset:0
    s_add_u32 m0, s76, 0
    s_add_u32 s7, s68, s78
    buffer_load_dwordx4 v6, s[48:51], s7 offen lds
    s_waitcnt lgkmcnt(2)
    v_mfma_f32_32x32x16_bf16 v[112:127], v[40:43], v[52:55], v[112:127]
    ds_read_b128 v[68:71], v31 offset:4096
    s_add_u32 m0, s76, 8192
    s_add_u32 s7, s72, s78
    buffer_load_dwordx4 v6, s[48:51], s7 offen lds
    s_waitcnt lgkmcnt(2)
    v_mfma_f32_32x32x16_bf16 v[80:95], v[40:43], v[56:59], v[80:95]
    ds_read_b128 v[72:75], v31 offset:8192
    s_add_u32 m0, s76, 32768
    s_add_u32 s7, s69, s78
    buffer_load_dwordx4 v6, s[52:55], s7 offen lds
    v_add_u32 v62, 16384, v62
    v_add_u32 v30, 24576, v30
    s_waitcnt lgkmcnt(2)
    v_mfma_f32_32x32x16_bf16 v[96:111], v[44:47], v[64:67], v[96:111]
    v_add_u32 v63, 16384, v63
    s_waitcnt lgkmcnt(1)
    v_mfma_f32_32x32x16_bf16 v[112:127], v[44:47], v[68:71], v[112:127]
    v_add_u32 v31, 24576, v31
    s_waitcnt lgkmcnt(0)
    v_mfma_f32_32x32x16_bf16 v[80:95], v[44:47], v[72:75], v[80:95]
    s_waitcnt vmcnt(3)
    s_barrier
    ds_read_b128 v[32:35], v60
    ds_read_b128 v[36:39], v61
    ds_read_b128 v[40:43], v62
    ds_read_b128 v[44:47], v63
    ds_read_b128 v[48:51], v28 offset:0
    ds_read_b128 v[52:55], v28 offset:4096
    ds_read_b128 v[56:59], v28 offset:8192
    s_waitcnt lgkmcnt(2)
    v_mfma_f32_32x32x16_bf16 v[96:111], v[32:35], v[48:51], v[96:111]
    ds_read_b128 v[64:67], v29 offset:0
    s_add_u32 m0, s76, 45056
    s_add_u32 s7, s69, s78
    buffer_load_dwordx4 v6, s[56:59], s7 offen lds
    s_waitcnt lgkmcnt(2)
    v_mfma_f32_32x32x16_bf16 v[112:127], v[32:35], v[52:55], v[112:127]
    ds_read_b128 v[68:71], v29 offset:4096
    s_add_u32 m0, s77, 53248
    s_add_u32 s7, s70, s78
    buffer_load_dwordx4 v6, s[56:59], s7 offen lds
    s_add_u32 s78, s78, 128
    s_cmp_eq_u32 s78, 1152
    s_cselect_b32 s78, 0, s78
    s_waitcnt lgkmcnt(2)
    v_mfma_f32_32x32x16_bf16 v[80:95], v[32:35], v[56:59], v[80:95]
    ds_read_b128 v[72:75], v29 offset:8192
    v_add_u32 v60, 4294950912, v60
    v_add_u32 v28, 4294942720, v28
    s_waitcnt lgkmcnt(2)
    v_mfma_f32_32x32x16_bf16 v[96:111], v[36:39], v[64:67], v[96:111]
    ds_read_b128 v[48:51], v30 offset:0
    s_waitcnt lgkmcnt(2)
    v_mfma_f32_32x32x16_bf16 v[112:127], v[36:39], v[68:71], v[112:127]
    ds_read_b128 v[52:55], v30 offset:4096
    s_waitcnt lgkmcnt(2)
    v_mfma_f32_32x32x16_bf16 v[80:95], v[36:39], v[72:75], v[80:95]
    ds_read_b128 v[56:59], v30 offset:8192
    v_add_u32 v61, 4294950912, v61
    v_add_u32 v29, 4294942720, v29
    s_waitcnt vmcnt(2)
    s_barrier
    s_waitcnt lgkmcnt(2)
    v_mfma_f32_32x32x16_bf16 v[96:111], v[40:43], v[48:51], v[96:111]
    ds_read_b128 v[64:67], v31 offset:0
    s_add_u32 m0, s76, 16384
    s_add_u32 s7, s68, s78
    buffer_load_dwordx4 v6, s[48:51], s7 offen lds
    s_waitcnt lgkmcnt(2)
    v_mfma_f32_32x32x16_bf16 v[112:127], v[40:43], v[52:55], v[112:127]
    ds_read_b128 v[68:71], v31 offset:4096
    s_add_u32 m0, s76, 24576
    s_add_u32 s7, s72, s78
    buffer_load_dwordx4 v6, s[48:51], s7 offen lds
    s_waitcnt lgkmcnt(2)
    v_mfma_f32_32x32x16_bf16 v[80:95], v[40:43], v[56:59], v[80:95]
    ds_read_b128 v[72:75], v31 offset:8192
    s_add_u32 m0, s76, 57344
    s_add_u32 s7, s69, s78
    buffer_load_dwordx4 v6, s[52:55], s7 offen lds
    v_add_u32 v62, 4294950912, v62
    v_add_u32 v30, 4294942720, v30
    s_waitcnt lgkmcnt(2)
    v_mfma_f32_32x32x16_bf16 v[96:111], v[44:47], v[64:67], v[96:111]
    v_add_u32 v63, 4294950912, v63
    s_waitcnt lgkmcnt(1)
    v_mfma_f32_32x32x16_bf16 v[112:127], v[44:47], v[68:71], v[112:127]
    v_add_u32 v31, 4294942720, v31
    s_waitcnt lgkmcnt(0)
    v_mfma_f32_32x32x16_bf16 v[80:95], v[44:47], v[72:75], v[80:95]
    s_waitcnt vmcnt(3)
    s_barrier
    ds_read_b128 v[32:35], v60
    ds_read_b128 v[36:39], v61
    ds_read_b128 v[40:43], v62
    ds_read_b128 v[44:47], v63
    ds_read_b128 v[48:51], v28 offset:0
    ds_read_b128 v[52:55], v28 offset:4096
    ds_read_b128 v[56:59], v28 offset:8192
    s_waitcnt lgkmcnt(2)
    v_mfma_f32_32x32x16_bf16 v[96:111], v[32:35], v[48:51], v[96:111]
    ds_read_b128 v[64:67], v29 offset:0
    s_add_u32 m0, s76, 69632
    s_add_u32 s7, s69, s78
    buffer_load_dwordx4 v6, s[56:59], s7 offen lds
    s_waitcnt lgkmcnt(2)
    v_mfma_f32_32x32x16_bf16 v[112:127], v[32:35], v[52:55], v[112:127]
    ds_read_b128 v[68:71], v29 offset:4096
    s_add_u32 m0, s77, 77824
    s_add_u32 s7, s70, s78
    buffer_load_dwordx4 v6, s[56:59], s7 offen lds
    s_add_u32 s78, s78, 128
    s_cmp_eq_u32 s78, 1152
    s_cselect_b32 s78, 0, s78
    s_waitcnt lgkmcnt(2)
    v_mfma_f32_32x32x16_bf16 v[80:95], v[32:35], v[56:59], v[80:95]
    ds_read_b128 v[72:75], v29 offset:8192
    v_add_u32 v60, 16384, v60
    v_add_u32 v28, 24576, v28
    s_waitcnt lgkmcnt(2)
    v_mfma_f32_32x32x16_bf16 v[96:111], v[36:39], v[64:67], v[96:111]
    ds_read_b128 v[48:51], v30 offset:0
    s_waitcnt lgkmcnt(2)
    v_mfma_f32_32x32x16_bf16 v[112:127], v[36:39], v[68:71], v[112:127]
    ds_read_b128 v[52:55], v30 offset:4096
    s_waitcnt lgkmcnt(2)
    v_mfma_f32_32x32x16_bf16 v[80:95], v[36:39], v[72:75], v[80:95]
    ds_read_b128 v[56:59], v30 offset:8192
    v_add_u32 v61, 16384, v61
    v_add_u32 v29, 24576, v29
    s_waitcnt vmcnt(2)
    s_barrier
    s_waitcnt lgkmcnt(2)
    v_mfma_f32_32x32x16_bf16 v[96:111], v[40:43], v[48:51], v[96:111]
    ds_read_b128 v[64:67], v31 offset:0
    s_add_u32 m0, s76, 0
    s_add_u32 s7, s68, s78
    buffer_load_dwordx4 v6, s[48:51], s7 offen lds
    s_waitcnt lgkmcnt(2)
    v_mfma_f32_32x32x16_bf16 v[112:127], v[40:43], v[52:55], v[112:127]
    ds_read_b128 v[68:71], v31 offset:4096
    s_add_u32 m0, s76, 8192
    s_add_u32 s7, s72, s78
    buffer_load_dwordx4 v6, s[48:51], s7 offen lds
    s_waitcnt lgkmcnt(2)
    v_mfma_f32_32x32x16_bf16 v[80:95], v[40:43], v[56:59], v[80:95]
    ds_read_b128 v[72:75], v31 offset:8192
    s_add_u32 m0, s76, 32768
    s_add_u32 s7, s69, s78
    buffer_load_dwordx4 v6, s[52:55], s7 offen lds
    v_add_u32 v62, 16384, v62
    v_add_u32 v30, 24576, v30
    s_waitcnt lgkmcnt(2)
    v_mfma_f32_32x32x16_bf16 v[96:111], v[44:47], v[64:67], v[96:111]
    v_add_u32 v63, 16384, v63
    s_waitcnt lgkmcnt(1)
    v_mfma_f32_32x32x16_bf16 v[112:127], v[44:47], v[68:71], v[112:127]
    v_add_u32 v31, 24576, v31
    s_waitcnt lgkmcnt(0)
    v_mfma_f32_32x32x16_bf16 v[80:95], v[44:47], v[72:75], v[80:95]
    s_waitcnt vmcnt(3)
    s_barrier
    ds_read_b128 v[32:35], v60
    ds_read_b128 v[36:39], v61
    ds_read_b128 v[40:43], v62
    ds_read_b128 v[44:47], v63
    ds_read_b128 v[48:51], v28 offset:0
    ds_read_b128 v[52:55], v28 offset:4096
    ds_read_b128 v[56:59], v28 offset:8192
    s_waitcnt lgkmcnt(2)
    v_mfma_f32_32x32x16_bf16 v[96:111], v[32:35], v[48:51], v[96:111]
    ds_read_b128 v[64:67], v29 offset:0
    s_add_u32 m0, s76, 45056
    s_add_u32 s7, s69, s78
    buffer_load_dwordx4 v6, s[56:59], s7 offen lds
    s_waitcnt lgkmcnt(2)
    v_mfma_f32_32x32x16_bf16 v[112:127], v[32:35], v[52:55], v[112:127]
    ds_read_b128 v[68:71], v29 offset:4096
    s_add_u32 m0, s77, 53248
    s_add_u32 s7, s70, s78
    buffer_load_dwordx4 v6, s[56:59], s7 offen lds
    s_add_u32 s78, s78, 128
    s_cmp_eq_u32 s78, 1152
    s_cselect_b32 s78, 0, s78
    s_waitcnt lgkmcnt(2)
    v_mfma_f32_32x32x16_bf16 v[80:95], v[32:35], v[56:59], v[80:95]
    ds_read_b128 v[72:75], v29 offset:8192
    v_add_u32 v60, 4294950912, v60
    v_add_u32 v28, 4294942720, v28
    s_waitcnt lgkmcnt(2)
    v_mfma_f32_32x32x16_bf16 v[96:111], v[36:39], v[64:67], v[96:111]
    ds_read_b128 v[48:51], v30 offset:0
    s_waitcnt lgkmcnt(2)
    v_mfma_f32_32x32x16_bf16 v[112:127], v[36:39], v[68:71], v[112:127]
    ds_read_b128 v[52:55], v30 offset:4096
    s_waitcnt lgkmcnt(2)
    v_mfma_f32_32x32x16_bf16 v[80:95], v[36:39], v[72:75], v[80:95]
    ds_read_b128 v[56:59], v30 offset:8192
    v_add_u32 v61, 4294950912, v61
    v_add_u32 v29, 4294942720, v29
    s_waitcnt vmcnt(2)
    s_barrier
    s_waitcnt lgkmcnt(2)
    v_mfma_f32_32x32x16_bf16 v[96:111], v[40:43], v[48:51], v[96:111]
    ds_read_b128 v[64:67], v31 offset:0
    s_waitcnt lgkmcnt(2)
    v_mfma_f32_32x32x16_bf16 v[112:127], v[40:43], v[52:55], v[112:127]
    ds_read_b128 v[68:71], v31 offset:4096
    s_waitcnt lgkmcnt(2)
    v_mfma_f32_32x32x16_bf16 v[80:95], v[40:43], v[56:59], v[80:95]
    ds_read_b128 v[72:75], v31 offset:8192
    v_add_u32 v62, 4294950912, v62
    v_add_u32 v30, 4294942720, v30
    s_waitcnt lgkmcnt(2)
    v_mfma_f32_32x32x16_bf16 v[96:111], v[44:47], v[64:67], v[96:111]
    v_add_u32 v63, 4294950912, v63
    s_waitcnt lgkmcnt(1)
    v_mfma_f32_32x32x16_bf16 v[112:127], v[44:47], v[68:71], v[112:127]
    v_add_u32 v31, 4294942720, v31
    s_waitcnt lgkmcnt(0)
    v_mfma_f32_32x32x16_bf16 v[80:95], v[44:47], v[72:75], v[80:95]
    s_waitcnt vmcnt(0)
    s_barrier
    ds_read_b128 v[32:35], v60
    ds_read_b128 v[36:39], v61
    ds_read_b128 v[40:43], v62
    ds_read_b128 v[44:47], v63
    ds_read_b128 v[48:51], v28 offset:0
    ds_read_b128 v[52:55], v28 offset:4096
    ds_read_b128 v[56:59], v28 offset:8192
    s_waitcnt lgkmcnt(2)
    v_mfma_f32_32x32x16_bf16 v[96:111], v[32:35], v[48:51], v[96:111]
    ds_read_b128 v[64:67], v29 offset:0
    s_waitcnt lgkmcnt(2)
    v_mfma_f32_32x32x16_bf16 v[112:127], v[32:35], v[52:55], v[112:127]
    ds_read_b128 v[68:71], v29 offset:4096
    s_waitcnt lgkmcnt(2)
    v_mfma_f32_32x32x16_bf16 v[80:95], v[32:35], v[56:59], v[80:95]
    ds_read_b128 v[72:75], v29 offset:8192
    s_waitcnt lgkmcnt(2)
    v_mfma_f32_32x32x16_bf16 v[96:111], v[36:39], v[64:67], v[96:111]
    ds_read_b128 v[48:51], v30 offset:0
    s_waitcnt lgkmcnt(2)
    v_mfma_f32_32x32x16_bf16 v[112:127], v[36:39], v[68:71], v[112:127]
    ds_read_b128 v[52:55], v30 offset:4096
    s_waitcnt lgkmcnt(2)
    v_mfma_f32_32x32x16_bf16 v[80:95], v[36:39], v[72:75], v[80:95]
    ds_read_b128 v[56:59], v30 offset:8192
    s_waitcnt lgkmcnt(2)
    v_mfma_f32_32x32x16_bf16 v[96:111], v[40:43], v[48:51], v[96:111]
    ds_read_b128 v[64:67], v31 offset:0
    s_waitcnt lgkmcnt(2)
    v_mfma_f32_32x32x16_bf16 v[112:127], v[40:43], v[52:55], v[112:127]
    ds_read_b128 v[68:71], v31 offset:4096
    s_waitcnt lgkmcnt(2)
    v_mfma_f32_32x32x16_bf16 v[80:95], v[40:43], v[56:59], v[80:95]
    ds_read_b128 v[72:75], v31 offset:8192
    s_waitcnt lgkmcnt(2)
    v_mfma_f32_32x32x16_bf16 v[96:111], v[44:47], v[64:67], v[96:111]
    s_waitcnt lgkmcnt(1)
    v_mfma_f32_32x32x16_bf16 v[112:127], v[44:47], v[68:71], v[112:127]
    s_waitcnt lgkmcnt(0)
    v_mfma_f32_32x32x16_bf16 v[80:95], v[44:47], v[72:75], v[80:95]
    s_setprio 3
    s_mul_i32 s6, s14, 12288
    v_lshl_add_u32 v7, v0, 4, s6
    s_nop 7
    s_barrier
    ds_write_b128 v7, v[96:99] offset:4096
    ds_write_b128 v7, v[100:103] offset:5120
    ds_write_b128 v7, v[104:107] offset:6144
    ds_write_b128 v7, v[108:111] offset:7168
    ds_write_b128 v7, v[112:115] offset:8192
    ds_write_b128 v7, v[116:119] offset:9216
    ds_write_b128 v7, v[120:123] offset:10240
    ds_write_b128 v7, v[124:127] offset:11264
    s_waitcnt lgkmcnt(0)
    s_barrier
    ds_read_b128 v[64:67], v7 offset:0
    ds_read_b128 v[68:71], v7 offset:1024
    ds_read_b128 v[72:75], v7 offset:2048
    ds_read_b128 v[76:79], v7 offset:3072
S_g2:
    v_lshlrev_b32 v3, 3, v1
    s_lshl_b32 s6, s71, 11
    s_add_u32 s6, s6, 49152
    v_add_u32 v4, s6, v3
    s_lshl_b32 s6, s14, 8
    v_add_u32 v5, s6, v4
    s_waitcnt lgkmcnt(0)
    v_pk_fma_f32 v[32:33], v[8:9], v[64:65], v[66:67] op_sel:[0,0,0] op_sel_hi:[0,1,1]
    v_pk_fma_f32 v[34:35], v[8:9], v[80:81], v[82:83] op_sel:[0,0,0] op_sel_hi:[0,1,1]
    v_pk_fma_f32 v[32:33], v[8:9], v[80:81], v[32:33] op_sel:[1,0,0] op_sel_hi:[1,1,1] neg_lo:[1,0,0] neg_hi:[1,0,0]
    v_pk_fma_f32 v[34:35], v[8:9], v[64:65], v[34:35] op_sel:[1,0,0] op_sel_hi:[1,1,1]
    v_pk_fma_f32 v[48:49], v[8:9], v[32:33], v[68:69] op_sel:[0,0,0] op_sel_hi:[0,1,1]
    v_pk_fma_f32 v[50:51], v[8:9], v[34:35], v[84:85] op_sel:[0,0,0] op_sel_hi:[0,1,1]
    v_pk_fma_f32 v[48:49], v[8:9], v[34:35], v[48:49] op_sel:[1,0,0] op_sel_hi:[1,1,1] neg_lo:[1,0,0] neg_hi:[1,0,0]
    v_pk_fma_f32 v[50:51], v[8:9], v[32:33], v[50:51] op_sel:[1,0,0] op_sel_hi:[1,1,1]
    v_pk_fma_f32 v[32:33], v[8:9], v[48:49], v[70:71] op_sel:[0,0,0] op_sel_hi:[0,1,1]
    v_pk_fma_f32 v[34:35], v[8:9], v[50:51], v[86:87] op_sel:[0,0,0] op_sel_hi:[0,1,1]
    v_pk_fma_f32 v[32:33], v[8:9], v[50:51], v[32:33] op_sel:[1,0,0] op_sel_hi:[1,1,1] neg_lo:[1,0,0] neg_hi:[1,0,0]
    v_pk_fma_f32 v[34:35], v[8:9], v[48:49], v[34:35] op_sel:[1,0,0] op_sel_hi:[1,1,1]
    v_pk_fma_f32 v[48:49], v[8:9], v[32:33], v[72:73] op_sel:[0,0,0] op_sel_hi:[0,1,1]
    v_pk_fma_f32 v[50:51], v[8:9], v[34:35], v[88:89] op_sel:[0,0,0] op_sel_hi:[0,1,1]
    v_pk_fma_f32 v[48:49], v[8:9], v[34:35], v[48:49] op_sel:[1,0,0] op_sel_hi:[1,1,1] neg_lo:[1,0,0] neg_hi:[1,0,0]
    v_pk_fma_f32 v[50:51], v[8:9], v[32:33], v[50:51] op_sel:[1,0,0] op_sel_hi:[1,1,1]
    v_pk_fma_f32 v[32:33], v[8:9], v[48:49], v[74:75] op_sel:[0,0,0] op_sel_hi:[0,1,1]
    v_pk_fma_f32 v[34:35], v[8:9], v[50:51], v[90:91] op_sel:[0,0,0] op_sel_hi:[0,1,1]
    v_pk_fma_f32 v[32:33], v[8:9], v[50:51], v[32:33] op_sel:[1,0,0] op_sel_hi:[1,1,1] neg_lo:[1,0,0] neg_hi:[1,0,0]
    v_pk_fma_f32 v[34:35], v[8:9], v[48:49], v[34:35] op_sel:[1,0,0] op_sel_hi:[1,1,1]
    v_pk_fma_f32 v[48:49], v[8:9], v[32:33], v[76:77] op_sel:[0,0,0] op_sel_hi:[0,1,1]
    v_pk_fma_f32 v[50:51], v[8:9], v[34:35], v[92:93] op_sel:[0,0,0] op_sel_hi:[0,1,1]
    v_pk_fma_f32 v[48:49], v[8:9], v[34:35], v[48:49] op_sel:[1,0,0] op_sel_hi:[1,1,1] neg_lo:[1,0,0] neg_hi:[1,0,0]
    v_pk_fma_f32 v[50:51], v[8:9], v[32:33], v[50:51] op_sel:[1,0,0] op_sel_hi:[1,1,1]
    v_pk_fma_f32 v[32:33], v[8:9], v[48:49], v[78:79] op_sel:[0,0,0] op_sel_hi:[0,1,1]
    v_pk_fma_f32 v[34:35], v[8:9], v[50:51], v[94:95] op_sel:[0,0,0] op_sel_hi:[0,1,1]
    v_pk_fma_f32 v[32:33], v[8:9], v[50:51], v[32:33] op_sel:[1,0,0] op_sel_hi:[1,1,1] neg_lo:[1,0,0] neg_hi:[1,0,0]
    v_pk_fma_f32 v[34:35], v[8:9], v[48:49], v[34:35] op_sel:[1,0,0] op_sel_hi:[1,1,1]
    v_fma_f32 v48, v12, v32, v33
    v_fma_f32 v49, v12, v34, v35
    v_fma_f32 v48, -v13, v34, v48
    v_fma_f32 v49, v13, v32, v49
    v_mov_b32 v36, v48
    v_mov_b32 v37, v49
    s_nop 1
    v_permlane32_swap_b32 v36, v48
    v_permlane32_swap_b32 v37, v49
    s_nop 1
    v_fma_f32 v50, v14, v36, v48
    v_fma_f32 v51, v14, v37, v49
    v_fma_f32 v50, -v15, v37, v50
    v_fma_f32 v51, v15, v36, v51
    ds_write_b64 v5, v[50:51] offset:0
    s_cmp_lg_u32 s71, 0
    s_cbranch_scc1 S_p1
    v_pk_fma_f32 v[40:41], v[18:19], v[96:97], v[98:99] op_sel:[0,0,0] op_sel_hi:[0,1,1]
    v_pk_fma_f32 v[42:43], v[18:19], v[112:113], v[114:115] op_sel:[0,0,0] op_sel_hi:[0,1,1]
    v_pk_fma_f32 v[40:41], v[18:19], v[112:113], v[40:41] op_sel:[1,0,0] op_sel_hi:[1,1,1] neg_lo:[1,0,0] neg_hi:[1,0,0]
    v_pk_fma_f32 v[42:43], v[18:19], v[96:97], v[42:43] op_sel:[1,0,0] op_sel_hi:[1,1,1]
    v_pk_fma_f32 v[48:49], v[18:19], v[40:41], v[100:101] op_sel:[0,0,0] op_sel_hi:[0,1,1]
    v_pk_fma_f32 v[50:51], v[18:19], v[42:43], v[116:117] op_sel:[0,0,0] op_sel_hi:[0,1,1]
    v_pk_fma_f32 v[48:49], v[18:19], v[42:43], v[48:49] op_sel:[1,0,0] op_sel_hi:[1,1,1] neg_lo:[1,0,0] neg_hi:[1,0,0]
    v_pk_fma_f32 v[50:51], v[18:19], v[40:41], v[50:51] op_sel:[1,0,0] op_sel_hi:[1,1,1]
    v_pk_fma_f32 v[40:41], v[18:19], v[48:49], v[102:103] op_sel:[0,0,0] op_sel_hi:[0,1,1]
    v_pk_fma_f32 v[42:43], v[18:19], v[50:51], v[118:119] op_sel:[0,0,0] op_sel_hi:[0,1,1]
    v_pk_fma_f32 v[40:41], v[18:19], v[50:51], v[40:41] op_sel:[1,0,0] op_sel_hi:[1,1,1] neg_lo:[1,0,0] neg_hi:[1,0,0]
    v_pk_fma_f32 v[42:43], v[18:19], v[48:49], v[42:43] op_sel:[1,0,0] op_sel_hi:[1,1,1]
    v_pk_fma_f32 v[48:49], v[18:19], v[40:41], v[104:105] op_sel:[0,0,0] op_sel_hi:[0,1,1]
    v_pk_fma_f32 v[50:51], v[18:19], v[42:43], v[120:121] op_sel:[0,0,0] op_sel_hi:[0,1,1]
    v_pk_fma_f32 v[48:49], v[18:19], v[42:43], v[48:49] op_sel:[1,0,0] op_sel_hi:[1,1,1] neg_lo:[1,0,0] neg_hi:[1,0,0]
    v_pk_fma_f32 v[50:51], v[18:19], v[40:41], v[50:51] op_sel:[1,0,0] op_sel_hi:[1,1,1]
    v_pk_fma_f32 v[40:41], v[18:19], v[48:49], v[106:107] op_sel:[0,0,0] op_sel_hi:[0,1,1]
    v_pk_fma_f32 v[42:43], v[18:19], v[50:51], v[122:123] op_sel:[0,0,0] op_sel_hi:[0,1,1]
    v_pk_fma_f32 v[40:41], v[18:19], v[50:51], v[40:41] op_sel:[1,0,0] op_sel_hi:[1,1,1] neg_lo:[1,0,0] neg_hi:[1,0,0]
    v_pk_fma_f32 v[42:43], v[18:19], v[48:49], v[42:43] op_sel:[1,0,0] op_sel_hi:[1,1,1]
    v_pk_fma_f32 v[48:49], v[18:19], v[40:41], v[108:109] op_sel:[0,0,0] op_sel_hi:[0,1,1]
    v_pk_fma_f32 v[50:51], v[18:19], v[42:43], v[124:125] op_sel:[0,0,0] op_sel_hi:[0,1,1]
    v_pk_fma_f32 v[48:49], v[18:19], v[42:43], v[48:49] op_sel:[1,0,0] op_sel_hi:[1,1,1] neg_lo:[1,0,0] neg_hi:[1,0,0]
    v_pk_fma_f32 v[50:51], v[18:19], v[40:41], v[50:51] op_sel:[1,0,0] op_sel_hi:[1,1,1]
    v_pk_fma_f32 v[40:41], v[18:19], v[48:49], v[110:111] op_sel:[0,0,0] op_sel_hi:[0,1,1]
    v_pk_fma_f32 v[42:43], v[18:19], v[50:51], v[126:127] op_sel:[0,0,0] op_sel_hi:[0,1,1]
    v_pk_fma_f32 v[40:41], v[18:19], v[50:51], v[40:41] op_sel:[1,0,0] op_sel_hi:[1,1,1] neg_lo:[1,0,0] neg_hi:[1,0,0]
    v_pk_fma_f32 v[42:43], v[18:19], v[48:49], v[42:43] op_sel:[1,0,0] op_sel_hi:[1,1,1]
    v_fma_f32 v48, v22, v40, v41
    v_fma_f32 v49, v22, v42, v43
    v_fma_f32 v48, -v23, v42, v48
    v_fma_f32 v49, v23, v40, v49
    v_mov_b32 v44, v48
    v_mov_b32 v45, v49
    s_nop 1
    v_permlane32_swap_b32 v44, v48
    v_permlane32_swap_b32 v45, v49
    s_nop 1
    v_fma_f32 v50, v24, v44, v48
    v_fma_f32 v51, v24, v45, v49
    v_fma_f32 v50, -v25, v45, v50
    v_fma_f32 v51, v25, v44, v51
    ds_write_b64 v5, v[50:51] offset:1024
S_p1:
    s_waitcnt lgkmcnt(0)
    s_barrier
    s_lshl_b32 s6, 1, s5
    s_and_b32 s6, s6, 0x70
    s_cbranch_scc0 S_wt
    s_cmp_lg_u32 s5, 6
    s_cselect_b64 vcc, -1, 0
    s_lshl_b32 s15, s14, 10
    s_add_u32 s6, s15, 49152
    v_add_u32 v7, s6, v3
    ds_read_b64 v[48:49], v7
    ds_read_b64 v[50:51], v7 offset:256
    ds_read_b64 v[52:53], v7 offset:512
    ds_read_b64 v[54:55], v7 offset:768
    v_cndmask_b32 v28, v16, v26, vcc
    v_cndmask_b32 v29, v17, v27, vcc
    s_lshr_b32 s15, s15, 2
    s_mul_i32 s6, s4, 768
    s_add_u32 s78, s6, s15
    s_add_u32 s78, s78, 17858560
    s_mul_i32 s13, s3, 4608
    s_add_u32 s13, s13, s78
    v_mul_f32 v56, v28, v28
    v_mul_f32 v57, v28, v29
    v_fma_f32 v56, -v29, v29, v56
    v_fma_f32 v57, v29, v28, v57
    v_mul_f32 v30, v56, v56
    v_mul_f32 v31, v56, v57
    v_fma_f32 v30, -v57, v57, v30
    v_fma_f32 v31, v57, v56, v31
    s_load_dword s73, s[42:43], 132
    s_waitcnt lgkmcnt(0)
    s_cmp_ge_u32 s73, 16
    s_cbranch_scc1 S_wi_c
    v_mov_b32 v60, v14
    v_mov_b32 v61, v15
    s_mov_b32 s80, s42
    s_mov_b32 s81, s43
    s_mov_b32 s82, 256
    s_mov_b32 s83, 0x00020000
    v_mov_b32 v14, 0
    s_mov_b32 exec_lo, 1
    s_mov_b32 exec_hi, 0
    s_mov_b32 s72, 0
S_wi:
    buffer_load_dword v15, v14, s[80:83], 0 offen offset:132 sc1
    s_waitcnt vmcnt(0)
    v_cmp_gt_u32 vcc, 16, v15
    s_add_u32 s72, s72, 1
    s_cbranch_vccz S_wi_ok
    s_sleep 8
    s_cmp_lt_u32 s72, 0x100000
    s_cbranch_scc1 S_wi
S_wi_ok:
    s_mov_b64 exec, -1
    v_mov_b32 v14, v60
    v_mov_b32 v15, v61
S_wi_c:
    v_fma_f32 v50, v28, v48, v50
    v_fma_f32 v51, v28, v49, v51
    v_fma_f32 v50, -v29, v49, v50
    v_fma_f32 v51, v29, v48, v51
    v_fma_f32 v52, v28, v50, v52
    v_fma_f32 v53, v28, v51, v53
    v_fma_f32 v52, -v29, v51, v52
    v_fma_f32 v53, v29, v50, v53
    v_fma_f32 v54, v28, v52, v54
    v_fma_f32 v55, v28, v53, v55
    v_fma_f32 v54, -v29, v53, v54
    v_fma_f32 v55, v29, v52, v55
    v_min_u32 v54, -2, v54
    v_min_u32 v55, -2, v55
    s_mov_b64 exec, 0xffffffff
    buffer_store_dwordx2 v[54:55], v3, s[60:63], s13 offen sc1
    s_mov_b64 exec, -1
    v_mov_b32 v96, 0
    v_mov_b32 v97, 0
    v_mov_b32 v46, 0
    v_mov_b32 v47, 0
    s_mov_b32 s12, 0
    s_mov_b32 s79, s3
K2_poll:
    s_mov_b32 s15, s78
    s_cmp_le_u32 s79, 0
    s_cbranch_scc1 K2_ld
    buffer_load_dwordx2 v[98:99], v3, s[60:63], s15 offen sc1
    s_add_u32 s15, s15, 4608
    s_cmp_le_u32 s79, 1
    s_cbranch_scc1 K2_ld
    buffer_load_dwordx2 v[100:101], v3, s[60:63], s15 offen sc1
    s_add_u32 s15, s15, 4608
    s_cmp_le_u32 s79, 2
    s_cbranch_scc1 K2_ld
    buffer_load_dwordx2 v[102:103], v3, s[60:63], s15 offen sc1
    s_add_u32 s15, s15, 4608
    s_cmp_le_u32 s79, 3
    s_cbranch_scc1 K2_ld
    buffer_load_dwordx2 v[104:105], v3, s[60:63], s15 offen sc1
    s_add_u32 s15, s15, 4608
    s_cmp_le_u32 s79, 4
    s_cbranch_scc1 K2_ld
    buffer_load_dwordx2 v[106:107], v3, s[60:63], s15 offen sc1
    s_add_u32 s15, s15, 4608
    s_cmp_le_u32 s79, 5
    s_cbranch_scc1 K2_ld
    buffer_load_dwordx2 v[108:109], v3, s[60:63], s15 offen sc1
    s_add_u32 s15, s15, 4608
    s_cmp_le_u32 s79, 6
    s_cbranch_scc1 K2_ld
    buffer_load_dwordx2 v[110:111], v3, s[60:63], s15 offen sc1
    s_add_u32 s15, s15, 4608
    s_cmp_le_u32 s79, 7
    s_cbranch_scc1 K2_ld
    buffer_load_dwordx2 v[112:113], v3, s[60:63], s15 offen sc1
    s_add_u32 s15, s15, 4608
    s_cmp_le_u32 s79, 8
    s_cbranch_scc1 K2_ld
    buffer_load_dwordx2 v[114:115], v3, s[60:63], s15 offen sc1
    s_add_u32 s15, s15, 4608
    s_cmp_le_u32 s79, 9
    s_cbranch_scc1 K2_ld
    buffer_load_dwordx2 v[116:117], v3, s[60:63], s15 offen sc1
    s_add_u32 s15, s15, 4608
    s_cmp_le_u32 s79, 10
    s_cbranch_scc1 K2_ld
    buffer_load_dwordx2 v[118:119], v3, s[60:63], s15 offen sc1
    s_add_u32 s15, s15, 4608
    s_cmp_le_u32 s79, 11
    s_cbranch_scc1 K2_ld
    buffer_load_dwordx2 v[120:121], v3, s[60:63], s15 offen sc1
    s_add_u32 s15, s15, 4608
    s_cmp_le_u32 s79, 12
    s_cbranch_scc1 K2_ld
    buffer_load_dwordx2 v[122:123], v3, s[60:63], s15 offen sc1
    s_add_u32 s15, s15, 4608
    s_cmp_le_u32 s79, 13
    s_cbranch_scc1 K2_ld
    buffer_load_dwordx2 v[124:125], v3, s[60:63], s15 offen sc1
    s_add_u32 s15, s15, 4608
    s_cmp_le_u32 s79, 14
    s_cbranch_scc1 K2_ld
    buffer_load_dwordx2 v[126:127], v3, s[60:63], s15 offen sc1
    s_add_u32 s15, s15, 4608
K2_ld:
    v_mov_b32 v62, 0
    s_waitcnt vmcnt(0)
    s_cmp_le_u32 s79, 0
    s_cbranch_scc1 K2_ck
    v_max3_u32 v62, v62, v98, v99
    s_cmp_le_u32 s79, 1
    s_cbranch_scc1 K2_ck
    v_max3_u32 v62, v62, v100, v101
    s_cmp_le_u32 s79, 2
    s_cbranch_scc1 K2_ck
    v_max3_u32 v62, v62, v102, v103
    s_cmp_le_u32 s79, 3
    s_cbranch_scc1 K2_ck
    v_max3_u32 v62, v62, v104, v105
    s_cmp_le_u32 s79, 4
    s_cbranch_scc1 K2_ck
    v_max3_u32 v62, v62, v106, v107
    s_cmp_le_u32 s79, 5
    s_cbranch_scc1 K2_ck
    v_max3_u32 v62, v62, v108, v109
    s_cmp_le_u32 s79, 6
    s_cbranch_scc1 K2_ck
    v_max3_u32 v62, v62, v110, v111
    s_cmp_le_u32 s79, 7
    s_cbranch_scc1 K2_ck
    v_max3_u32 v62, v62, v112, v113
    s_cmp_le_u32 s79, 8
    s_cbranch_scc1 K2_ck
    v_max3_u32 v62, v62, v114, v115
    s_cmp_le_u32 s79, 9
    s_cbranch_scc1 K2_ck
    v_max3_u32 v62, v62, v116, v117
    s_cmp_le_u32 s79, 10
    s_cbranch_scc1 K2_ck
    v_max3_u32 v62, v62, v118, v119
    s_cmp_le_u32 s79, 11
    s_cbranch_scc1 K2_ck
    v_max3_u32 v62, v62, v120, v121
    s_cmp_le_u32 s79, 12
    s_cbranch_scc1 K2_ck
    v_max3_u32 v62, v62, v122, v123
    s_cmp_le_u32 s79, 13
    s_cbranch_scc1 K2_ck
    v_max3_u32 v62, v62, v124, v125
    s_cmp_le_u32 s79, 14
    s_cbranch_scc1 K2_ck
    v_max3_u32 v62, v62, v126, v127
K2_ck:
    v_cmp_eq_u32 vcc, -1, v62
    s_add_u32 s12, s12, 1
    s_cbranch_vccz K2_got
    s_sleep 8
    s_cmp_lt_u32 s12, 0x40000
    s_cbranch_scc1 K2_poll
K2_got:
    s_cmp_le_u32 s79, 0
    s_cbranch_scc1 K2_h0
    v_fma_f32 v98, v30, v96, v98
    v_fma_f32 v99, v30, v97, v99
    v_fma_f32 v98, -v31, v97, v98
    v_fma_f32 v99, v31, v96, v99
    s_cmp_le_u32 s79, 1
    s_cbranch_scc1 K2_h1
    v_fma_f32 v100, v30, v98, v100
    v_fma_f32 v101, v30, v99, v101
    v_fma_f32 v100, -v31, v99, v100
    v_fma_f32 v101, v31, v98, v101
    s_cmp_le_u32 s79, 2
    s_cbranch_scc1 K2_h2
    v_fma_f32 v102, v30, v100, v102
    v_fma_f32 v103, v30, v101, v103
    v_fma_f32 v102, -v31, v101, v102
    v_fma_f32 v103, v31, v100, v103
    s_cmp_le_u32 s79, 3
    s_cbranch_scc1 K2_h3
    v_fma_f32 v104, v30, v102, v104
    v_fma_f32 v105, v30, v103, v105
    v_fma_f32 v104, -v31, v103, v104
    v_fma_f32 v105, v31, v102, v105
    s_cmp_le_u32 s79, 4
    s_cbranch_scc1 K2_h4
    v_fma_f32 v106, v30, v104, v106
    v_fma_f32 v107, v30, v105, v107
    v_fma_f32 v106, -v31, v105, v106
    v_fma_f32 v107, v31, v104, v107
    s_cmp_le_u32 s79, 5
    s_cbranch_scc1 K2_h5
    v_fma_f32 v108, v30, v106, v108
    v_fma_f32 v109, v30, v107, v109
    v_fma_f32 v108, -v31, v107, v108
    v_fma_f32 v109, v31, v106, v109
    s_cmp_le_u32 s79, 6
    s_cbranch_scc1 K2_h6
    v_fma_f32 v110, v30, v108, v110
    v_fma_f32 v111, v30, v109, v111
    v_fma_f32 v110, -v31, v109, v110
    v_fma_f32 v111, v31, v108, v111
    s_cmp_le_u32 s79, 7
    s_cbranch_scc1 K2_h7
    v_fma_f32 v112, v30, v110, v112
    v_fma_f32 v113, v30, v111, v113
    v_fma_f32 v112, -v31, v111, v112
    v_fma_f32 v113, v31, v110, v113
    s_cmp_le_u32 s79, 8
    s_cbranch_scc1 K2_h8
    v_fma_f32 v114, v30, v112, v114
    v_fma_f32 v115, v30, v113, v115
    v_fma_f32 v114, -v31, v113, v114
    v_fma_f32 v115, v31, v112, v115
    s_cmp_le_u32 s79, 9
    s_cbranch_scc1 K2_h9
    v_fma_f32 v116, v30, v114, v116
    v_fma_f32 v117, v30, v115, v117
    v_fma_f32 v116, -v31, v115, v116
    v_fma_f32 v117, v31, v114, v117
    s_cmp_le_u32 s79, 10
    s_cbranch_scc1 K2_h10
    v_fma_f32 v118, v30, v116, v118
    v_fma_f32 v119, v30, v117, v119
    v_fma_f32 v118, -v31, v117, v118
    v_fma_f32 v119, v31, v116, v119
    s_cmp_le_u32 s79, 11
    s_cbranch_scc1 K2_h11
    v_fma_f32 v120, v30, v118, v120
    v_fma_f32 v121, v30, v119, v121
    v_fma_f32 v120, -v31, v119, v120
    v_fma_f32 v121, v31, v118, v121
    s_cmp_le_u32 s79, 12
    s_cbranch_scc1 K2_h12
    v_fma_f32 v122, v30, v120, v122
    v_fma_f32 v123, v30, v121, v123
    v_fma_f32 v122, -v31, v121, v122
    v_fma_f32 v123, v31, v120, v123
    s_cmp_le_u32 s79, 13
    s_cbranch_scc1 K2_h13
    v_fma_f32 v124, v30, v122, v124
    v_fma_f32 v125, v30, v123, v125
    v_fma_f32 v124, -v31, v123, v124
    v_fma_f32 v125, v31, v122, v125
    s_cmp_le_u32 s79, 14
    s_cbranch_scc1 K2_h14
    v_fma_f32 v126, v30, v124, v126
    v_fma_f32 v127, v30, v125, v127
    v_fma_f32 v126, -v31, v125, v126
    v_fma_f32 v127, v31, v124, v127
    v_mov_b32 v46, v126
    v_mov_b32 v47, v127
    s_branch K2_h0
K2_h14:
    v_mov_b32 v46, v124
    v_mov_b32 v47, v125
    s_branch K2_h0
K2_h13:
    v_mov_b32 v46, v122
    v_mov_b32 v47, v123
    s_branch K2_h0
K2_h12:
    v_mov_b32 v46, v120
    v_mov_b32 v47, v121
    s_branch K2_h0
K2_h11:
    v_mov_b32 v46, v118
    v_mov_b32 v47, v119
    s_branch K2_h0
K2_h10:
    v_mov_b32 v46, v116
    v_mov_b32 v47, v117
    s_branch K2_h0
K2_h9:
    v_mov_b32 v46, v114
    v_mov_b32 v47, v115
    s_branch K2_h0
K2_h8:
    v_mov_b32 v46, v112
    v_mov_b32 v47, v113
    s_branch K2_h0
K2_h7:
    v_mov_b32 v46, v110
    v_mov_b32 v47, v111
    s_branch K2_h0
K2_h6:
    v_mov_b32 v46, v108
    v_mov_b32 v47, v109
    s_branch K2_h0
K2_h5:
    v_mov_b32 v46, v106
    v_mov_b32 v47, v107
    s_branch K2_h0
K2_h4:
    v_mov_b32 v46, v104
    v_mov_b32 v47, v105
    s_branch K2_h0
K2_h3:
    v_mov_b32 v46, v102
    v_mov_b32 v47, v103
    s_branch K2_h0
K2_h2:
    v_mov_b32 v46, v100
    v_mov_b32 v47, v101
    s_branch K2_h0
K2_h1:
    v_mov_b32 v46, v98
    v_mov_b32 v47, v99
K2_h0:
    ds_write_b64 v7, v[46:47] offset:768
    s_waitcnt lgkmcnt(0)
S_wt:
    s_setprio 3
    s_barrier
    v_mul_u32_u24 v6, 37120, v2
    v_lshl_add_u32 v6, v1, 4, v6
    s_lshl_b32 s75, s3, 2
    s_add_u32 s75, s75, s14
    s_mul_i32 s75, s75, 74240
    s_lshl_b32 s6, s46, 4
    s_add_u32 s75, s75, s6
    s_add_u32 s75, s75, 9961472
    ds_read_b64 v[48:49], v4 offset:768
    ds_read_b64 v[50:51], v4 offset:0
    ds_read_b64 v[52:53], v4 offset:256
    ds_read_b64 v[54:55], v4 offset:512
    s_waitcnt lgkmcnt(0)
    s_cmp_le_u32 s14, 0
    s_cbranch_scc1 S_c0
    v_fma_f32 v50, v16, v48, v50
    v_fma_f32 v51, v16, v49, v51
    v_fma_f32 v50, -v17, v49, v50
    v_fma_f32 v51, v17, v48, v51
    v_mov_b32 v48, v50
    v_mov_b32 v49, v51
    s_cmp_le_u32 s14, 1
    s_cbranch_scc1 S_c0
    v_fma_f32 v52, v16, v48, v52
    v_fma_f32 v53, v16, v49, v53
    v_fma_f32 v52, -v17, v49, v52
    v_fma_f32 v53, v17, v48, v53
    v_mov_b32 v48, v52
    v_mov_b32 v49, v53
    s_cmp_le_u32 s14, 2
    s_cbranch_scc1 S_c0
    v_fma_f32 v54, v16, v48, v54
    v_fma_f32 v55, v16, v49, v55
    v_fma_f32 v54, -v17, v49, v54
    v_fma_f32 v55, v17, v48, v55
    v_mov_b32 v48, v54
    v_mov_b32 v49, v55
S_c0:
    v_fma_f32 v50, v14, v48, v36
    v_fma_f32 v51, v14, v49, v37
    v_fma_f32 v50, -v15, v49, v50
    v_fma_f32 v51, v15, v48, v51
    v_cndmask_b32 v28, v48, v50, s[8:9]
    v_cndmask_b32 v30, v49, v51, s[8:9]
    v_fma_f32 v29, v12, v28, v32
    v_fma_f32 v31, v12, v30, v34
    v_fma_f32 v29, -v13, v30, v29
    v_fma_f32 v31, v13, v28, v31
    v_pk_fma_f32 v[64:65], v[8:9], v[28:29], v[64:65] op_sel:[0,0,0] op_sel_hi:[0,1,1]
    v_pk_fma_f32 v[80:81], v[8:9], v[30:31], v[80:81] op_sel:[0,0,0] op_sel_hi:[0,1,1]
    v_pk_fma_f32 v[64:65], v[8:9], v[30:31], v[64:65] op_sel:[1,0,0] op_sel_hi:[1,1,1] neg_lo:[1,0,0] neg_hi:[1,0,0]
    v_pk_fma_f32 v[80:81], v[8:9], v[28:29], v[80:81] op_sel:[1,0,0] op_sel_hi:[1,1,1]
    v_pk_mul_f32 v[32:33], v[10:11], v[64:65] op_sel:[0,0] op_sel_hi:[0,1]
    v_pk_mul_f32 v[34:35], v[10:11], v[80:81] op_sel:[0,0] op_sel_hi:[0,1] neg_lo:[1,0] neg_hi:[1,0]
    v_pk_fma_f32 v[32:33], v[10:11], v[80:81], v[32:33] op_sel:[1,0,0] op_sel_hi:[1,1,1] neg_lo:[1,0,0] neg_hi:[1,0,0]
    v_pk_fma_f32 v[34:35], v[10:11], v[64:65], v[34:35] op_sel:[1,0,0] op_sel_hi:[1,1,1] neg_lo:[1,0,0] neg_hi:[1,0,0]
    v_pk_fma_f32 v[66:67], v[8:9], v[64:65], v[66:67] op_sel:[0,0,0] op_sel_hi:[0,1,1]
    v_pk_fma_f32 v[82:83], v[8:9], v[80:81], v[82:83] op_sel:[0,0,0] op_sel_hi:[0,1,1]
    v_pk_fma_f32 v[66:67], v[8:9], v[80:81], v[66:67] op_sel:[1,0,0] op_sel_hi:[1,1,1] neg_lo:[1,0,0] neg_hi:[1,0,0]
    v_pk_fma_f32 v[82:83], v[8:9], v[64:65], v[82:83] op_sel:[1,0,0] op_sel_hi:[1,1,1]
    v_pk_mul_f32 v[36:37], v[10:11], v[66:67] op_sel:[0,0] op_sel_hi:[0,1]
    v_pk_mul_f32 v[38:39], v[10:11], v[82:83] op_sel:[0,0] op_sel_hi:[0,1] neg_lo:[1,0] neg_hi:[1,0]
    v_pk_fma_f32 v[36:37], v[10:11], v[82:83], v[36:37] op_sel:[1,0,0] op_sel_hi:[1,1,1] neg_lo:[1,0,0] neg_hi:[1,0,0]
    v_pk_fma_f32 v[38:39], v[10:11], v[66:67], v[38:39] op_sel:[1,0,0] op_sel_hi:[1,1,1] neg_lo:[1,0,0] neg_hi:[1,0,0]
    v_cvt_pk_bf16_f32 v48, v32, v36
    v_cvt_pk_bf16_f32 v52, v33, v37
    v_cvt_pk_bf16_f32 v56, v34, v38
    v_cvt_pk_bf16_f32 v60, v35, v39
    v_pk_fma_f32 v[68:69], v[8:9], v[66:67], v[68:69] op_sel:[0,0,0] op_sel_hi:[0,1,1]
    v_pk_fma_f32 v[84:85], v[8:9], v[82:83], v[84:85] op_sel:[0,0,0] op_sel_hi:[0,1,1]
    v_pk_fma_f32 v[68:69], v[8:9], v[82:83], v[68:69] op_sel:[1,0,0] op_sel_hi:[1,1,1] neg_lo:[1,0,0] neg_hi:[1,0,0]
    v_pk_fma_f32 v[84:85], v[8:9], v[66:67], v[84:85] op_sel:[1,0,0] op_sel_hi:[1,1,1]
    v_pk_mul_f32 v[32:33], v[10:11], v[68:69] op_sel:[0,0] op_sel_hi:[0,1]
    v_pk_mul_f32 v[34:35], v[10:11], v[84:85] op_sel:[0,0] op_sel_hi:[0,1] neg_lo:[1,0] neg_hi:[1,0]
    v_pk_fma_f32 v[32:33], v[10:11], v[84:85], v[32:33] op_sel:[1,0,0] op_sel_hi:[1,1,1] neg_lo:[1,0,0] neg_hi:[1,0,0]
    v_pk_fma_f32 v[34:35], v[10:11], v[68:69], v[34:35] op_sel:[1,0,0] op_sel_hi:[1,1,1] neg_lo:[1,0,0] neg_hi:[1,0,0]
    v_pk_fma_f32 v[70:71], v[8:9], v[68:69], v[70:71] op_sel:[0,0,0] op_sel_hi:[0,1,1]
    v_pk_fma_f32 v[86:87], v[8:9], v[84:85], v[86:87] op_sel:[0,0,0] op_sel_hi:[0,1,1]
    v_pk_fma_f32 v[70:71], v[8:9], v[84:85], v[70:71] op_sel:[1,0,0] op_sel_hi:[1,1,1] neg_lo:[1,0,0] neg_hi:[1,0,0]
    v_pk_fma_f32 v[86:87], v[8:9], v[68:69], v[86:87] op_sel:[1,0,0] op_sel_hi:[1,1,1]
    v_pk_mul_f32 v[36:37], v[10:11], v[70:71] op_sel:[0,0] op_sel_hi:[0,1]
    v_pk_mul_f32 v[38:39], v[10:11], v[86:87] op_sel:[0,0] op_sel_hi:[0,1] neg_lo:[1,0] neg_hi:[1,0]
    v_pk_fma_f32 v[36:37], v[10:11], v[86:87], v[36:37] op_sel:[1,0,0] op_sel_hi:[1,1,1] neg_lo:[1,0,0] neg_hi:[1,0,0]
    v_pk_fma_f32 v[38:39], v[10:11], v[70:71], v[38:39] op_sel:[1,0,0] op_sel_hi:[1,1,1] neg_lo:[1,0,0] neg_hi:[1,0,0]
    v_cvt_pk_bf16_f32 v49, v32, v36
    v_cvt_pk_bf16_f32 v53, v33, v37
    v_cvt_pk_bf16_f32 v57, v34, v38
    v_cvt_pk_bf16_f32 v61, v35, v39
    v_pk_fma_f32 v[72:73], v[8:9], v[70:71], v[72:73] op_sel:[0,0,0] op_sel_hi:[0,1,1]
    v_pk_fma_f32 v[88:89], v[8:9], v[86:87], v[88:89] op_sel:[0,0,0] op_sel_hi:[0,1,1]
    v_pk_fma_f32 v[72:73], v[8:9], v[86:87], v[72:73] op_sel:[1,0,0] op_sel_hi:[1,1,1] neg_lo:[1,0,0] neg_hi:[1,0,0]
    v_pk_fma_f32 v[88:89], v[8:9], v[70:71], v[88:89] op_sel:[1,0,0] op_sel_hi:[1,1,1]
    v_pk_mul_f32 v[32:33], v[10:11], v[72:73] op_sel:[0,0] op_sel_hi:[0,1]
    v_pk_mul_f32 v[34:35], v[10:11], v[88:89] op_sel:[0,0] op_sel_hi:[0,1] neg_lo:[1,0] neg_hi:[1,0]
    v_pk_fma_f32 v[32:33], v[10:11], v[88:89], v[32:33] op_sel:[1,0,0] op_sel_hi:[1,1,1] neg_lo:[1,0,0] neg_hi:[1,0,0]
    v_pk_fma_f32 v[34:35], v[10:11], v[72:73], v[34:35] op_sel:[1,0,0] op_sel_hi:[1,1,1] neg_lo:[1,0,0] neg_hi:[1,0,0]
    v_pk_fma_f32 v[74:75], v[8:9], v[72:73], v[74:75] op_sel:[0,0,0] op_sel_hi:[0,1,1]
    v_pk_fma_f32 v[90:91], v[8:9], v[88:89], v[90:91] op_sel:[0,0,0] op_sel_hi:[0,1,1]
    v_pk_fma_f32 v[74:75], v[8:9], v[88:89], v[74:75] op_sel:[1,0,0] op_sel_hi:[1,1,1] neg_lo:[1,0,0] neg_hi:[1,0,0]
    v_pk_fma_f32 v[90:91], v[8:9], v[72:73], v[90:91] op_sel:[1,0,0] op_sel_hi:[1,1,1]
    v_pk_mul_f32 v[36:37], v[10:11], v[74:75] op_sel:[0,0] op_sel_hi:[0,1]
    v_pk_mul_f32 v[38:39], v[10:11], v[90:91] op_sel:[0,0] op_sel_hi:[0,1] neg_lo:[1,0] neg_hi:[1,0]
    v_pk_fma_f32 v[36:37], v[10:11], v[90:91], v[36:37] op_sel:[1,0,0] op_sel_hi:[1,1,1] neg_lo:[1,0,0] neg_hi:[1,0,0]
    v_pk_fma_f32 v[38:39], v[10:11], v[74:75], v[38:39] op_sel:[1,0,0] op_sel_hi:[1,1,1] neg_lo:[1,0,0] neg_hi:[1,0,0]
    v_cvt_pk_bf16_f32 v50, v32, v36
    v_cvt_pk_bf16_f32 v54, v33, v37
    v_cvt_pk_bf16_f32 v58, v34, v38
    v_cvt_pk_bf16_f32 v62, v35, v39
    v_pk_fma_f32 v[76:77], v[8:9], v[74:75], v[76:77] op_sel:[0,0,0] op_sel_hi:[0,1,1]
    v_pk_fma_f32 v[92:93], v[8:9], v[90:91], v[92:93] op_sel:[0,0,0] op_sel_hi:[0,1,1]
    v_pk_fma_f32 v[76:77], v[8:9], v[90:91], v[76:77] op_sel:[1,0,0] op_sel_hi:[1,1,1] neg_lo:[1,0,0] neg_hi:[1,0,0]
    v_pk_fma_f32 v[92:93], v[8:9], v[74:75], v[92:93] op_sel:[1,0,0] op_sel_hi:[1,1,1]
    v_pk_mul_f32 v[32:33], v[10:11], v[76:77] op_sel:[0,0] op_sel_hi:[0,1]
    v_pk_mul_f32 v[34:35], v[10:11], v[92:93] op_sel:[0,0] op_sel_hi:[0,1] neg_lo:[1,0] neg_hi:[1,0]
    v_pk_fma_f32 v[32:33], v[10:11], v[92:93], v[32:33] op_sel:[1,0,0] op_sel_hi:[1,1,1] neg_lo:[1,0,0] neg_hi:[1,0,0]
    v_pk_fma_f32 v[34:35], v[10:11], v[76:77], v[34:35] op_sel:[1,0,0] op_sel_hi:[1,1,1] neg_lo:[1,0,0] neg_hi:[1,0,0]
    v_pk_fma_f32 v[78:79], v[8:9], v[76:77], v[78:79] op_sel:[0,0,0] op_sel_hi:[0,1,1]
    v_pk_fma_f32 v[94:95], v[8:9], v[92:93], v[94:95] op_sel:[0,0,0] op_sel_hi:[0,1,1]
    v_pk_fma_f32 v[78:79], v[8:9], v[92:93], v[78:79] op_sel:[1,0,0] op_sel_hi:[1,1,1] neg_lo:[1,0,0] neg_hi:[1,0,0]
    v_pk_fma_f32 v[94:95], v[8:9], v[76:77], v[94:95] op_sel:[1,0,0] op_sel_hi:[1,1,1]
    v_pk_mul_f32 v[36:37], v[10:11], v[78:79] op_sel:[0,0] op_sel_hi:[0,1]
    v_pk_mul_f32 v[38:39], v[10:11], v[94:95] op_sel:[0,0] op_sel_hi:[0,1] neg_lo:[1,0] neg_hi:[1,0]
    v_pk_fma_f32 v[36:37], v[10:11], v[94:95], v[36:37] op_sel:[1,0,0] op_sel_hi:[1,1,1] neg_lo:[1,0,0] neg_hi:[1,0,0]
    v_pk_fma_f32 v[38:39], v[10:11], v[78:79], v[38:39] op_sel:[1,0,0] op_sel_hi:[1,1,1] neg_lo:[1,0,0] neg_hi:[1,0,0]
    v_cvt_pk_bf16_f32 v51, v32, v36
    v_cvt_pk_bf16_f32 v55, v33, v37
    v_cvt_pk_bf16_f32 v59, v34, v38
    v_cvt_pk_bf16_f32 v63, v35, v39
    s_add_u32 s6, s75, 0
    buffer_store_dwordx4 v[48:51], v6, s[60:63], s6 offen sc1
    s_add_u32 s6, s75, 18560
    buffer_store_dwordx4 v[52:55], v6, s[60:63], s6 offen sc1
    s_add_u32 s6, s75, 9216
    buffer_store_dwordx4 v[56:59], v6, s[60:63], s6 offen sc1
    s_add_u32 s6, s75, 27776
    buffer_store_dwordx4 v[60:63], v6, s[60:63], s6 offen sc1
    s_cmp_lg_u32 s71, 0
    s_cbranch_scc1 S_p2
    ds_read_b64 v[48:49], v4 offset:1792
    ds_read_b64 v[50:51], v4 offset:1024
    ds_read_b64 v[52:53], v4 offset:1280
    ds_read_b64 v[54:55], v4 offset:1536
    s_waitcnt lgkmcnt(0)
    s_cmp_le_u32 s14, 0
    s_cbranch_scc1 S_c1
    v_fma_f32 v50, v26, v48, v50
    v_fma_f32 v51, v26, v49, v51
    v_fma_f32 v50, -v27, v49, v50
    v_fma_f32 v51, v27, v48, v51
    v_mov_b32 v48, v50
    v_mov_b32 v49, v51
    s_cmp_le_u32 s14, 1
    s_cbranch_scc1 S_c1
    v_fma_f32 v52, v26, v48, v52
    v_fma_f32 v53, v26, v49, v53
    v_fma_f32 v52, -v27, v49, v52
    v_fma_f32 v53, v27, v48, v53
    v_mov_b32 v48, v52
    v_mov_b32 v49, v53
    s_cmp_le_u32 s14, 2
    s_cbranch_scc1 S_c1
    v_fma_f32 v54, v26, v48, v54
    v_fma_f32 v55, v26, v49, v55
    v_fma_f32 v54, -v27, v49, v54
    v_fma_f32 v55, v27, v48, v55
    v_mov_b32 v48, v54
    v_mov_b32 v49, v55
S_c1:
    v_fma_f32 v50, v24, v48, v44
    v_fma_f32 v51, v24, v49, v45
    v_fma_f32 v50, -v25, v49, v50
    v_fma_f32 v51, v25, v48, v51
    v_cndmask_b32 v28, v48, v50, s[8:9]
    v_cndmask_b32 v30, v49, v51, s[8:9]
    v_fma_f32 v29, v22, v28, v40
    v_fma_f32 v31, v22, v30, v42
    v_fma_f32 v29, -v23, v30, v29
    v_fma_f32 v31, v23, v28, v31
    v_pk_fma_f32 v[96:97], v[18:19], v[28:29], v[96:97] op_sel:[0,0,0] op_sel_hi:[0,1,1]
    v_pk_fma_f32 v[112:113], v[18:19], v[30:31], v[112:113] op_sel:[0,0,0] op_sel_hi:[0,1,1]
    v_pk_fma_f32 v[96:97], v[18:19], v[30:31], v[96:97] op_sel:[1,0,0] op_sel_hi:[1,1,1] neg_lo:[1,0,0] neg_hi:[1,0,0]
    v_pk_fma_f32 v[112:113], v[18:19], v[28:29], v[112:113] op_sel:[1,0,0] op_sel_hi:[1,1,1]
    v_pk_mul_f32 v[40:41], v[20:21], v[96:97] op_sel:[0,0] op_sel_hi:[0,1]
    v_pk_mul_f32 v[42:43], v[20:21], v[112:113] op_sel:[0,0] op_sel_hi:[0,1] neg_lo:[1,0] neg_hi:[1,0]
    v_pk_fma_f32 v[40:41], v[20:21], v[112:113], v[40:41] op_sel:[1,0,0] op_sel_hi:[1,1,1] neg_lo:[1,0,0] neg_hi:[1,0,0]
    v_pk_fma_f32 v[42:43], v[20:21], v[96:97], v[42:43] op_sel:[1,0,0] op_sel_hi:[1,1,1] neg_lo:[1,0,0] neg_hi:[1,0,0]
    v_pk_fma_f32 v[98:99], v[18:19], v[96:97], v[98:99] op_sel:[0,0,0] op_sel_hi:[0,1,1]
    v_pk_fma_f32 v[114:115], v[18:19], v[112:113], v[114:115] op_sel:[0,0,0] op_sel_hi:[0,1,1]
    v_pk_fma_f32 v[98:99], v[18:19], v[112:113], v[98:99] op_sel:[1,0,0] op_sel_hi:[1,1,1] neg_lo:[1,0,0] neg_hi:[1,0,0]
    v_pk_fma_f32 v[114:115], v[18:19], v[96:97], v[114:115] op_sel:[1,0,0] op_sel_hi:[1,1,1]
    v_pk_mul_f32 v[44:45], v[20:21], v[98:99] op_sel:[0,0] op_sel_hi:[0,1]
    v_pk_mul_f32 v[46:47], v[20:21], v[114:115] op_sel:[0,0] op_sel_hi:[0,1] neg_lo:[1,0] neg_hi:[1,0]
    v_pk_fma_f32 v[44:45], v[20:21], v[114:115], v[44:45] op_sel:[1,0,0] op_sel_hi:[1,1,1] neg_lo:[1,0,0] neg_hi:[1,0,0]
    v_pk_fma_f32 v[46:47], v[20:21], v[98:99], v[46:47] op_sel:[1,0,0] op_sel_hi:[1,1,1] neg_lo:[1,0,0] neg_hi:[1,0,0]
    v_cvt_pk_bf16_f32 v64, v40, v44
    v_cvt_pk_bf16_f32 v68, v41, v45
    v_cvt_pk_bf16_f32 v72, v42, v46
    v_cvt_pk_bf16_f32 v76, v43, v47
    v_pk_fma_f32 v[100:101], v[18:19], v[98:99], v[100:101] op_sel:[0,0,0] op_sel_hi:[0,1,1]
    v_pk_fma_f32 v[116:117], v[18:19], v[114:115], v[116:117] op_sel:[0,0,0] op_sel_hi:[0,1,1]
    v_pk_fma_f32 v[100:101], v[18:19], v[114:115], v[100:101] op_sel:[1,0,0] op_sel_hi:[1,1,1] neg_lo:[1,0,0] neg_hi:[1,0,0]
    v_pk_fma_f32 v[116:117], v[18:19], v[98:99], v[116:117] op_sel:[1,0,0] op_sel_hi:[1,1,1]
    v_pk_mul_f32 v[40:41], v[20:21], v[100:101] op_sel:[0,0] op_sel_hi:[0,1]
    v_pk_mul_f32 v[42:43], v[20:21], v[116:117] op_sel:[0,0] op_sel_hi:[0,1] neg_lo:[1,0] neg_hi:[1,0]
    v_pk_fma_f32 v[40:41], v[20:21], v[116:117], v[40:41] op_sel:[1,0,0] op_sel_hi:[1,1,1] neg_lo:[1,0,0] neg_hi:[1,0,0]
    v_pk_fma_f32 v[42:43], v[20:21], v[100:101], v[42:43] op_sel:[1,0,0] op_sel_hi:[1,1,1] neg_lo:[1,0,0] neg_hi:[1,0,0]
    v_pk_fma_f32 v[102:103], v[18:19], v[100:101], v[102:103] op_sel:[0,0,0] op_sel_hi:[0,1,1]
    v_pk_fma_f32 v[118:119], v[18:19], v[116:117], v[118:119] op_sel:[0,0,0] op_sel_hi:[0,1,1]
    v_pk_fma_f32 v[102:103], v[18:19], v[116:117], v[102:103] op_sel:[1,0,0] op_sel_hi:[1,1,1] neg_lo:[1,0,0] neg_hi:[1,0,0]
    v_pk_fma_f32 v[118:119], v[18:19], v[100:101], v[118:119] op_sel:[1,0,0] op_sel_hi:[1,1,1]
    v_pk_mul_f32 v[44:45], v[20:21], v[102:103] op_sel:[0,0] op_sel_hi:[0,1]
    v_pk_mul_f32 v[46:47], v[20:21], v[118:119] op_sel:[0,0] op_sel_hi:[0,1] neg_lo:[1,0] neg_hi:[1,0]
    v_pk_fma_f32 v[44:45], v[20:21], v[118:119], v[44:45] op_sel:[1,0,0] op_sel_hi:[1,1,1] neg_lo:[1,0,0] neg_hi:[1,0,0]
    v_pk_fma_f32 v[46:47], v[20:21], v[102:103], v[46:47] op_sel:[1,0,0] op_sel_hi:[1,1,1] neg_lo:[1,0,0] neg_hi:[1,0,0]
    v_cvt_pk_bf16_f32 v65, v40, v44
    v_cvt_pk_bf16_f32 v69, v41, v45
    v_cvt_pk_bf16_f32 v73, v42, v46
    v_cvt_pk_bf16_f32 v77, v43, v47
    v_pk_fma_f32 v[104:105], v[18:19], v[102:103], v[104:105] op_sel:[0,0,0] op_sel_hi:[0,1,1]
    v_pk_fma_f32 v[120:121], v[18:19], v[118:119], v[120:121] op_sel:[0,0,0] op_sel_hi:[0,1,1]
    v_pk_fma_f32 v[104:105], v[18:19], v[118:119], v[104:105] op_sel:[1,0,0] op_sel_hi:[1,1,1] neg_lo:[1,0,0] neg_hi:[1,0,0]
    v_pk_fma_f32 v[120:121], v[18:19], v[102:103], v[120:121] op_sel:[1,0,0] op_sel_hi:[1,1,1]
    v_pk_mul_f32 v[40:41], v[20:21], v[104:105] op_sel:[0,0] op_sel_hi:[0,1]
    v_pk_mul_f32 v[42:43], v[20:21], v[120:121] op_sel:[0,0] op_sel_hi:[0,1] neg_lo:[1,0] neg_hi:[1,0]
    v_pk_fma_f32 v[40:41], v[20:21], v[120:121], v[40:41] op_sel:[1,0,0] op_sel_hi:[1,1,1] neg_lo:[1,0,0] neg_hi:[1,0,0]
    v_pk_fma_f32 v[42:43], v[20:21], v[104:105], v[42:43] op_sel:[1,0,0] op_sel_hi:[1,1,1] neg_lo:[1,0,0] neg_hi:[1,0,0]
    v_pk_fma_f32 v[106:107], v[18:19], v[104:105], v[106:107] op_sel:[0,0,0] op_sel_hi:[0,1,1]
    v_pk_fma_f32 v[122:123], v[18:19], v[120:121], v[122:123] op_sel:[0,0,0] op_sel_hi:[0,1,1]
    v_pk_fma_f32 v[106:107], v[18:19], v[120:121], v[106:107] op_sel:[1,0,0] op_sel_hi:[1,1,1] neg_lo:[1,0,0] neg_hi:[1,0,0]
    v_pk_fma_f32 v[122:123], v[18:19], v[104:105], v[122:123] op_sel:[1,0,0] op_sel_hi:[1,1,1]
    v_pk_mul_f32 v[44:45], v[20:21], v[106:107] op_sel:[0,0] op_sel_hi:[0,1]
    v_pk_mul_f32 v[46:47], v[20:21], v[122:123] op_sel:[0,0] op_sel_hi:[0,1] neg_lo:[1,0] neg_hi:[1,0]
    v_pk_fma_f32 v[44:45], v[20:21], v[122:123], v[44:45] op_sel:[1,0,0] op_sel_hi:[1,1,1] neg_lo:[1,0,0] neg_hi:[1,0,0]
    v_pk_fma_f32 v[46:47], v[20:21], v[106:107], v[46:47] op_sel:[1,0,0] op_sel_hi:[1,1,1] neg_lo:[1,0,0] neg_hi:[1,0,0]
    v_cvt_pk_bf16_f32 v66, v40, v44
    v_cvt_pk_bf16_f32 v70, v41, v45
    v_cvt_pk_bf16_f32 v74, v42, v46
    v_cvt_pk_bf16_f32 v78, v43, v47
    v_pk_fma_f32 v[108:109], v[18:19], v[106:107], v[108:109] op_sel:[0,0,0] op_sel_hi:[0,1,1]
    v_pk_fma_f32 v[124:125], v[18:19], v[122:123], v[124:125] op_sel:[0,0,0] op_sel_hi:[0,1,1]
    v_pk_fma_f32 v[108:109], v[18:19], v[122:123], v[108:109] op_sel:[1,0,0] op_sel_hi:[1,1,1] neg_lo:[1,0,0] neg_hi:[1,0,0]
    v_pk_fma_f32 v[124:125], v[18:19], v[106:107], v[124:125] op_sel:[1,0,0] op_sel_hi:[1,1,1]
    v_pk_mul_f32 v[40:41], v[20:21], v[108:109] op_sel:[0,0] op_sel_hi:[0,1]
    v_pk_mul_f32 v[42:43], v[20:21], v[124:125] op_sel:[0,0] op_sel_hi:[0,1] neg_lo:[1,0] neg_hi:[1,0]
    v_pk_fma_f32 v[40:41], v[20:21], v[124:125], v[40:41] op_sel:[1,0,0] op_sel_hi:[1,1,1] neg_lo:[1,0,0] neg_hi:[1,0,0]
    v_pk_fma_f32 v[42:43], v[20:21], v[108:109], v[42:43] op_sel:[1,0,0] op_sel_hi:[1,1,1] neg_lo:[1,0,0] neg_hi:[1,0,0]
    v_pk_fma_f32 v[110:111], v[18:19], v[108:109], v[110:111] op_sel:[0,0,0] op_sel_hi:[0,1,1]
    v_pk_fma_f32 v[126:127], v[18:19], v[124:125], v[126:127] op_sel:[0,0,0] op_sel_hi:[0,1,1]
    v_pk_fma_f32 v[110:111], v[18:19], v[124:125], v[110:111] op_sel:[1,0,0] op_sel_hi:[1,1,1] neg_lo:[1,0,0] neg_hi:[1,0,0]
    v_pk_fma_f32 v[126:127], v[18:19], v[108:109], v[126:127] op_sel:[1,0,0] op_sel_hi:[1,1,1]
    v_pk_mul_f32 v[44:45], v[20:21], v[110:111] op_sel:[0,0] op_sel_hi:[0,1]
    v_pk_mul_f32 v[46:47], v[20:21], v[126:127] op_sel:[0,0] op_sel_hi:[0,1] neg_lo:[1,0] neg_hi:[1,0]
    v_pk_fma_f32 v[44:45], v[20:21], v[126:127], v[44:45] op_sel:[1,0,0] op_sel_hi:[1,1,1] neg_lo:[1,0,0] neg_hi:[1,0,0]
    v_pk_fma_f32 v[46:47], v[20:21], v[110:111], v[46:47] op_sel:[1,0,0] op_sel_hi:[1,1,1] neg_lo:[1,0,0] neg_hi:[1,0,0]
    v_cvt_pk_bf16_f32 v67, v40, v44
    v_cvt_pk_bf16_f32 v71, v41, v45
    v_cvt_pk_bf16_f32 v75, v42, v46
    v_cvt_pk_bf16_f32 v79, v43, v47
    s_add_u32 s6, s75, 512
    buffer_store_dwordx4 v[64:67], v6, s[60:63], s6 offen sc1
    s_add_u32 s6, s75, 19072
    buffer_store_dwordx4 v[68:71], v6, s[60:63], s6 offen sc1
    s_add_u32 s6, s75, 9728
    buffer_store_dwordx4 v[72:75], v6, s[60:63], s6 offen sc1
    s_add_u32 s6, s75, 28288
    buffer_store_dwordx4 v[76:79], v6, s[60:63], s6 offen sc1
S_p2:
    s_lshl_b32 s74, s3, 7
    s_lshl_b32 s6, s4, 2
    s_add_u32 s74, s74, s6
    s_add_u32 s74, s74, 18006016
    v_mov_b32 v14, 0
    v_mov_b32 v15, 1
    s_waitcnt vmcnt(0)
    s_barrier
    s_cmp_lg_u32 s5, 0
    s_cbranch_scc1 G2_end
    s_mov_b64 exec, 1
    buffer_store_dword v15, v14, s[60:63], s74 offen sc1
    s_branch G2_end
G2x:
    s_mov_b64 exec, -1
G2:
    s_mov_b32 s60, s44
    s_mov_b32 s61, s45
    s_mov_b32 s62, 18021376
    s_mov_b32 s63, 0x00020000
    s_cmp_ge_u32 s47, 18
    s_cbranch_scc1 G2_end
    s_setprio 3
    s_and_b32 s6, s2, 7
    s_lshl_b32 s3, s6, 1
    s_and_b32 s7, s47, 1
    s_add_u32 s3, s3, s7
    s_lshr_b32 s4, s47, 1
    s_cmp_lt_u32 s5, 4
    s_cbranch_scc1 G2_c
    s_mov_b32 s52, s32
    s_mov_b32 s53, s33
    s_mov_b32 s54, 663552
    s_mov_b32 s55, 0x00020000
    s_mov_b32 s56, s34
    s_mov_b32 s57, s35
    s_mov_b32 s58, 663552
    s_mov_b32 s59, 0x00020000
    s_sub_u32 s6, s5, 4
    v_lshrrev_b32 v8, 3, v0
    v_lshrrev_b32 v9, 4, v0
    s_and_b32 s7, s6, 1
    s_lshl_b32 s7, s7, 2
    v_add_u32 v9, s7, v9
    v_and_b32 v10, 7, v0
    v_xor_b32 v9, v9, v10
    s_lshl_b32 s7, s6, 3
    v_add_u32 v8, s7, v8
    v_mul_u32_u24 v8, 1152, v8
    v_lshl_add_u32 v1, v9, 4, v8
    s_mul_i32 s69, s4, 73728
    s_lshl_b32 s76, s6, 10
    s_lshl_b32 s77, s6, 11
    v_lshrrev_b32 v8, 3, v0
    v_mul_u32_u24 v8, 18560, v8
    v_lshrrev_b32 v9, 2, v0
    v_and_b32 v9, 4, v9
    v_and_b32 v10, 7, v0
    v_xor_b32 v9, v9, v10
    s_lshl_b32 s7, s6, 3
    v_add_u32 v9, s7, v9
    v_lshl_add_u32 v4, v9, 4, v8
    s_mul_i32 s68, s3, 296960
    s_add_u32 s68, s68, 9961472
    s_cmp_lg_u32 s5, 4
    s_cbranch_scc1 G2_l
    s_load_dword s73, s[42:43], 132
    s_waitcnt lgkmcnt(0)
    s_cmp_ge_u32 s73, 16
    s_cbranch_scc1 G2_wi_c
    s_mov_b32 s80, s42
    s_mov_b32 s81, s43
    s_mov_b32 s82, 256
    s_mov_b32 s83, 0x00020000
    v_mov_b32 v14, 0
    s_mov_b32 exec_lo, 1
    s_mov_b32 exec_hi, 0
    s_mov_b32 s72, 0
G2_wi:
    buffer_load_dword v15, v14, s[80:83], 0 offen offset:132 sc1
    s_waitcnt vmcnt(0)
    v_cmp_gt_u32 vcc, 16, v15
    s_add_u32 s72, s72, 1
    s_cbranch_vccz G2_wi_ok
    s_sleep 8
    s_cmp_lt_u32 s72, 0x100000
    s_cbranch_scc1 G2_wi
G2_wi_ok:
    s_mov_b64 exec, -1
G2_wi_c:
    s_lshl_b32 s74, s3, 7
    s_add_u32 s74, s74, 18006016
    v_lshlrev_b32 v14, 2, v0
    s_mov_b32 exec_lo, 63
    s_mov_b32 exec_hi, 0
    s_mov_b32 s72, 0
G2_p:
    buffer_load_dword v15, v14, s[60:63], s74 offen sc1
    s_waitcnt vmcnt(0)
    v_cmp_gt_u32 vcc, 1, v15
    s_add_u32 s72, s72, 1
    s_cbranch_vccz G2_p_ok
    s_sleep 8
    s_cmp_lt_u32 s72, 0x100000
    s_cbranch_scc1 G2_p
G2_p_ok:
    s_mov_b64 exec, -1
G2_l:
    s_waitcnt vmcnt(0)
    s_barrier
    s_add_u32 m0, s76, 16384
    s_add_u32 s7, s69, 0
    buffer_load_dwordx4 v1, s[52:55], s7 offen lds
    s_add_u32 m0, s76, 20480
    s_add_u32 s7, s69, 36864
    buffer_load_dwordx4 v1, s[52:55], s7 offen lds
    s_add_u32 m0, s77, 0
    s_add_u32 s7, s68, 0
    buffer_load_dwordx4 v4, s[60:63], s7 offen sc1 lds
    s_add_u32 m0, s77, 1024
    s_add_u32 s7, s68, 148480
    buffer_load_dwordx4 v4, s[60:63], s7 offen sc1 lds
    s_add_u32 m0, s77, 8192
    s_add_u32 s7, s68, 512
    buffer_load_dwordx4 v4, s[60:63], s7 offen sc1 lds
    s_add_u32 m0, s77, 9216
    s_add_u32 s7, s68, 148992
    buffer_load_dwordx4 v4, s[60:63], s7 offen sc1 lds
    s_add_u32 m0, s76, 40960
    s_add_u32 s7, s69, 0
    buffer_load_dwordx4 v1, s[56:59], s7 offen lds
    s_add_u32 m0, s76, 45056
    s_add_u32 s7, s69, 36864
    buffer_load_dwordx4 v1, s[56:59], s7 offen lds
    s_add_u32 m0, s77, 24576
    s_add_u32 s7, s68, 9216
    buffer_load_dwordx4 v4, s[60:63], s7 offen sc1 lds
    s_add_u32 m0, s77, 25600
    s_add_u32 s7, s68, 157696
    buffer_load_dwordx4 v4, s[60:63], s7 offen sc1 lds
    s_add_u32 m0, s77, 32768
    s_add_u32 s7, s68, 9728
    buffer_load_dwordx4 v4, s[60:63], s7 offen sc1 lds
    s_add_u32 m0, s77, 33792
    s_add_u32 s7, s68, 158208
    buffer_load_dwordx4 v4, s[60:63], s7 offen sc1 lds
    s_waitcnt vmcnt(6)
    s_barrier
    s_add_u32 m0, s76, 65536
    s_add_u32 s7, s69, 128
    buffer_load_dwordx4 v1, s[52:55], s7 offen lds
    s_add_u32 m0, s76, 69632
    s_add_u32 s7, s69, 36992
    buffer_load_dwordx4 v1, s[52:55], s7 offen lds
    s_add_u32 m0, s77, 49152
    s_add_u32 s7, s68, 1024
    buffer_load_dwordx4 v4, s[60:63], s7 offen sc1 lds
    s_add_u32 m0, s77, 50176
    s_add_u32 s7, s68, 149504
    buffer_load_dwordx4 v4, s[60:63], s7 offen sc1 lds
    s_add_u32 m0, s77, 57344
    s_add_u32 s7, s68, 1536
    buffer_load_dwordx4 v4, s[60:63], s7 offen sc1 lds
    s_add_u32 m0, s77, 58368
    s_add_u32 s7, s68, 150016
    buffer_load_dwordx4 v4, s[60:63], s7 offen sc1 lds
    s_waitcnt vmcnt(6)
    s_barrier
    s_add_u32 m0, s76, 16384
    s_add_u32 s7, s69, 128
    buffer_load_dwordx4 v1, s[56:59], s7 offen lds
    s_add_u32 m0, s76, 20480
    s_add_u32 s7, s69, 36992
    buffer_load_dwordx4 v1, s[56:59], s7 offen lds
    s_add_u32 m0, s77, 0
    s_add_u32 s7, s68, 10240
    buffer_load_dwordx4 v4, s[60:63], s7 offen sc1 lds
    s_add_u32 m0, s77, 1024
    s_add_u32 s7, s68, 158720
    buffer_load_dwordx4 v4, s[60:63], s7 offen sc1 lds
    s_add_u32 m0, s77, 8192
    s_add_u32 s7, s68, 10752
    buffer_load_dwordx4 v4, s[60:63], s7 offen sc1 lds
    s_add_u32 m0, s77, 9216
    s_add_u32 s7, s68, 159232
    buffer_load_dwordx4 v4, s[60:63], s7 offen sc1 lds
    s_waitcnt vmcnt(6)
    s_barrier
    s_add_u32 m0, s76, 40960
    s_add_u32 s7, s69, 256
    buffer_load_dwordx4 v1, s[52:55], s7 offen lds
    s_add_u32 m0, s76, 45056
    s_add_u32 s7, s69, 37120
    buffer_load_dwordx4 v1, s[52:55], s7 offen lds
    s_add_u32 m0, s77, 24576
    s_add_u32 s7, s68, 2048
    buffer_load_dwordx4 v4, s[60:63], s7 offen sc1 lds
    s_add_u32 m0, s77, 25600
    s_add_u32 s7, s68, 150528
    buffer_load_dwordx4 v4, s[60:63], s7 offen sc1 lds
    s_add_u32 m0, s77, 32768
    s_add_u32 s7, s68, 2560
    buffer_load_dwordx4 v4, s[60:63], s7 offen sc1 lds
    s_add_u32 m0, s77, 33792
    s_add_u32 s7, s68, 151040
    buffer_load_dwordx4 v4, s[60:63], s7 offen sc1 lds
    s_waitcnt vmcnt(6)
    s_barrier
    s_add_u32 m0, s76, 65536
    s_add_u32 s7, s69, 256
    buffer_load_dwordx4 v1, s[56:59], s7 offen lds
    s_add_u32 m0, s76, 69632
    s_add_u32 s7, s69, 37120
    buffer_load_dwordx4 v1, s[56:59], s7 offen lds
    s_add_u32 m0, s77, 49152
    s_add_u32 s7, s68, 11264
    buffer_load_dwordx4 v4, s[60:63], s7 offen sc1 lds
    s_add_u32 m0, s77, 50176
    s_add_u32 s7, s68, 159744
    buffer_load_dwordx4 v4, s[60:63], s7 offen sc1 lds
    s_add_u32 m0, s77, 57344
    s_add_u32 s7, s68, 11776
    buffer_load_dwordx4 v4, s[60:63], s7 offen sc1 lds
    s_add_u32 m0, s77, 58368
    s_add_u32 s7, s68, 160256
    buffer_load_dwordx4 v4, s[60:63], s7 offen sc1 lds
    s_waitcnt vmcnt(6)
    s_barrier
    s_add_u32 m0, s76, 16384
    s_add_u32 s7, s69, 384
    buffer_load_dwordx4 v1, s[52:55], s7 offen lds
    s_add_u32 m0, s76, 20480
    s_add_u32 s7, s69, 37248
    buffer_load_dwordx4 v1, s[52:55], s7 offen lds
    s_add_u32 m0, s77, 0
    s_add_u32 s7, s68, 3072
    buffer_load_dwordx4 v4, s[60:63], s7 offen sc1 lds
    s_add_u32 m0, s77, 1024
    s_add_u32 s7, s68, 151552
    buffer_load_dwordx4 v4, s[60:63], s7 offen sc1 lds
    s_add_u32 m0, s77, 8192
    s_add_u32 s7, s68, 3584
    buffer_load_dwordx4 v4, s[60:63], s7 offen sc1 lds
    s_add_u32 m0, s77, 9216
    s_add_u32 s7, s68, 152064
    buffer_load_dwordx4 v4, s[60:63], s7 offen sc1 lds
    s_waitcnt vmcnt(6)
    s_barrier
    s_add_u32 m0, s76, 40960
    s_add_u32 s7, s69, 384
    buffer_load_dwordx4 v1, s[56:59], s7 offen lds
    s_add_u32 m0, s76, 45056
    s_add_u32 s7, s69, 37248
    buffer_load_dwordx4 v1, s[56:59], s7 offen lds
    s_add_u32 m0, s77, 24576
    s_add_u32 s7, s68, 12288
    buffer_load_dwordx4 v4, s[60:63], s7 offen sc1 lds
    s_add_u32 m0, s77, 25600
    s_add_u32 s7, s68, 160768
    buffer_load_dwordx4 v4, s[60:63], s7 offen sc1 lds
    s_add_u32 m0, s77, 32768
    s_add_u32 s7, s68, 12800
    buffer_load_dwordx4 v4, s[60:63], s7 offen sc1 lds
    s_add_u32 m0, s77, 33792
    s_add_u32 s7, s68, 161280
    buffer_load_dwordx4 v4, s[60:63], s7 offen sc1 lds
    s_waitcnt vmcnt(6)
    s_barrier
    s_add_u32 m0, s76, 65536
    s_add_u32 s7, s69, 512
    buffer_load_dwordx4 v1, s[52:55], s7 offen lds
    s_add_u32 m0, s76, 69632
    s_add_u32 s7, s69, 37376
    buffer_load_dwordx4 v1, s[52:55], s7 offen lds
    s_add_u32 m0, s77, 49152
    s_add_u32 s7, s68, 4096
    buffer_load_dwordx4 v4, s[60:63], s7 offen sc1 lds
    s_add_u32 m0, s77, 50176
    s_add_u32 s7, s68, 152576
    buffer_load_dwordx4 v4, s[60:63], s7 offen sc1 lds
    s_add_u32 m0, s77, 57344
    s_add_u32 s7, s68, 4608
    buffer_load_dwordx4 v4, s[60:63], s7 offen sc1 lds
    s_add_u32 m0, s77, 58368
    s_add_u32 s7, s68, 153088
    buffer_load_dwordx4 v4, s[60:63], s7 offen sc1 lds
    s_waitcnt vmcnt(6)
    s_barrier
    s_add_u32 m0, s76, 16384
    s_add_u32 s7, s69, 512
    buffer_load_dwordx4 v1, s[56:59], s7 offen lds
    s_add_u32 m0, s76, 20480
    s_add_u32 s7, s69, 37376
    buffer_load_dwordx4 v1, s[56:59], s7 offen lds
    s_add_u32 m0, s77, 0
    s_add_u32 s7, s68, 13312
    buffer_load_dwordx4 v4, s[60:63], s7 offen sc1 lds
    s_add_u32 m0, s77, 1024
    s_add_u32 s7, s68, 161792
    buffer_load_dwordx4 v4, s[60:63], s7 offen sc1 lds
    s_add_u32 m0, s77, 8192
    s_add_u32 s7, s68, 13824
    buffer_load_dwordx4 v4, s[60:63], s7 offen sc1 lds
    s_add_u32 m0, s77, 9216
    s_add_u32 s7, s68, 162304
    buffer_load_dwordx4 v4, s[60:63], s7 offen sc1 lds
    s_waitcnt vmcnt(6)
    s_barrier
    s_add_u32 m0, s76, 40960
    s_add_u32 s7, s69, 640
    buffer_load_dwordx4 v1, s[52:55], s7 offen lds
    s_add_u32 m0, s76, 45056
    s_add_u32 s7, s69, 37504
    buffer_load_dwordx4 v1, s[52:55], s7 offen lds
    s_add_u32 m0, s77, 24576
    s_add_u32 s7, s68, 5120
    buffer_load_dwordx4 v4, s[60:63], s7 offen sc1 lds
    s_add_u32 m0, s77, 25600
    s_add_u32 s7, s68, 153600
    buffer_load_dwordx4 v4, s[60:63], s7 offen sc1 lds
    s_add_u32 m0, s77, 32768
    s_add_u32 s7, s68, 5632
    buffer_load_dwordx4 v4, s[60:63], s7 offen sc1 lds
    s_add_u32 m0, s77, 33792
    s_add_u32 s7, s68, 154112
    buffer_load_dwordx4 v4, s[60:63], s7 offen sc1 lds
    s_waitcnt vmcnt(6)
    s_barrier
    s_add_u32 m0, s76, 65536
    s_add_u32 s7, s69, 640
    buffer_load_dwordx4 v1, s[56:59], s7 offen lds
    s_add_u32 m0, s76, 69632
    s_add_u32 s7, s69, 37504
    buffer_load_dwordx4 v1, s[56:59], s7 offen lds
    s_add_u32 m0, s77, 49152
    s_add_u32 s7, s68, 14336
    buffer_load_dwordx4 v4, s[60:63], s7 offen sc1 lds
    s_add_u32 m0, s77, 50176
    s_add_u32 s7, s68, 162816
    buffer_load_dwordx4 v4, s[60:63], s7 offen sc1 lds
    s_add_u32 m0, s77, 57344
    s_add_u32 s7, s68, 14848
    buffer_load_dwordx4 v4, s[60:63], s7 offen sc1 lds
    s_add_u32 m0, s77, 58368
    s_add_u32 s7, s68, 163328
    buffer_load_dwordx4 v4, s[60:63], s7 offen sc1 lds
    s_waitcnt vmcnt(6)
    s_barrier
    s_add_u32 m0, s76, 16384
    s_add_u32 s7, s69, 768
    buffer_load_dwordx4 v1, s[52:55], s7 offen lds
    s_add_u32 m0, s76, 20480
    s_add_u32 s7, s69, 37632
    buffer_load_dwordx4 v1, s[52:55], s7 offen lds
    s_add_u32 m0, s77, 0
    s_add_u32 s7, s68, 6144
    buffer_load_dwordx4 v4, s[60:63], s7 offen sc1 lds
    s_add_u32 m0, s77, 1024
    s_add_u32 s7, s68, 154624
    buffer_load_dwordx4 v4, s[60:63], s7 offen sc1 lds
    s_add_u32 m0, s77, 8192
    s_add_u32 s7, s68, 6656
    buffer_load_dwordx4 v4, s[60:63], s7 offen sc1 lds
    s_add_u32 m0, s77, 9216
    s_add_u32 s7, s68, 155136
    buffer_load_dwordx4 v4, s[60:63], s7 offen sc1 lds
    s_waitcnt vmcnt(6)
    s_barrier
    s_add_u32 m0, s76, 40960
    s_add_u32 s7, s69, 768
    buffer_load_dwordx4 v1, s[56:59], s7 offen lds
    s_add_u32 m0, s76, 45056
    s_add_u32 s7, s69, 37632
    buffer_load_dwordx4 v1, s[56:59], s7 offen lds
    s_add_u32 m0, s77, 24576
    s_add_u32 s7, s68, 15360
    buffer_load_dwordx4 v4, s[60:63], s7 offen sc1 lds
    s_add_u32 m0, s77, 25600
    s_add_u32 s7, s68, 163840
    buffer_load_dwordx4 v4, s[60:63], s7 offen sc1 lds
    s_add_u32 m0, s77, 32768
    s_add_u32 s7, s68, 15872
    buffer_load_dwordx4 v4, s[60:63], s7 offen sc1 lds
    s_add_u32 m0, s77, 33792
    s_add_u32 s7, s68, 164352
    buffer_load_dwordx4 v4, s[60:63], s7 offen sc1 lds
    s_waitcnt vmcnt(6)
    s_barrier
    s_add_u32 m0, s76, 65536
    s_add_u32 s7, s69, 896
    buffer_load_dwordx4 v1, s[52:55], s7 offen lds
    s_add_u32 m0, s76, 69632
    s_add_u32 s7, s69, 37760
    buffer_load_dwordx4 v1, s[52:55], s7 offen lds
    s_add_u32 m0, s77, 49152
    s_add_u32 s7, s68, 7168
    buffer_load_dwordx4 v4, s[60:63], s7 offen sc1 lds
    s_add_u32 m0, s77, 50176
    s_add_u32 s7, s68, 155648
    buffer_load_dwordx4 v4, s[60:63], s7 offen sc1 lds
    s_add_u32 m0, s77, 57344
    s_add_u32 s7, s68, 7680
    buffer_load_dwordx4 v4, s[60:63], s7 offen sc1 lds
    s_add_u32 m0, s77, 58368
    s_add_u32 s7, s68, 156160
    buffer_load_dwordx4 v4, s[60:63], s7 offen sc1 lds
    s_waitcnt vmcnt(6)
    s_barrier
    s_add_u32 m0, s76, 16384
    s_add_u32 s7, s69, 896
    buffer_load_dwordx4 v1, s[56:59], s7 offen lds
    s_add_u32 m0, s76, 20480
    s_add_u32 s7, s69, 37760
    buffer_load_dwordx4 v1, s[56:59], s7 offen lds
    s_add_u32 m0, s77, 0
    s_add_u32 s7, s68, 16384
    buffer_load_dwordx4 v4, s[60:63], s7 offen sc1 lds
    s_add_u32 m0, s77, 1024
    s_add_u32 s7, s68, 164864
    buffer_load_dwordx4 v4, s[60:63], s7 offen sc1 lds
    s_add_u32 m0, s77, 8192
    s_add_u32 s7, s68, 16896
    buffer_load_dwordx4 v4, s[60:63], s7 offen sc1 lds
    s_add_u32 m0, s77, 9216
    s_add_u32 s7, s68, 165376
    buffer_load_dwordx4 v4, s[60:63], s7 offen sc1 lds
    s_waitcnt vmcnt(6)
    s_barrier
    s_add_u32 m0, s76, 40960
    s_add_u32 s7, s69, 1024
    buffer_load_dwordx4 v1, s[52:55], s7 offen lds
    s_add_u32 m0, s76, 45056
    s_add_u32 s7, s69, 37888
    buffer_load_dwordx4 v1, s[52:55], s7 offen lds
    s_add_u32 m0, s77, 24576
    s_add_u32 s7, s68, 8192
    buffer_load_dwordx4 v4, s[60:63], s7 offen sc1 lds
    s_add_u32 m0, s77, 25600
    s_add_u32 s7, s68, 156672
    buffer_load_dwordx4 v4, s[60:63], s7 offen sc1 lds
    s_add_u32 m0, s77, 32768
    s_add_u32 s7, s68, 8704
    buffer_load_dwordx4 v4, s[60:63], s7 offen sc1 lds
    s_add_u32 m0, s77, 33792
    s_add_u32 s7, s68, 157184
    buffer_load_dwordx4 v4, s[60:63], s7 offen sc1 lds
    s_waitcnt vmcnt(6)
    s_barrier
    s_add_u32 m0, s76, 65536
    s_add_u32 s7, s69, 1024
    buffer_load_dwordx4 v1, s[56:59], s7 offen lds
    s_add_u32 m0, s76, 69632
    s_add_u32 s7, s69, 37888
    buffer_load_dwordx4 v1, s[56:59], s7 offen lds
    s_add_u32 m0, s77, 49152
    s_add_u32 s7, s68, 17408
    buffer_load_dwordx4 v4, s[60:63], s7 offen sc1 lds
    s_add_u32 m0, s77, 50176
    s_add_u32 s7, s68, 165888
    buffer_load_dwordx4 v4, s[60:63], s7 offen sc1 lds
    s_add_u32 m0, s77, 57344
    s_add_u32 s7, s68, 17920
    buffer_load_dwordx4 v4, s[60:63], s7 offen sc1 lds
    s_add_u32 m0, s77, 58368
    s_add_u32 s7, s68, 166400
    buffer_load_dwordx4 v4, s[60:63], s7 offen sc1 lds
    s_waitcnt vmcnt(6)
    s_barrier
    s_waitcnt vmcnt(0)
    s_barrier
    s_endpgm
G2_c:
    v_and_b32 v1, 31, v0
    v_lshrrev_b32 v2, 5, v0
    s_mov_b32 s8, 0
    s_mov_b32 s9, -1
    s_mov_b32 s10, 0xffff0000
    s_mov_b32 s11, 0xffff0000
    s_and_b32 s14, s5, 1
    s_lshr_b32 s15, s5, 1
    s_lshl_b32 s79, s3, 1
    s_add_u32 s79, s79, s14
    s_lshl_b32 s46, s4, 1
    s_add_u32 s46, s46, s15
    s_lshl_b32 s46, s46, 5
    v_lshlrev_b32 v3, 3, v2
    s_lshl_b32 s6, s46, 1
    v_add_u32 v3, s6, v3
    s_lshl_b32 s6, s79, 6
    v_add_u32 v4, s6, v1
    v_mul_u32_u24 v4, 1152, v4
    v_add_u32 v4, v4, v3
    v_add_u32 v5, 36864, v4
    global_load_dwordx2 v[96:97], v3, s[38:39] offset:0
    global_load_dwordx2 v[98:99], v3, s[38:39] offset:16
    global_load_dwordx2 v[100:101], v3, s[38:39] offset:32
    global_load_dwordx2 v[102:103], v3, s[38:39] offset:48
    global_load_dwordx2 v[104:105], v4, s[22:23] offset:0
    global_load_dwordx2 v[106:107], v4, s[22:23] offset:16
    global_load_dwordx2 v[108:109], v4, s[22:23] offset:32
    global_load_dwordx2 v[110:111], v4, s[22:23] offset:48
    global_load_dwordx2 v[112:113], v5, s[22:23] offset:0
    global_load_dwordx2 v[114:115], v5, s[22:23] offset:16
    global_load_dwordx2 v[116:117], v5, s[22:23] offset:32
    global_load_dwordx2 v[118:119], v5, s[22:23] offset:48
    s_mov_b32 s64, s40
    s_mov_b32 s65, s41
    s_mov_b32 s66, 9437184
    s_mov_b32 s67, 0x00020000
    v_bfe_u32 v6, v0, 4, 1
    v_mul_u32_u24 v6, 320, v6
    v_lshl_add_u32 v6, v2, 11, v6
    s_lshl_b32 s7, s14, 10
    v_add_u32 v6, s7, v6
    v_and_b32 v7, 2, v0
    v_lshl_add_u32 v6, v7, 6, v6
    v_and_b32 v7, 12, v0
    v_lshl_add_u32 v6, v7, 2, v6
    v_and_b32 v7, 1, v0
    v_lshl_add_u32 v24, v7, 3, v6
    v_xor_b32 v25, 64, v24
    s_lshl_b32 s7, s15, 12
    s_add_u32 s7, s7, 16384
    v_bfe_u32 v8, v1, 1, 3
    v_xor_b32 v8, v8, v2
    v_lshlrev_b32 v8, 4, v8
    v_lshl_add_u32 v8, v1, 7, v8
    v_add_u32 v20, s7, v8
    v_xor_b32 v21, 32, v20
    v_xor_b32 v22, 64, v20
    v_xor_b32 v23, 96, v20
    s_mul_i32 s7, s5, 8192
    s_cmp_eq_u32 s5, 3
    s_cselect_b32 s7, 73728, s7
    v_and_b32 v3, 7, v1
    v_xor_b32 v3, v3, v2
    v_lshlrev_b32 v3, 4, v3
    v_lshl_add_u32 v3, v1, 7, v3
    v_add_u32 v6, s7, v3
    v_xor_b32 v7, 32, v6
    v_xor_b32 v8, 64, v6
    v_xor_b32 v9, 96, v6
    v_lshrrev_b32 v3, 3, v0
    v_and_b32 v5, 7, v0
    v_xor_b32 v4, v3, v5
    v_lshlrev_b32 v4, 4, v4
    v_lshl_add_u32 v4, v3, 7, v4
    v_add_u32 v4, s7, v4
    v_mul_u32_u24 v10, 4608, v3
    v_lshl_add_u32 v10, v5, 4, v10
    v_add_u32 v11, 36864, v10
    v_add_u32 v12, 73728, v10
    v_add_u32 v13, 110592, v10
    s_mul_i32 s6, s79, 294912
    s_lshl_b32 s7, s46, 2
    s_add_u32 s6, s6, s7
    s_add_u32 s12, s6, 2304
    s_add_u32 s13, s12, 147456
    s_mov_b32 s14, 0xffff0000
    s_waitcnt vmcnt(0)
    v_lshlrev_b32 v32, 16, v96
    v_and_b32 v33, s14, v96
    v_lshlrev_b32 v34, 16, v97
    v_and_b32 v35, s14, v97
    v_lshlrev_b32 v36, 16, v98
    v_and_b32 v37, s14, v98
    v_lshlrev_b32 v38, 16, v99
    v_and_b32 v39, s14, v99
    v_lshlrev_b32 v40, 16, v100
    v_and_b32 v41, s14, v100
    v_lshlrev_b32 v42, 16, v101
    v_and_b32 v43, s14, v101
    v_lshlrev_b32 v44, 16, v102
    v_and_b32 v45, s14, v102
    v_lshlrev_b32 v46, 16, v103
    v_and_b32 v47, s14, v103
    v_lshlrev_b32 v64, 16, v104
    v_and_b32 v65, s14, v104
    v_mul_f32 v64, v64, v32
    v_mul_f32 v65, v65, v33
    v_lshlrev_b32 v66, 16, v105
    v_and_b32 v67, s14, v105
    v_mul_f32 v66, v66, v34
    v_mul_f32 v67, v67, v35
    v_lshlrev_b32 v68, 16, v106
    v_and_b32 v69, s14, v106
    v_mul_f32 v68, v68, v36
    v_mul_f32 v69, v69, v37
    v_lshlrev_b32 v70, 16, v107
    v_and_b32 v71, s14, v107
    v_mul_f32 v70, v70, v38
    v_mul_f32 v71, v71, v39
    v_lshlrev_b32 v72, 16, v108
    v_and_b32 v73, s14, v108
    v_mul_f32 v72, v72, v40
    v_mul_f32 v73, v73, v41
    v_lshlrev_b32 v74, 16, v109
    v_and_b32 v75, s14, v109
    v_mul_f32 v74, v74, v42
    v_mul_f32 v75, v75, v43
    v_lshlrev_b32 v76, 16, v110
    v_and_b32 v77, s14, v110
    v_mul_f32 v76, v76, v44
    v_mul_f32 v77, v77, v45
    v_lshlrev_b32 v78, 16, v111
    v_and_b32 v79, s14, v111
    v_mul_f32 v78, v78, v46
    v_mul_f32 v79, v79, v47
    v_lshlrev_b32 v80, 16, v112
    v_and_b32 v81, s14, v112
    v_mul_f32 v80, v80, v32
    v_mul_f32 v81, v81, v33
    v_lshlrev_b32 v82, 16, v113
    v_and_b32 v83, s14, v113
    v_mul_f32 v82, v82, v34
    v_mul_f32 v83, v83, v35
    v_lshlrev_b32 v84, 16, v114
    v_and_b32 v85, s14, v114
    v_mul_f32 v84, v84, v36
    v_mul_f32 v85, v85, v37
    v_lshlrev_b32 v86, 16, v115
    v_and_b32 v87, s14, v115
    v_mul_f32 v86, v86, v38
    v_mul_f32 v87, v87, v39
    v_lshlrev_b32 v88, 16, v116
    v_and_b32 v89, s14, v116
    v_mul_f32 v88, v88, v40
    v_mul_f32 v89, v89, v41
    v_lshlrev_b32 v90, 16, v117
    v_and_b32 v91, s14, v117
    v_mul_f32 v90, v90, v42
    v_mul_f32 v91, v91, v43
    v_lshlrev_b32 v92, 16, v118
    v_and_b32 v93, s14, v118
    v_mul_f32 v92, v92, v44
    v_mul_f32 v93, v93, v45
    v_lshlrev_b32 v94, 16, v119
    v_and_b32 v95, s14, v119
    v_mul_f32 v94, v94, v46
    v_mul_f32 v95, v95, v47
    s_setprio 0
    s_barrier
    s_waitcnt lgkmcnt(0)
    s_barrier
    ds_read_b128 v[28:31], v20
    ds_read_b64_tr_b16 v[32:33], v24 offset:0
    ds_read_b64_tr_b16 v[34:35], v25 offset:0
    ds_read_b64_tr_b16 v[36:37], v24 offset:512
    ds_read_b64_tr_b16 v[38:39], v25 offset:512
    v_add_u32 v20, 24576, v20
    ds_read_b128 v[40:43], v21
    ds_read_b64_tr_b16 v[44:45], v24 offset:4096
    ds_read_b64_tr_b16 v[46:47], v25 offset:4096
    ds_read_b64_tr_b16 v[48:49], v24 offset:4608
    ds_read_b64_tr_b16 v[50:51], v25 offset:4608
    v_add_u32 v21, 24576, v21
    s_waitcnt lgkmcnt(7)
    v_mfma_f32_32x32x16_bf16 v[64:79], v[28:31], v[32:35], v[64:79]
    ds_read_b128 v[52:55], v22
    ds_read_b64_tr_b16 v[56:57], v24 offset:8192
    ds_read_b64_tr_b16 v[58:59], v25 offset:8192
    s_waitcnt lgkmcnt(8)
    v_mfma_f32_32x32x16_bf16 v[80:95], v[28:31], v[36:39], v[80:95]
    ds_read_b64_tr_b16 v[60:61], v24 offset:8704
    ds_read_b64_tr_b16 v[62:63], v25 offset:8704
    v_add_u32 v22, 24576, v22
    s_waitcnt lgkmcnt(7)
    v_mfma_f32_32x32x16_bf16 v[64:79], v[40:43], v[44:47], v[64:79]
    ds_read_b128 v[28:31], v23
    ds_read_b64_tr_b16 v[32:33], v24 offset:12288
    ds_read_b64_tr_b16 v[34:35], v25 offset:12288
    s_waitcnt lgkmcnt(8)
    v_mfma_f32_32x32x16_bf16 v[80:95], v[40:43], v[48:51], v[80:95]
    ds_read_b64_tr_b16 v[36:37], v24 offset:12800
    ds_read_b64_tr_b16 v[38:39], v25 offset:12800
    v_add_u32 v23, 24576, v23
    v_add_u32 v24, 24576, v24
    v_add_u32 v25, 24576, v25
    s_waitcnt lgkmcnt(7)
    v_mfma_f32_32x32x16_bf16 v[64:79], v[52:55], v[56:59], v[64:79]
    s_waitcnt lgkmcnt(0)
    s_barrier
    ds_read_b128 v[40:43], v20
    ds_read_b64_tr_b16 v[44:45], v24 offset:0
    ds_read_b64_tr_b16 v[46:47], v25 offset:0
    s_waitcnt lgkmcnt(8)
    v_mfma_f32_32x32x16_bf16 v[80:95], v[52:55], v[60:63], v[80:95]
    ds_read_b64_tr_b16 v[48:49], v24 offset:512
    ds_read_b64_tr_b16 v[50:51], v25 offset:512
    v_add_u32 v20, 24576, v20
    s_waitcnt lgkmcnt(7)
    v_mfma_f32_32x32x16_bf16 v[64:79], v[28:31], v[32:35], v[64:79]
    ds_read_b128 v[52:55], v21
    ds_read_b64_tr_b16 v[56:57], v24 offset:4096
    ds_read_b64_tr_b16 v[58:59], v25 offset:4096
    s_waitcnt lgkmcnt(8)
    v_mfma_f32_32x32x16_bf16 v[80:95], v[28:31], v[36:39], v[80:95]
    ds_read_b64_tr_b16 v[60:61], v24 offset:4608
    ds_read_b64_tr_b16 v[62:63], v25 offset:4608
    v_add_u32 v21, 24576, v21
    s_waitcnt lgkmcnt(7)
    v_mfma_f32_32x32x16_bf16 v[64:79], v[40:43], v[44:47], v[64:79]
    ds_read_b128 v[28:31], v22
    ds_read_b64_tr_b16 v[32:33], v24 offset:8192
    ds_read_b64_tr_b16 v[34:35], v25 offset:8192
    s_waitcnt lgkmcnt(8)
    v_mfma_f32_32x32x16_bf16 v[80:95], v[40:43], v[48:51], v[80:95]
    ds_read_b64_tr_b16 v[36:37], v24 offset:8704
    ds_read_b64_tr_b16 v[38:39], v25 offset:8704
    v_add_u32 v22, 24576, v22
    s_waitcnt lgkmcnt(7)
    v_mfma_f32_32x32x16_bf16 v[64:79], v[52:55], v[56:59], v[64:79]
    ds_read_b128 v[40:43], v23
    ds_read_b64_tr_b16 v[44:45], v24 offset:12288
    ds_read_b64_tr_b16 v[46:47], v25 offset:12288
    s_waitcnt lgkmcnt(8)
    v_mfma_f32_32x32x16_bf16 v[80:95], v[52:55], v[60:63], v[80:95]
    ds_read_b64_tr_b16 v[48:49], v24 offset:12800
    ds_read_b64_tr_b16 v[50:51], v25 offset:12800
    v_add_u32 v23, 24576, v23
    v_add_u32 v24, 24576, v24
    v_add_u32 v25, 24576, v25
    s_waitcnt lgkmcnt(7)
    v_mfma_f32_32x32x16_bf16 v[64:79], v[28:31], v[32:35], v[64:79]
    s_waitcnt lgkmcnt(0)
    s_barrier
    ds_read_b128 v[52:55], v20
    ds_read_b64_tr_b16 v[56:57], v24 offset:0
    ds_read_b64_tr_b16 v[58:59], v25 offset:0
    s_waitcnt lgkmcnt(8)
    v_mfma_f32_32x32x16_bf16 v[80:95], v[28:31], v[36:39], v[80:95]
    ds_read_b64_tr_b16 v[60:61], v24 offset:512
    ds_read_b64_tr_b16 v[62:63], v25 offset:512
    v_add_u32 v20, 4294918144, v20
    s_waitcnt lgkmcnt(7)
    v_mfma_f32_32x32x16_bf16 v[64:79], v[40:43], v[44:47], v[64:79]
    ds_read_b128 v[28:31], v21
    ds_read_b64_tr_b16 v[32:33], v24 offset:4096
    ds_read_b64_tr_b16 v[34:35], v25 offset:4096
    s_waitcnt lgkmcnt(8)
    v_mfma_f32_32x32x16_bf16 v[80:95], v[40:43], v[48:51], v[80:95]
    ds_read_b64_tr_b16 v[36:37], v24 offset:4608
    ds_read_b64_tr_b16 v[38:39], v25 offset:4608
    v_add_u32 v21, 4294918144, v21
    s_waitcnt lgkmcnt(7)
    v_mfma_f32_32x32x16_bf16 v[64:79], v[52:55], v[56:59], v[64:79]
    ds_read_b128 v[40:43], v22
    ds_read_b64_tr_b16 v[44:45], v24 offset:8192
    ds_read_b64_tr_b16 v[46:47], v25 offset:8192
    s_waitcnt lgkmcnt(8)
    v_mfma_f32_32x32x16_bf16 v[80:95], v[52:55], v[60:63], v[80:95]
    ds_read_b64_tr_b16 v[48:49], v24 offset:8704
    ds_read_b64_tr_b16 v[50:51], v25 offset:8704
    v_add_u32 v22, 4294918144, v22
    s_waitcnt lgkmcnt(7)
    v_mfma_f32_32x32x16_bf16 v[64:79], v[28:31], v[32:35], v[64:79]
    ds_read_b128 v[52:55], v23
    ds_read_b64_tr_b16 v[56:57], v24 offset:12288
    ds_read_b64_tr_b16 v[58:59], v25 offset:12288
    s_waitcnt lgkmcnt(8)
    v_mfma_f32_32x32x16_bf16 v[80:95], v[28:31], v[36:39], v[80:95]
    ds_read_b64_tr_b16 v[60:61], v24 offset:12800
    ds_read_b64_tr_b16 v[62:63], v25 offset:12800
    v_add_u32 v23, 4294918144, v23
    v_add_u32 v24, 4294918144, v24
    v_add_u32 v25, 4294918144, v25
    s_waitcnt lgkmcnt(7)
    v_mfma_f32_32x32x16_bf16 v[64:79], v[40:43], v[44:47], v[64:79]
    s_waitcnt lgkmcnt(0)
    s_barrier
    ds_read_b128 v[28:31], v20
    ds_read_b64_tr_b16 v[32:33], v24 offset:0
    ds_read_b64_tr_b16 v[34:35], v25 offset:0
    s_waitcnt lgkmcnt(8)
    v_mfma_f32_32x32x16_bf16 v[80:95], v[40:43], v[48:51], v[80:95]
    ds_read_b64_tr_b16 v[36:37], v24 offset:512
    ds_read_b64_tr_b16 v[38:39], v25 offset:512
    v_add_u32 v20, 24576, v20
    s_waitcnt lgkmcnt(7)
    v_mfma_f32_32x32x16_bf16 v[64:79], v[52:55], v[56:59], v[64:79]
    ds_read_b128 v[40:43], v21
    ds_read_b64_tr_b16 v[44:45], v24 offset:4096
    ds_read_b64_tr_b16 v[46:47], v25 offset:4096
    s_waitcnt lgkmcnt(8)
    v_mfma_f32_32x32x16_bf16 v[80:95], v[52:55], v[60:63], v[80:95]
    ds_read_b64_tr_b16 v[48:49], v24 offset:4608
    ds_read_b64_tr_b16 v[50:51], v25 offset:4608
    v_add_u32 v21, 24576, v21
    s_waitcnt lgkmcnt(7)
    v_mfma_f32_32x32x16_bf16 v[64:79], v[28:31], v[32:35], v[64:79]
    ds_read_b128 v[52:55], v22
    ds_read_b64_tr_b16 v[56:57], v24 offset:8192
    ds_read_b64_tr_b16 v[58:59], v25 offset:8192
    s_waitcnt lgkmcnt(8)
    v_mfma_f32_32x32x16_bf16 v[80:95], v[28:31], v[36:39], v[80:95]
    ds_read_b64_tr_b16 v[60:61], v24 offset:8704
    ds_read_b64_tr_b16 v[62:63], v25 offset:8704
    v_add_u32 v22, 24576, v22
    s_waitcnt lgkmcnt(7)
    v_mfma_f32_32x32x16_bf16 v[64:79], v[40:43], v[44:47], v[64:79]
    ds_read_b128 v[28:31], v23
    ds_read_b64_tr_b16 v[32:33], v24 offset:12288
    ds_read_b64_tr_b16 v[34:35], v25 offset:12288
    s_waitcnt lgkmcnt(8)
    v_mfma_f32_32x32x16_bf16 v[80:95], v[40:43], v[48:51], v[80:95]
    ds_read_b64_tr_b16 v[36:37], v24 offset:12800
    ds_read_b64_tr_b16 v[38:39], v25 offset:12800
    v_add_u32 v23, 24576, v23
    v_add_u32 v24, 24576, v24
    v_add_u32 v25, 24576, v25
    s_waitcnt lgkmcnt(7)
    v_mfma_f32_32x32x16_bf16 v[64:79], v[52:55], v[56:59], v[64:79]
    s_waitcnt lgkmcnt(0)
    s_barrier
    ds_read_b128 v[40:43], v20
    ds_read_b64_tr_b16 v[44:45], v24 offset:0
    ds_read_b64_tr_b16 v[46:47], v25 offset:0
    s_waitcnt lgkmcnt(8)
    v_mfma_f32_32x32x16_bf16 v[80:95], v[52:55], v[60:63], v[80:95]
    ds_read_b64_tr_b16 v[48:49], v24 offset:512
    ds_read_b64_tr_b16 v[50:51], v25 offset:512
    v_add_u32 v20, 24576, v20
    s_waitcnt lgkmcnt(7)
    v_mfma_f32_32x32x16_bf16 v[64:79], v[28:31], v[32:35], v[64:79]
    ds_read_b128 v[52:55], v21
    ds_read_b64_tr_b16 v[56:57], v24 offset:4096
    ds_read_b64_tr_b16 v[58:59], v25 offset:4096
    s_waitcnt lgkmcnt(8)
    v_mfma_f32_32x32x16_bf16 v[80:95], v[28:31], v[36:39], v[80:95]
    ds_read_b64_tr_b16 v[60:61], v24 offset:4608
    ds_read_b64_tr_b16 v[62:63], v25 offset:4608
    v_add_u32 v21, 24576, v21
    s_waitcnt lgkmcnt(7)
    v_mfma_f32_32x32x16_bf16 v[64:79], v[40:43], v[44:47], v[64:79]
    ds_read_b128 v[28:31], v22
    ds_read_b64_tr_b16 v[32:33], v24 offset:8192
    ds_read_b64_tr_b16 v[34:35], v25 offset:8192
    s_waitcnt lgkmcnt(8)
    v_mfma_f32_32x32x16_bf16 v[80:95], v[40:43], v[48:51], v[80:95]
    ds_read_b64_tr_b16 v[36:37], v24 offset:8704
    ds_read_b64_tr_b16 v[38:39], v25 offset:8704
    v_add_u32 v22, 24576, v22
    s_waitcnt lgkmcnt(7)
    v_mfma_f32_32x32x16_bf16 v[64:79], v[52:55], v[56:59], v[64:79]
    ds_read_b128 v[40:43], v23
    ds_read_b64_tr_b16 v[44:45], v24 offset:12288
    ds_read_b64_tr_b16 v[46:47], v25 offset:12288
    s_waitcnt lgkmcnt(8)
    v_mfma_f32_32x32x16_bf16 v[80:95], v[52:55], v[60:63], v[80:95]
    ds_read_b64_tr_b16 v[48:49], v24 offset:12800
    ds_read_b64_tr_b16 v[50:51], v25 offset:12800
    v_add_u32 v23, 24576, v23
    v_add_u32 v24, 24576, v24
    v_add_u32 v25, 24576, v25
    s_waitcnt lgkmcnt(7)
    v_mfma_f32_32x32x16_bf16 v[64:79], v[28:31], v[32:35], v[64:79]
    s_waitcnt lgkmcnt(0)
    s_barrier
    ds_read_b128 v[52:55], v20
    ds_read_b64_tr_b16 v[56:57], v24 offset:0
    ds_read_b64_tr_b16 v[58:59], v25 offset:0
    s_waitcnt lgkmcnt(8)
    v_mfma_f32_32x32x16_bf16 v[80:95], v[28:31], v[36:39], v[80:95]
    ds_read_b64_tr_b16 v[60:61], v24 offset:512
    ds_read_b64_tr_b16 v[62:63], v25 offset:512
    v_add_u32 v20, 4294918144, v20
    s_waitcnt lgkmcnt(7)
    v_mfma_f32_32x32x16_bf16 v[64:79], v[40:43], v[44:47], v[64:79]
    ds_read_b128 v[28:31], v21
    ds_read_b64_tr_b16 v[32:33], v24 offset:4096
    ds_read_b64_tr_b16 v[34:35], v25 offset:4096
    s_waitcnt lgkmcnt(8)
    v_mfma_f32_32x32x16_bf16 v[80:95], v[40:43], v[48:51], v[80:95]
    ds_read_b64_tr_b16 v[36:37], v24 offset:4608
    ds_read_b64_tr_b16 v[38:39], v25 offset:4608
    v_add_u32 v21, 4294918144, v21
    s_waitcnt lgkmcnt(7)
    v_mfma_f32_32x32x16_bf16 v[64:79], v[52:55], v[56:59], v[64:79]
    ds_read_b128 v[40:43], v22
    ds_read_b64_tr_b16 v[44:45], v24 offset:8192
    ds_read_b64_tr_b16 v[46:47], v25 offset:8192
    s_waitcnt lgkmcnt(8)
    v_mfma_f32_32x32x16_bf16 v[80:95], v[52:55], v[60:63], v[80:95]
    ds_read_b64_tr_b16 v[48:49], v24 offset:8704
    ds_read_b64_tr_b16 v[50:51], v25 offset:8704
    v_add_u32 v22, 4294918144, v22
    s_waitcnt lgkmcnt(7)
    v_mfma_f32_32x32x16_bf16 v[64:79], v[28:31], v[32:35], v[64:79]
    ds_read_b128 v[52:55], v23
    ds_read_b64_tr_b16 v[56:57], v24 offset:12288
    ds_read_b64_tr_b16 v[58:59], v25 offset:12288
    s_waitcnt lgkmcnt(8)
    v_mfma_f32_32x32x16_bf16 v[80:95], v[28:31], v[36:39], v[80:95]
    ds_read_b64_tr_b16 v[60:61], v24 offset:12800
    ds_read_b64_tr_b16 v[62:63], v25 offset:12800
    v_add_u32 v23, 4294918144, v23
    v_add_u32 v24, 4294918144, v24
    v_add_u32 v25, 4294918144, v25
    s_waitcnt lgkmcnt(7)
    v_mfma_f32_32x32x16_bf16 v[64:79], v[40:43], v[44:47], v[64:79]
    s_waitcnt lgkmcnt(0)
    s_barrier
    ds_read_b128 v[28:31], v20
    ds_read_b64_tr_b16 v[32:33], v24 offset:0
    ds_read_b64_tr_b16 v[34:35], v25 offset:0
    s_waitcnt lgkmcnt(8)
    v_mfma_f32_32x32x16_bf16 v[80:95], v[40:43], v[48:51], v[80:95]
    ds_read_b64_tr_b16 v[36:37], v24 offset:512
    ds_read_b64_tr_b16 v[38:39], v25 offset:512
    v_add_u32 v20, 24576, v20
    s_waitcnt lgkmcnt(7)
    v_mfma_f32_32x32x16_bf16 v[64:79], v[52:55], v[56:59], v[64:79]
    ds_read_b128 v[40:43], v21
    ds_read_b64_tr_b16 v[44:45], v24 offset:4096
    ds_read_b64_tr_b16 v[46:47], v25 offset:4096
    s_waitcnt lgkmcnt(8)
    v_mfma_f32_32x32x16_bf16 v[80:95], v[52:55], v[60:63], v[80:95]
    ds_read_b64_tr_b16 v[48:49], v24 offset:4608
    ds_read_b64_tr_b16 v[50:51], v25 offset:4608
    v_add_u32 v21, 24576, v21
    s_waitcnt lgkmcnt(7)
    v_mfma_f32_32x32x16_bf16 v[64:79], v[28:31], v[32:35], v[64:79]
    ds_read_b128 v[52:55], v22
    ds_read_b64_tr_b16 v[56:57], v24 offset:8192
    ds_read_b64_tr_b16 v[58:59], v25 offset:8192
    s_waitcnt lgkmcnt(8)
    v_mfma_f32_32x32x16_bf16 v[80:95], v[28:31], v[36:39], v[80:95]
    ds_read_b64_tr_b16 v[60:61], v24 offset:8704
    ds_read_b64_tr_b16 v[62:63], v25 offset:8704
    v_add_u32 v22, 24576, v22
    s_waitcnt lgkmcnt(7)
    v_mfma_f32_32x32x16_bf16 v[64:79], v[40:43], v[44:47], v[64:79]
    ds_read_b128 v[28:31], v23
    ds_read_b64_tr_b16 v[32:33], v24 offset:12288
    ds_read_b64_tr_b16 v[34:35], v25 offset:12288
    s_waitcnt lgkmcnt(8)
    v_mfma_f32_32x32x16_bf16 v[80:95], v[40:43], v[48:51], v[80:95]
    ds_read_b64_tr_b16 v[36:37], v24 offset:12800
    ds_read_b64_tr_b16 v[38:39], v25 offset:12800
    v_add_u32 v23, 24576, v23
    v_add_u32 v24, 24576, v24
    v_add_u32 v25, 24576, v25
    s_waitcnt lgkmcnt(7)
    v_mfma_f32_32x32x16_bf16 v[64:79], v[52:55], v[56:59], v[64:79]
    s_waitcnt lgkmcnt(0)
    s_barrier
    ds_read_b128 v[40:43], v20
    ds_read_b64_tr_b16 v[44:45], v24 offset:0
    ds_read_b64_tr_b16 v[46:47], v25 offset:0
    s_waitcnt lgkmcnt(8)
    v_mfma_f32_32x32x16_bf16 v[80:95], v[52:55], v[60:63], v[80:95]
    ds_read_b64_tr_b16 v[48:49], v24 offset:512
    ds_read_b64_tr_b16 v[50:51], v25 offset:512
    v_add_u32 v20, 24576, v20
    s_waitcnt lgkmcnt(7)
    v_mfma_f32_32x32x16_bf16 v[64:79], v[28:31], v[32:35], v[64:79]
    ds_read_b128 v[52:55], v21
    ds_read_b64_tr_b16 v[56:57], v24 offset:4096
    ds_read_b64_tr_b16 v[58:59], v25 offset:4096
    s_waitcnt lgkmcnt(8)
    v_mfma_f32_32x32x16_bf16 v[80:95], v[28:31], v[36:39], v[80:95]
    ds_read_b64_tr_b16 v[60:61], v24 offset:4608
    ds_read_b64_tr_b16 v[62:63], v25 offset:4608
    v_add_u32 v21, 24576, v21
    s_waitcnt lgkmcnt(7)
    v_mfma_f32_32x32x16_bf16 v[64:79], v[40:43], v[44:47], v[64:79]
    ds_read_b128 v[28:31], v22
    ds_read_b64_tr_b16 v[32:33], v24 offset:8192
    ds_read_b64_tr_b16 v[34:35], v25 offset:8192
    s_waitcnt lgkmcnt(8)
    v_mfma_f32_32x32x16_bf16 v[80:95], v[40:43], v[48:51], v[80:95]
    ds_read_b64_tr_b16 v[36:37], v24 offset:8704
    ds_read_b64_tr_b16 v[38:39], v25 offset:8704
    v_add_u32 v22, 24576, v22
    s_waitcnt lgkmcnt(7)
    v_mfma_f32_32x32x16_bf16 v[64:79], v[52:55], v[56:59], v[64:79]
    ds_read_b128 v[40:43], v23
    ds_read_b64_tr_b16 v[44:45], v24 offset:12288
    ds_read_b64_tr_b16 v[46:47], v25 offset:12288
    s_waitcnt lgkmcnt(8)
    v_mfma_f32_32x32x16_bf16 v[80:95], v[52:55], v[60:63], v[80:95]
    ds_read_b64_tr_b16 v[48:49], v24 offset:12800
    ds_read_b64_tr_b16 v[50:51], v25 offset:12800
    v_add_u32 v23, 24576, v23
    v_add_u32 v24, 24576, v24
    v_add_u32 v25, 24576, v25
    s_waitcnt lgkmcnt(7)
    v_mfma_f32_32x32x16_bf16 v[64:79], v[28:31], v[32:35], v[64:79]
    s_waitcnt lgkmcnt(0)
    s_setprio 2
    s_barrier
    ds_read_b128 v[52:55], v20
    ds_read_b64_tr_b16 v[56:57], v24 offset:0
    ds_read_b64_tr_b16 v[58:59], v25 offset:0
    s_waitcnt lgkmcnt(8)
    v_mfma_f32_32x32x16_bf16 v[80:95], v[28:31], v[36:39], v[80:95]
    ds_read_b64_tr_b16 v[60:61], v24 offset:512
    ds_read_b64_tr_b16 v[62:63], v25 offset:512
    v_add_u32 v20, 4294918144, v20
    s_waitcnt lgkmcnt(7)
    v_mfma_f32_32x32x16_bf16 v[64:79], v[40:43], v[44:47], v[64:79]
    ds_read_b128 v[28:31], v21
    ds_read_b64_tr_b16 v[32:33], v24 offset:4096
    ds_read_b64_tr_b16 v[34:35], v25 offset:4096
    s_waitcnt lgkmcnt(8)
    v_mfma_f32_32x32x16_bf16 v[80:95], v[40:43], v[48:51], v[80:95]
    ds_read_b64_tr_b16 v[36:37], v24 offset:4608
    ds_read_b64_tr_b16 v[38:39], v25 offset:4608
    v_add_u32 v21, 4294918144, v21
    s_waitcnt lgkmcnt(7)
    v_mfma_f32_32x32x16_bf16 v[64:79], v[52:55], v[56:59], v[64:79]
    ds_read_b128 v[40:43], v22
    ds_read_b64_tr_b16 v[44:45], v24 offset:8192
    ds_read_b64_tr_b16 v[46:47], v25 offset:8192
    s_waitcnt lgkmcnt(8)
    v_mfma_f32_32x32x16_bf16 v[80:95], v[52:55], v[60:63], v[80:95]
    ds_read_b64_tr_b16 v[48:49], v24 offset:8704
    ds_read_b64_tr_b16 v[50:51], v25 offset:8704
    v_add_u32 v22, 4294918144, v22
    s_waitcnt lgkmcnt(7)
    v_mfma_f32_32x32x16_bf16 v[64:79], v[28:31], v[32:35], v[64:79]
    ds_read_b128 v[52:55], v23
    ds_read_b64_tr_b16 v[56:57], v24 offset:12288
    ds_read_b64_tr_b16 v[58:59], v25 offset:12288
    s_waitcnt lgkmcnt(8)
    v_mfma_f32_32x32x16_bf16 v[80:95], v[28:31], v[36:39], v[80:95]
    ds_read_b64_tr_b16 v[60:61], v24 offset:12800
    ds_read_b64_tr_b16 v[62:63], v25 offset:12800
    v_add_u32 v23, 4294918144, v23
    v_add_u32 v24, 4294918144, v24
    v_add_u32 v25, 4294918144, v25
    s_waitcnt lgkmcnt(7)
    v_mfma_f32_32x32x16_bf16 v[64:79], v[40:43], v[44:47], v[64:79]
    s_waitcnt lgkmcnt(0)
    s_barrier
    ds_read_b128 v[28:31], v20
    ds_read_b64_tr_b16 v[32:33], v24 offset:0
    ds_read_b64_tr_b16 v[34:35], v25 offset:0
    s_waitcnt lgkmcnt(8)
    v_mfma_f32_32x32x16_bf16 v[80:95], v[40:43], v[48:51], v[80:95]
    ds_read_b64_tr_b16 v[36:37], v24 offset:512
    ds_read_b64_tr_b16 v[38:39], v25 offset:512
    v_add_u32 v20, 24576, v20
    s_waitcnt lgkmcnt(7)
    v_mfma_f32_32x32x16_bf16 v[64:79], v[52:55], v[56:59], v[64:79]
    ds_read_b128 v[40:43], v21
    ds_read_b64_tr_b16 v[44:45], v24 offset:4096
    ds_read_b64_tr_b16 v[46:47], v25 offset:4096
    s_waitcnt lgkmcnt(8)
    v_mfma_f32_32x32x16_bf16 v[80:95], v[52:55], v[60:63], v[80:95]
    ds_read_b64_tr_b16 v[48:49], v24 offset:4608
    ds_read_b64_tr_b16 v[50:51], v25 offset:4608
    v_add_u32 v21, 24576, v21
    s_waitcnt lgkmcnt(7)
    v_mfma_f32_32x32x16_bf16 v[64:79], v[28:31], v[32:35], v[64:79]
    ds_read_b128 v[52:55], v22
    ds_read_b64_tr_b16 v[56:57], v24 offset:8192
    ds_read_b64_tr_b16 v[58:59], v25 offset:8192
    s_waitcnt lgkmcnt(8)
    v_mfma_f32_32x32x16_bf16 v[80:95], v[28:31], v[36:39], v[80:95]
    ds_read_b64_tr_b16 v[60:61], v24 offset:8704
    ds_read_b64_tr_b16 v[62:63], v25 offset:8704
    v_add_u32 v22, 24576, v22
    s_waitcnt lgkmcnt(7)
    v_mfma_f32_32x32x16_bf16 v[64:79], v[40:43], v[44:47], v[64:79]
    ds_read_b128 v[28:31], v23
    ds_read_b64_tr_b16 v[32:33], v24 offset:12288
    ds_read_b64_tr_b16 v[34:35], v25 offset:12288
    s_waitcnt lgkmcnt(8)
    v_mfma_f32_32x32x16_bf16 v[80:95], v[40:43], v[48:51], v[80:95]
    ds_read_b64_tr_b16 v[36:37], v24 offset:12800
    ds_read_b64_tr_b16 v[38:39], v25 offset:12800
    v_add_u32 v23, 24576, v23
    v_add_u32 v24, 24576, v24
    v_add_u32 v25, 24576, v25
    s_waitcnt lgkmcnt(7)
    v_mfma_f32_32x32x16_bf16 v[64:79], v[52:55], v[56:59], v[64:79]
    s_waitcnt lgkmcnt(0)
    s_barrier
    ds_read_b128 v[40:43], v20
    ds_read_b64_tr_b16 v[44:45], v24 offset:0
    ds_read_b64_tr_b16 v[46:47], v25 offset:0
    s_waitcnt lgkmcnt(8)
    v_mfma_f32_32x32x16_bf16 v[80:95], v[52:55], v[60:63], v[80:95]
    ds_read_b64_tr_b16 v[48:49], v24 offset:512
    ds_read_b64_tr_b16 v[50:51], v25 offset:512
    v_add_u32 v20, 24576, v20
    s_waitcnt lgkmcnt(7)
    v_mfma_f32_32x32x16_bf16 v[64:79], v[28:31], v[32:35], v[64:79]
    ds_read_b128 v[52:55], v21
    ds_read_b64_tr_b16 v[56:57], v24 offset:4096
    ds_read_b64_tr_b16 v[58:59], v25 offset:4096
    s_waitcnt lgkmcnt(8)
    v_mfma_f32_32x32x16_bf16 v[80:95], v[28:31], v[36:39], v[80:95]
    ds_read_b64_tr_b16 v[60:61], v24 offset:4608
    ds_read_b64_tr_b16 v[62:63], v25 offset:4608
    v_add_u32 v21, 24576, v21
    s_waitcnt lgkmcnt(7)
    v_mfma_f32_32x32x16_bf16 v[64:79], v[40:43], v[44:47], v[64:79]
    ds_read_b128 v[28:31], v22
    ds_read_b64_tr_b16 v[32:33], v24 offset:8192
    ds_read_b64_tr_b16 v[34:35], v25 offset:8192
    s_waitcnt lgkmcnt(8)
    v_mfma_f32_32x32x16_bf16 v[80:95], v[40:43], v[48:51], v[80:95]
    ds_read_b64_tr_b16 v[36:37], v24 offset:8704
    ds_read_b64_tr_b16 v[38:39], v25 offset:8704
    v_add_u32 v22, 24576, v22
    s_waitcnt lgkmcnt(7)
    v_mfma_f32_32x32x16_bf16 v[64:79], v[52:55], v[56:59], v[64:79]
    ds_read_b128 v[40:43], v23
    ds_read_b64_tr_b16 v[44:45], v24 offset:12288
    ds_read_b64_tr_b16 v[46:47], v25 offset:12288
    s_waitcnt lgkmcnt(8)
    v_mfma_f32_32x32x16_bf16 v[80:95], v[52:55], v[60:63], v[80:95]
    ds_read_b64_tr_b16 v[48:49], v24 offset:12800
    ds_read_b64_tr_b16 v[50:51], v25 offset:12800
    v_add_u32 v23, 24576, v23
    v_add_u32 v24, 24576, v24
    v_add_u32 v25, 24576, v25
    s_waitcnt lgkmcnt(7)
    v_mfma_f32_32x32x16_bf16 v[64:79], v[28:31], v[32:35], v[64:79]
    s_waitcnt lgkmcnt(0)
    s_barrier
    ds_read_b128 v[52:55], v20
    ds_read_b64_tr_b16 v[56:57], v24 offset:0
    ds_read_b64_tr_b16 v[58:59], v25 offset:0
    s_waitcnt lgkmcnt(8)
    v_mfma_f32_32x32x16_bf16 v[80:95], v[28:31], v[36:39], v[80:95]
    ds_read_b64_tr_b16 v[60:61], v24 offset:512
    ds_read_b64_tr_b16 v[62:63], v25 offset:512
    v_add_u32 v20, 4294918144, v20
    s_waitcnt lgkmcnt(7)
    v_mfma_f32_32x32x16_bf16 v[64:79], v[40:43], v[44:47], v[64:79]
    ds_read_b128 v[28:31], v21
    ds_read_b64_tr_b16 v[32:33], v24 offset:4096
    ds_read_b64_tr_b16 v[34:35], v25 offset:4096
    s_waitcnt lgkmcnt(8)
    v_mfma_f32_32x32x16_bf16 v[80:95], v[40:43], v[48:51], v[80:95]
    ds_read_b64_tr_b16 v[36:37], v24 offset:4608
    ds_read_b64_tr_b16 v[38:39], v25 offset:4608
    v_add_u32 v21, 4294918144, v21
    s_waitcnt lgkmcnt(7)
    v_mfma_f32_32x32x16_bf16 v[64:79], v[52:55], v[56:59], v[64:79]
    ds_read_b128 v[40:43], v22
    ds_read_b64_tr_b16 v[44:45], v24 offset:8192
    ds_read_b64_tr_b16 v[46:47], v25 offset:8192
    s_waitcnt lgkmcnt(8)
    v_mfma_f32_32x32x16_bf16 v[80:95], v[52:55], v[60:63], v[80:95]
    ds_read_b64_tr_b16 v[48:49], v24 offset:8704
    ds_read_b64_tr_b16 v[50:51], v25 offset:8704
    v_add_u32 v22, 4294918144, v22
    s_waitcnt lgkmcnt(7)
    v_mfma_f32_32x32x16_bf16 v[64:79], v[28:31], v[32:35], v[64:79]
    ds_read_b128 v[52:55], v23
    ds_read_b64_tr_b16 v[56:57], v24 offset:12288
    ds_read_b64_tr_b16 v[58:59], v25 offset:12288
    s_waitcnt lgkmcnt(8)
    v_mfma_f32_32x32x16_bf16 v[80:95], v[28:31], v[36:39], v[80:95]
    ds_read_b64_tr_b16 v[60:61], v24 offset:12800
    ds_read_b64_tr_b16 v[62:63], v25 offset:12800
    v_add_u32 v23, 4294918144, v23
    v_add_u32 v24, 4294918144, v24
    v_add_u32 v25, 4294918144, v25
    s_waitcnt lgkmcnt(7)
    v_mfma_f32_32x32x16_bf16 v[64:79], v[40:43], v[44:47], v[64:79]
    s_waitcnt lgkmcnt(0)
    s_barrier
    ds_read_b128 v[28:31], v20
    ds_read_b64_tr_b16 v[32:33], v24 offset:0
    ds_read_b64_tr_b16 v[34:35], v25 offset:0
    s_waitcnt lgkmcnt(8)
    v_mfma_f32_32x32x16_bf16 v[80:95], v[40:43], v[48:51], v[80:95]
    ds_read_b64_tr_b16 v[36:37], v24 offset:512
    ds_read_b64_tr_b16 v[38:39], v25 offset:512
    v_add_u32 v20, 24576, v20
    s_waitcnt lgkmcnt(7)
    v_mfma_f32_32x32x16_bf16 v[64:79], v[52:55], v[56:59], v[64:79]
    ds_read_b128 v[40:43], v21
    ds_read_b64_tr_b16 v[44:45], v24 offset:4096
    ds_read_b64_tr_b16 v[46:47], v25 offset:4096
    s_waitcnt lgkmcnt(8)
    v_mfma_f32_32x32x16_bf16 v[80:95], v[52:55], v[60:63], v[80:95]
    ds_read_b64_tr_b16 v[48:49], v24 offset:4608
    ds_read_b64_tr_b16 v[50:51], v25 offset:4608
    v_add_u32 v21, 24576, v21
    s_waitcnt lgkmcnt(7)
    v_mfma_f32_32x32x16_bf16 v[64:79], v[28:31], v[32:35], v[64:79]
    ds_read_b128 v[52:55], v22
    ds_read_b64_tr_b16 v[56:57], v24 offset:8192
    ds_read_b64_tr_b16 v[58:59], v25 offset:8192
    s_waitcnt lgkmcnt(8)
    v_mfma_f32_32x32x16_bf16 v[80:95], v[28:31], v[36:39], v[80:95]
    ds_read_b64_tr_b16 v[60:61], v24 offset:8704
    ds_read_b64_tr_b16 v[62:63], v25 offset:8704
    v_add_u32 v22, 24576, v22
    s_waitcnt lgkmcnt(7)
    v_mfma_f32_32x32x16_bf16 v[64:79], v[40:43], v[44:47], v[64:79]
    ds_read_b128 v[28:31], v23
    ds_read_b64_tr_b16 v[32:33], v24 offset:12288
    ds_read_b64_tr_b16 v[34:35], v25 offset:12288
    s_waitcnt lgkmcnt(8)
    v_mfma_f32_32x32x16_bf16 v[80:95], v[40:43], v[48:51], v[80:95]
    ds_read_b64_tr_b16 v[36:37], v24 offset:12800
    ds_read_b64_tr_b16 v[38:39], v25 offset:12800
    v_add_u32 v23, 24576, v23
    v_add_u32 v24, 24576, v24
    v_add_u32 v25, 24576, v25
    s_waitcnt lgkmcnt(7)
    v_mfma_f32_32x32x16_bf16 v[64:79], v[52:55], v[56:59], v[64:79]
    s_waitcnt lgkmcnt(0)
    s_barrier
    ds_read_b128 v[40:43], v20
    ds_read_b64_tr_b16 v[44:45], v24 offset:0
    ds_read_b64_tr_b16 v[46:47], v25 offset:0
    s_waitcnt lgkmcnt(8)
    v_mfma_f32_32x32x16_bf16 v[80:95], v[52:55], v[60:63], v[80:95]
    ds_read_b64_tr_b16 v[48:49], v24 offset:512
    ds_read_b64_tr_b16 v[50:51], v25 offset:512
    v_add_u32 v20, 24576, v20
    s_waitcnt lgkmcnt(7)
    v_mfma_f32_32x32x16_bf16 v[64:79], v[28:31], v[32:35], v[64:79]
    ds_read_b128 v[52:55], v21
    ds_read_b64_tr_b16 v[56:57], v24 offset:4096
    ds_read_b64_tr_b16 v[58:59], v25 offset:4096
    s_waitcnt lgkmcnt(8)
    v_mfma_f32_32x32x16_bf16 v[80:95], v[28:31], v[36:39], v[80:95]
    ds_read_b64_tr_b16 v[60:61], v24 offset:4608
    ds_read_b64_tr_b16 v[62:63], v25 offset:4608
    v_add_u32 v21, 24576, v21
    s_waitcnt lgkmcnt(7)
    v_mfma_f32_32x32x16_bf16 v[64:79], v[40:43], v[44:47], v[64:79]
    ds_read_b128 v[28:31], v22
    ds_read_b64_tr_b16 v[32:33], v24 offset:8192
    ds_read_b64_tr_b16 v[34:35], v25 offset:8192
    s_waitcnt lgkmcnt(8)
    v_mfma_f32_32x32x16_bf16 v[80:95], v[40:43], v[48:51], v[80:95]
    ds_read_b64_tr_b16 v[36:37], v24 offset:8704
    ds_read_b64_tr_b16 v[38:39], v25 offset:8704
    v_add_u32 v22, 24576, v22
    s_waitcnt lgkmcnt(7)
    v_mfma_f32_32x32x16_bf16 v[64:79], v[52:55], v[56:59], v[64:79]
    ds_read_b128 v[40:43], v23
    ds_read_b64_tr_b16 v[44:45], v24 offset:12288
    ds_read_b64_tr_b16 v[46:47], v25 offset:12288
    s_waitcnt lgkmcnt(8)
    v_mfma_f32_32x32x16_bf16 v[80:95], v[52:55], v[60:63], v[80:95]
    ds_read_b64_tr_b16 v[48:49], v24 offset:12800
    ds_read_b64_tr_b16 v[50:51], v25 offset:12800
    v_add_u32 v23, 24576, v23
    v_add_u32 v24, 24576, v24
    v_add_u32 v25, 24576, v25
    s_waitcnt lgkmcnt(7)
    v_mfma_f32_32x32x16_bf16 v[64:79], v[28:31], v[32:35], v[64:79]
    s_waitcnt lgkmcnt(0)
    s_barrier
    ds_read_b128 v[52:55], v20
    ds_read_b64_tr_b16 v[56:57], v24 offset:0
    ds_read_b64_tr_b16 v[58:59], v25 offset:0
    s_waitcnt lgkmcnt(8)
    v_mfma_f32_32x32x16_bf16 v[80:95], v[28:31], v[36:39], v[80:95]
    ds_read_b64_tr_b16 v[60:61], v24 offset:512
    ds_read_b64_tr_b16 v[62:63], v25 offset:512
    v_add_u32 v20, 4294918144, v20
    s_waitcnt lgkmcnt(7)
    v_mfma_f32_32x32x16_bf16 v[64:79], v[40:43], v[44:47], v[64:79]
    ds_read_b128 v[28:31], v21
    ds_read_b64_tr_b16 v[32:33], v24 offset:4096
    ds_read_b64_tr_b16 v[34:35], v25 offset:4096
    s_waitcnt lgkmcnt(8)
    v_mfma_f32_32x32x16_bf16 v[80:95], v[40:43], v[48:51], v[80:95]
    ds_read_b64_tr_b16 v[36:37], v24 offset:4608
    ds_read_b64_tr_b16 v[38:39], v25 offset:4608
    v_add_u32 v21, 4294918144, v21
    s_waitcnt lgkmcnt(7)
    v_mfma_f32_32x32x16_bf16 v[64:79], v[52:55], v[56:59], v[64:79]
    ds_read_b128 v[40:43], v22
    ds_read_b64_tr_b16 v[44:45], v24 offset:8192
    ds_read_b64_tr_b16 v[46:47], v25 offset:8192
    s_waitcnt lgkmcnt(8)
    v_mfma_f32_32x32x16_bf16 v[80:95], v[52:55], v[60:63], v[80:95]
    ds_read_b64_tr_b16 v[48:49], v24 offset:8704
    ds_read_b64_tr_b16 v[50:51], v25 offset:8704
    v_add_u32 v22, 4294918144, v22
    s_waitcnt lgkmcnt(7)
    v_mfma_f32_32x32x16_bf16 v[64:79], v[28:31], v[32:35], v[64:79]
    ds_read_b128 v[52:55], v23
    ds_read_b64_tr_b16 v[56:57], v24 offset:12288
    ds_read_b64_tr_b16 v[58:59], v25 offset:12288
    s_waitcnt lgkmcnt(8)
    v_mfma_f32_32x32x16_bf16 v[80:95], v[28:31], v[36:39], v[80:95]
    ds_read_b64_tr_b16 v[60:61], v24 offset:12800
    ds_read_b64_tr_b16 v[62:63], v25 offset:12800
    v_add_u32 v23, 4294918144, v23
    v_add_u32 v24, 4294918144, v24
    v_add_u32 v25, 4294918144, v25
    s_waitcnt lgkmcnt(7)
    v_mfma_f32_32x32x16_bf16 v[64:79], v[40:43], v[44:47], v[64:79]
    s_waitcnt lgkmcnt(0)
    s_barrier
    ds_read_b128 v[28:31], v20
    ds_read_b64_tr_b16 v[32:33], v24 offset:0
    ds_read_b64_tr_b16 v[34:35], v25 offset:0
    s_waitcnt lgkmcnt(8)
    v_mfma_f32_32x32x16_bf16 v[80:95], v[40:43], v[48:51], v[80:95]
    ds_read_b64_tr_b16 v[36:37], v24 offset:512
    ds_read_b64_tr_b16 v[38:39], v25 offset:512
    v_add_u32 v20, 24576, v20
    s_waitcnt lgkmcnt(7)
    v_mfma_f32_32x32x16_bf16 v[64:79], v[52:55], v[56:59], v[64:79]
    ds_read_b128 v[40:43], v21
    ds_read_b64_tr_b16 v[44:45], v24 offset:4096
    ds_read_b64_tr_b16 v[46:47], v25 offset:4096
    s_waitcnt lgkmcnt(8)
    v_mfma_f32_32x32x16_bf16 v[80:95], v[52:55], v[60:63], v[80:95]
    ds_read_b64_tr_b16 v[48:49], v24 offset:4608
    ds_read_b64_tr_b16 v[50:51], v25 offset:4608
    v_add_u32 v21, 24576, v21
    s_waitcnt lgkmcnt(7)
    v_mfma_f32_32x32x16_bf16 v[64:79], v[28:31], v[32:35], v[64:79]
    ds_read_b128 v[52:55], v22
    ds_read_b64_tr_b16 v[56:57], v24 offset:8192
    ds_read_b64_tr_b16 v[58:59], v25 offset:8192
    s_waitcnt lgkmcnt(8)
    v_mfma_f32_32x32x16_bf16 v[80:95], v[28:31], v[36:39], v[80:95]
    ds_read_b64_tr_b16 v[60:61], v24 offset:8704
    ds_read_b64_tr_b16 v[62:63], v25 offset:8704
    v_add_u32 v22, 24576, v22
    s_waitcnt lgkmcnt(7)
    v_mfma_f32_32x32x16_bf16 v[64:79], v[40:43], v[44:47], v[64:79]
    ds_read_b128 v[28:31], v23
    ds_read_b64_tr_b16 v[32:33], v24 offset:12288
    ds_read_b64_tr_b16 v[34:35], v25 offset:12288
    s_waitcnt lgkmcnt(8)
    v_mfma_f32_32x32x16_bf16 v[80:95], v[40:43], v[48:51], v[80:95]
    ds_read_b64_tr_b16 v[36:37], v24 offset:12800
    ds_read_b64_tr_b16 v[38:39], v25 offset:12800
    v_add_u32 v23, 24576, v23
    v_add_u32 v24, 24576, v24
    v_add_u32 v25, 24576, v25
    s_waitcnt lgkmcnt(7)
    v_mfma_f32_32x32x16_bf16 v[64:79], v[52:55], v[56:59], v[64:79]
    s_waitcnt lgkmcnt(0)
    s_barrier
    ds_read_b128 v[40:43], v20
    ds_read_b64_tr_b16 v[44:45], v24 offset:0
    ds_read_b64_tr_b16 v[46:47], v25 offset:0
    s_waitcnt lgkmcnt(8)
    v_mfma_f32_32x32x16_bf16 v[80:95], v[52:55], v[60:63], v[80:95]
    ds_read_b64_tr_b16 v[48:49], v24 offset:512
    ds_read_b64_tr_b16 v[50:51], v25 offset:512
    v_add_u32 v20, 24576, v20
    s_waitcnt lgkmcnt(7)
    v_mfma_f32_32x32x16_bf16 v[64:79], v[28:31], v[32:35], v[64:79]
    ds_read_b128 v[52:55], v21
    ds_read_b64_tr_b16 v[56:57], v24 offset:4096
    ds_read_b64_tr_b16 v[58:59], v25 offset:4096
    s_waitcnt lgkmcnt(8)
    v_mfma_f32_32x32x16_bf16 v[80:95], v[28:31], v[36:39], v[80:95]
    ds_read_b64_tr_b16 v[60:61], v24 offset:4608
    ds_read_b64_tr_b16 v[62:63], v25 offset:4608
    v_add_u32 v21, 24576, v21
    s_waitcnt lgkmcnt(7)
    v_mfma_f32_32x32x16_bf16 v[64:79], v[40:43], v[44:47], v[64:79]
    ds_read_b128 v[28:31], v22
    ds_read_b64_tr_b16 v[32:33], v24 offset:8192
    ds_read_b64_tr_b16 v[34:35], v25 offset:8192
    s_waitcnt lgkmcnt(8)
    v_mfma_f32_32x32x16_bf16 v[80:95], v[40:43], v[48:51], v[80:95]
    ds_read_b64_tr_b16 v[36:37], v24 offset:8704
    ds_read_b64_tr_b16 v[38:39], v25 offset:8704
    v_add_u32 v22, 24576, v22
    s_waitcnt lgkmcnt(7)
    v_mfma_f32_32x32x16_bf16 v[64:79], v[52:55], v[56:59], v[64:79]
    ds_read_b128 v[40:43], v23
    ds_read_b64_tr_b16 v[44:45], v24 offset:12288
    ds_read_b64_tr_b16 v[46:47], v25 offset:12288
    s_waitcnt lgkmcnt(8)
    v_mfma_f32_32x32x16_bf16 v[80:95], v[52:55], v[60:63], v[80:95]
    ds_read_b64_tr_b16 v[48:49], v24 offset:12800
    ds_read_b64_tr_b16 v[50:51], v25 offset:12800
    v_add_u32 v23, 24576, v23
    v_add_u32 v24, 24576, v24
    v_add_u32 v25, 24576, v25
    s_waitcnt lgkmcnt(7)
    v_mfma_f32_32x32x16_bf16 v[64:79], v[28:31], v[32:35], v[64:79]
    s_waitcnt lgkmcnt(0)
    s_barrier
    ds_read_b128 v[52:55], v20
    ds_read_b64_tr_b16 v[56:57], v24 offset:0
    ds_read_b64_tr_b16 v[58:59], v25 offset:0
    s_waitcnt lgkmcnt(8)
    v_mfma_f32_32x32x16_bf16 v[80:95], v[28:31], v[36:39], v[80:95]
    ds_read_b64_tr_b16 v[60:61], v24 offset:512
    ds_read_b64_tr_b16 v[62:63], v25 offset:512
    s_waitcnt lgkmcnt(7)
    v_mfma_f32_32x32x16_bf16 v[64:79], v[40:43], v[44:47], v[64:79]
    ds_read_b128 v[28:31], v21
    ds_read_b64_tr_b16 v[32:33], v24 offset:4096
    ds_read_b64_tr_b16 v[34:35], v25 offset:4096
    s_waitcnt lgkmcnt(8)
    v_mfma_f32_32x32x16_bf16 v[80:95], v[40:43], v[48:51], v[80:95]
    ds_read_b64_tr_b16 v[36:37], v24 offset:4608
    ds_read_b64_tr_b16 v[38:39], v25 offset:4608
    s_waitcnt lgkmcnt(7)
    v_mfma_f32_32x32x16_bf16 v[64:79], v[52:55], v[56:59], v[64:79]
    ds_read_b128 v[40:43], v22
    ds_read_b64_tr_b16 v[44:45], v24 offset:8192
    ds_read_b64_tr_b16 v[46:47], v25 offset:8192
    s_waitcnt lgkmcnt(8)
    v_mfma_f32_32x32x16_bf16 v[80:95], v[52:55], v[60:63], v[80:95]
    ds_read_b64_tr_b16 v[48:49], v24 offset:8704
    ds_read_b64_tr_b16 v[50:51], v25 offset:8704
    s_waitcnt lgkmcnt(7)
    v_mfma_f32_32x32x16_bf16 v[64:79], v[28:31], v[32:35], v[64:79]
    ds_read_b128 v[52:55], v23
    ds_read_b64_tr_b16 v[56:57], v24 offset:12288
    ds_read_b64_tr_b16 v[58:59], v25 offset:12288
    s_waitcnt lgkmcnt(8)
    v_mfma_f32_32x32x16_bf16 v[80:95], v[28:31], v[36:39], v[80:95]
    ds_read_b64_tr_b16 v[60:61], v24 offset:12800
    ds_read_b64_tr_b16 v[62:63], v25 offset:12800
    s_waitcnt lgkmcnt(7)
    v_mfma_f32_32x32x16_bf16 v[64:79], v[40:43], v[44:47], v[64:79]
    s_waitcnt lgkmcnt(5)
    v_mfma_f32_32x32x16_bf16 v[80:95], v[40:43], v[48:51], v[80:95]
    s_waitcnt lgkmcnt(2)
    v_mfma_f32_32x32x16_bf16 v[64:79], v[52:55], v[56:59], v[64:79]
    s_waitcnt lgkmcnt(0)
    v_mfma_f32_32x32x16_bf16 v[80:95], v[52:55], v[60:63], v[80:95]
    s_setprio 3
    s_nop 9
    ds_write_b128 v6, v[64:67] offset:0
    ds_write_b128 v7, v[68:71] offset:0
    ds_write_b128 v8, v[72:75] offset:0
    ds_write_b128 v9, v[76:79] offset:0
    ds_read_b128 v[64:67], v4 offset:0
    ds_read_b128 v[68:71], v4 offset:1024
    ds_read_b128 v[72:75], v4 offset:2048
    ds_read_b128 v[76:79], v4 offset:3072
    ds_write_b128 v6, v[80:83] offset:4096
    ds_write_b128 v7, v[84:87] offset:4096
    ds_write_b128 v8, v[88:91] offset:4096
    ds_write_b128 v9, v[92:95] offset:4096
    s_waitcnt lgkmcnt(4)
    ds_read_b128 v[80:83], v4 offset:4096
    ds_read_b128 v[84:87], v4 offset:5120
    ds_read_b128 v[88:91], v4 offset:6144
    ds_read_b128 v[92:95], v4 offset:7168
    buffer_store_dwordx4 v[64:67], v10, s[64:67], s12 offen offset:0 sc1
    buffer_store_dwordx4 v[68:71], v11, s[64:67], s12 offen offset:0 sc1
    buffer_store_dwordx4 v[72:75], v12, s[64:67], s12 offen offset:0 sc1
    buffer_store_dwordx4 v[76:79], v13, s[64:67], s12 offen offset:0 sc1
    s_waitcnt lgkmcnt(0)
    buffer_store_dwordx4 v[80:83], v10, s[64:67], s13 offen offset:0 sc1
    buffer_store_dwordx4 v[84:87], v11, s[64:67], s13 offen offset:0 sc1
    buffer_store_dwordx4 v[88:91], v12, s[64:67], s13 offen offset:0 sc1
    buffer_store_dwordx4 v[92:95], v13, s[64:67], s13 offen offset:0 sc1
G2_end:
K2_last:
    s_endpgm
.section .rodata,"a"
.p2align 6
.amdhsa_kernel concat_heads__mha_block__ssm_conv_s5__prompt_kernel
  .amdhsa_next_free_vgpr 128
  .amdhsa_next_free_sgpr 102
  .amdhsa_accum_offset 128
  .amdhsa_group_segment_fixed_size 0
  .amdhsa_kernarg_size 120
  .amdhsa_user_sgpr_count 2
  .amdhsa_user_sgpr_kernarg_segment_ptr 1
  .amdhsa_system_sgpr_workgroup_id_x 1
.end_amdhsa_kernel
```
